```python
import torch

def _softmax(x, axis=-1):
    return torch.softmax(x, dim=axis)

def _gelu(x):
    return torch.nn.functional.gelu(x, approximate='tanh')

def _silu(x):
    return torch.nn.functional.silu(x)

def _sigmoid(x):
    return torch.sigmoid(x)

def _layernorm(x, axis=-1, eps=1e-05):
    m = x.mean(dim=axis, keepdim=True)
    v = x.var(dim=axis, keepdim=True, unbiased=False)
    return (x - m) / torch.sqrt(v + eps)

def _scatter_add(tgt, idx, src, axis=0):
    return tgt.clone().index_add_(axis, idx, src)

def _segment_sum(src, seg, n):
    out = torch.zeros((n,) + src.shape[1:], dtype=src.dtype)
    return out.index_add_(0, seg, src)

def _pad(x, pw):
    flat = tuple((v for pair in reversed(pw) for v in pair))
    return torch.nn.functional.pad(x, flat)
kernel_name = 'adaLN_cond__sliding_block_cached__dense_activation_gelu__prompt'

def setup_inputs():

    _w = lambda a: (lambda t: t.to(torch.bfloat16) if t.is_floating_point() else t)(torch.as_tensor(a))

    def _A_setup():
        B, Sq, D = (1, 2048, 512)
        Hq, Hkv, Sk, Dh = (32, 32, 2048, 128)
        assert Hq % Hkv == 0, (Hq, Hkv)
        return {'x': _w((lambda *s: torch.randn(*s, dtype=torch.bfloat16) * 0.1)(B, Sq, D)), 'k_cache': _w((lambda *s: torch.randn(*s, dtype=torch.bfloat16) * 0.8)(B, Hkv, Sk, Dh)), 'v_cache': _w((lambda *s: torch.randn(*s, dtype=torch.bfloat16) * 3.2)(B, Hkv, Sk, Dh)), 'wq': _w((lambda *s: torch.randn(*s, dtype=torch.bfloat16) * 0.8)(D, Hq * Dh) * D ** (-0.5)), 'wo': _w((lambda *s: torch.randn(*s, dtype=torch.bfloat16) * 3.2)(Hq * Dh, D) * (Hq * Dh) ** (-0.5))}
    _A_in = _A_setup()

    def _B_setup():
        B, S, D, F = (1, 2048, 512, 1376)
        return {'x': _w((lambda *s: torch.randn(*s, dtype=torch.bfloat16) * 0.1)(B, S, D)), 'w1': _w((lambda *s: torch.randn(*s, dtype=torch.bfloat16) * 3.2)(D, F) * D ** (-0.5)), 'b1': _w((lambda *s: torch.randn(*s, dtype=torch.bfloat16) * 3.2)(F) * 0.01), 'w2': _w((lambda *s: torch.randn(*s, dtype=torch.bfloat16) * 3.2)(F, D) * F ** (-0.5)), 'b2': _w((lambda *s: torch.randn(*s, dtype=torch.bfloat16) * 3.2)(D) * 0.01)}
    _B_in = _B_setup()
    return {'A_x': _A_in['x'], 'A_k_cache': _A_in['k_cache'], 'A_v_cache': _A_in['v_cache'], 'A_wq': _A_in['wq'], 'A_wo': _A_in['wo'], 'B_x': _B_in['x'], 'B_w1': _B_in['w1'], 'B_b1': _B_in['b1'], 'B_w2': _B_in['w2'], 'B_b2': _B_in['b2'], 'c': _w((lambda *s: torch.randn(*s, dtype=torch.bfloat16) * 0.1)(1, 512) * 8.0), 'w_mod': _w((lambda *s: torch.randn(*s, dtype=torch.bfloat16) * 0.1)(512, 6 * 512) * 512 ** (-0.5) * 8.0)}

def reference(A_x, A_k_cache, A_v_cache, A_wq, A_wo, B_x, B_w1, B_b1, B_w2, B_b2, c, w_mod):

    def _A_ref(x, k_cache, v_cache, wq, wo):
        B, Sq, D = x.shape
        Hq, Dh = (32, 128)
        Hkv, Sk = (k_cache.shape[1], k_cache.shape[2])
        W = min(4096, max(256, Sk // 4))
        rep = Hq // Hkv
        q = (lambda x, *d: x.permute(*d))((x @ wq).reshape(B, Sq, Hq, Dh), 0, 2, 1, 3)
        k = (lambda x, n, axis: torch.repeat_interleave(x, n, dim=axis))(k_cache[:, :, Sk - W:, :], rep, axis=1)
        v = (lambda x, n, axis: torch.repeat_interleave(x, n, dim=axis))(v_cache[:, :, Sk - W:, :], rep, axis=1)
        scores = torch.einsum('bhqd,bhkd->bhqk', q, k) * Dh ** (-0.5)
        p = _softmax(scores, axis=-1)
        o = torch.einsum('bhqk,bhkd->bhqd', p, v)
        return (lambda x, *d: x.permute(*d))(o, 0, 2, 1, 3).reshape(B, Sq, Hq * Dh) @ wo

    def _B_ref(x, w1, b1, w2, b2):
        h = torch.einsum('bsd,df->bsf', x, w1) + b1
        h = _gelu(h)
        return torch.einsum('bsf,fd->bsd', h, w2) + b2
    x = A_x
    mod = (_silu(c) @ w_mod).reshape(c.shape[0], 6, 1, -1)
    sa, ca, ga, sb, cb, gb = (mod[:, 0].clone(), mod[:, 1].clone(), mod[:, 2].clone(), mod[:, 3].clone(), mod[:, 4].clone(), mod[:, 5].clone())
    h = _layernorm(x, axis=-1) * (1 + ca) + sa
    x = x + ga * _A_ref(h, A_k_cache, A_v_cache, A_wq, A_wo)
    h = _layernorm(x, axis=-1) * (1 + cb) + sb
    x = x + gb * _B_ref(h, B_w1, B_b1, B_w2, B_b2)
    return x
```

```asm
; @launch grid=(256,1,1) block=(256,1,1) lds=163840
.amdgcn_target "amdgcn-amd-amdhsa--gfx950"
.text
.globl adaLN_cond__sliding_block_cached__dense_activation_gelu__prompt_kernel
.p2align 8
.type adaLN_cond__sliding_block_cached__dense_activation_gelu__prompt_kernel,@function
adaLN_cond__sliding_block_cached__dense_activation_gelu__prompt_kernel:
    s_load_dwordx2 s[68:69], s[0:1], 88
    s_load_dwordx2 s[4:5], s[0:1], 80
    s_load_dwordx2 s[8:9], s[0:1], 0
    s_cmp_ge_u32 s2, 256
    s_cbranch_scc1 L_main_end
    s_getpc_b64 s[84:85]
L_pc:
    v_lshlrev_b32 v150, 5, v0
    global_load_dword v150, v150, s[84:85]
    s_load_dwordx2 s[24:25], s[0:1], 112
    s_load_dwordx2 s[20:21], s[0:1], 24
    v_and_b32 v113, 0xf8, v0
    v_mul_u32_u24 v112, 3056, v113
    v_lshl_add_u32 v112, v0, 4, v112
    s_mov_b32 s70, 3145728
    s_mov_b32 s71, 0x20000
    s_movk_i32 s6, 1024
    s_mov_b32 s7, s71
    s_and_b32 s53, s2, 3
    s_lshl_b32 s56, s53, 8
    s_mul_i32 s58, s53, 786400
    s_lshl_b32 s54, s2, 5
    s_add_u32 s58, s58, s54
    s_cmpk_ge_u32 s2, 192
    s_cmov_b32 s58, s70
    s_waitcnt lgkmcnt(0)
    buffer_load_dwordx2 v[116:117], v113, s[4:7], s56 offen
    buffer_load_dwordx4 v[120:123], v112, s[68:71], s58 offen
    s_addk_i32 s58, 6144
    buffer_load_dwordx4 v[124:127], v112, s[68:71], s58 offen
    s_addk_i32 s58, 6144
    buffer_load_dwordx4 v[128:131], v112, s[68:71], s58 offen
    s_addk_i32 s58, 6144
    buffer_load_dwordx4 v[132:135], v112, s[68:71], s58 offen
    s_load_dword s66, s[24:25], 0x50000
    s_lshr_b32 s53, s2, 3
    s_lshl_b32 s53, s53, 11
    v_lshrrev_b32 v151, 4, v0
    v_lshl_add_u32 v151, v151, 7, s53
    v_min_u32 v151, L_code_end - L_pc - 4, v151
    global_load_dword v151, v151, s[84:85]
    v_lshrrev_b32 v16, 6, v0
    v_and_b32 v1, 63, v0
    v_readfirstlane_b32 s3, v16
    s_load_dwordx2 s[12:13], s[0:1], 8
    s_load_dwordx2 s[16:17], s[0:1], 16
    s_load_dwordx2 s[28:29], s[0:1], 96
    s_load_dwordx2 s[32:33], s[0:1], 56
    s_load_dwordx2 s[36:37], s[0:1], 72
    s_lshl2_add_u32 s50, s2, s3
    s_lshl_b32 s50, s50, 5
    s_cmp_lt_u32 s2, 172
    s_cselect_b32 s53, 64, 48
    s_cmp_lt_u32 s2, 128
    s_cselect_b32 s53, 32, s53
    s_mov_b32 s74, 1409024
    s_cmov_b32 s74, 4194304
    s_load_dwordx2 s[72:73], s[0:1], s53
    v_lshlrev_b32 v2, 4, v1
    s_mov_b32 s10, 0x200000
    s_mov_b32 s11, 0x20000
    s_mov_b32 s26, 0x10000000
    s_mov_b32 s27, 0x20000
    s_mov_b32 s22, 0x400000
    s_mov_b32 s23, 0x20000
    s_mov_b32 s14, 0x1000000
    s_mov_b32 s15, 0x20000
    s_mov_b32 s18, 0x1000000
    s_mov_b32 s19, 0x20000
    s_mov_b32 s30, 0x200000
    s_mov_b32 s31, 0x20000
    s_mov_b32 s34, 0xac0
    s_mov_b32 s35, 0x20000
    s_mov_b32 s38, 0x400
    s_mov_b32 s39, 0x20000
    s_mov_b32 s75, 0x20000
    s_lshr_b32 s53, s2, 3
    s_and_b32 s54, s2, 7
    s_and_b32 s55, s53, 3
    s_lshl2_add_u32 s40, s54, s55
    s_lshr_b32 s41, s53, 2
    s_lshl_b32 s43, s41, 1
    s_mul_i32 s52, s3, 2112
    s_lshr_b32 s55, s53, 3
    s_lshl2_add_u32 s61, s54, s55
    s_and_b32 s62, s53, 7
    v_and_b32 v100, 7, v1
    v_lshrrev_b32 v101, 3, v1
    v_lshlrev_b32 v24, 10, v100
    v_lshl_add_u32 v24, v101, 4, v24
    s_lshl_b32 s63, s2, 13
    s_lshl_b32 s54, s3, 8
    s_add_u32 s63, s63, s54
    s_lshl_b32 s42, s41, 2
    s_add_u32 s42, s42, s3
    s_lshl_b32 s44, s40, 19
    s_add_u32 s44, s44, 393216
    s_mul_i32 s51, s3, 2176
    s_mov_b32 s48, 0
    s_cmp_eq_u32 s3, 0
    s_cselect_b32 s41, s50, 0x10000000
    v_bfe_u32 v16, v1, 2, 3
    v_mul_u32_u24 v4, 1056, v16
    v_lshrrev_b32 v16, 5, v1
    v_lshl_add_u32 v4, v16, 8, v4
    v_and_b32 v17, 3, v1
    v_lshl_add_u32 v4, v17, 3, v4
    v_and_b32 v16, 3, v1
    v_mul_u32_u24 v3, 1088, v16
    v_bfe_u32 v16, v1, 2, 2
    v_lshl_add_u32 v3, v16, 8, v3
    v_bfe_u32 v16, v1, 4, 1
    v_lshl_add_u32 v3, v16, 5, v3
    v_lshrrev_b32 v16, 5, v1
    v_bfe_u32 v17, v1, 3, 1
    v_xor_b32 v16, v16, v17
    v_lshl_add_u32 v3, v16, 4, v3
    s_lshr_b32 s53, s3, 1
    s_lshl_b32 s53, s53, 12
    s_and_b32 s54, s3, 1
    s_lshl_b32 s54, s54, 9
    s_add_u32 s53, s53, s54
    v_lshrrev_b32 v16, 4, v1
    v_lshlrev_b32 v5, 10, v16
    v_and_b32 v16, 15, v1
    v_lshrrev_b32 v17, 5, v1
    v_xor_b32 v16, v16, v17
    v_lshl_add_u32 v5, v16, 4, v5
    v_add_u32 v5, s53, v5
    s_lshl_b32 s53, s3, 9
    v_lshrrev_b32 v16, 4, v1
    v_lshlrev_b32 v6, 11, v16
    v_and_b32 v16, 15, v1
    v_lshl_add_u32 v6, v16, 4, v6
    v_add_u32 v6, s53, v6
    s_lshr_b32 s59, s42, 2
    s_mul_i32 s59, s59, 16384
    s_mov_b32 s60, s59
    s_add_u32 s46, s44, s59
    s_mov_b32 s47, s46
    v_add_u32 v16, s3, v1
    v_add_u32 v17, s40, v16
    v_and_b32 v16, 12, v16
    v_mov_b32 v18, 0x804c
    v_bfe_u32 v16, v18, v16, 4
    v_and_or_b32 v16, v17, 3, v16
    v_mul_u32_u24 v233, 8448, v16
    v_add_u32 v233, 25856, v233
    v_add_u32 v16, s43, v16
    v_and_b32 v16, 15, v16
    s_lshl_b32 s54, s42, 16
    s_add_u32 s54, s54, 0x100000
    v_lshl_add_u32 v232, v16, 12, s54
    v_readlane_b32 s53, v233, 0
    v_readlane_b32 s54, v233, 1
    v_readlane_b32 s55, v233, 2
    v_readlane_b32 s56, v233, 3
    v_add_u32 v216, s53, v4
    v_add_u32 v217, s54, v4
    v_add_u32 v218, s55, v4
    v_add_u32 v219, s56, v4
    v_readlane_b32 s53, v233, 4
    v_readlane_b32 s54, v233, 5
    v_readlane_b32 s55, v233, 6
    v_readlane_b32 s56, v233, 7
    v_add_u32 v220, s53, v4
    v_add_u32 v221, s54, v4
    v_add_u32 v222, s55, v4
    v_add_u32 v223, s56, v4
    v_readlane_b32 s53, v233, 8
    v_readlane_b32 s54, v233, 9
    v_readlane_b32 s55, v233, 10
    v_readlane_b32 s56, v233, 11
    v_add_u32 v224, s53, v4
    v_add_u32 v225, s54, v4
    v_add_u32 v226, s55, v4
    v_add_u32 v227, s56, v4
    v_readlane_b32 s53, v233, 12
    v_readlane_b32 s54, v233, 13
    v_readlane_b32 s55, v233, 14
    v_readlane_b32 s56, v233, 15
    v_add_u32 v228, s53, v4
    v_add_u32 v229, s54, v4
    v_add_u32 v230, s55, v4
    v_add_u32 v231, s56, v4
    v_readlane_b32 s84, v232, 0
    v_readlane_b32 s85, v232, 1
    v_readlane_b32 s86, v232, 2
    v_readlane_b32 s87, v232, 3
    v_readlane_b32 s88, v232, 4
    v_readlane_b32 s89, v232, 5
    v_readlane_b32 s90, v232, 6
    v_readlane_b32 s91, v232, 7
    v_readlane_b32 s92, v232, 8
    v_readlane_b32 s93, v232, 9
    v_readlane_b32 s94, v232, 10
    v_readlane_b32 s95, v232, 11
    v_readlane_b32 s96, v232, 12
    v_readlane_b32 s97, v232, 13
    v_readlane_b32 s98, v232, 14
    v_readlane_b32 s99, v232, 15
    buffer_load_dwordx4 v[28:31], v24, s[8:11], s63 offen
    buffer_load_dwordx4 v[32:35], v24, s[8:11], s63 offen offset:128
    buffer_load_ubyte v149, v1, s[24:27], s41 offen sc1
    v_bfe_u32 v102, v1, 4, 1
    v_lshlrev_b32 v110, 17, v102
    v_lshrrev_b32 v102, 5, v1
    v_lshl_add_u32 v110, v102, 15, v110
    v_and_b32 v102, 15, v1
    v_lshl_add_u32 v110, v102, 4, v110
    v_add_u32 v111, 8192, v110
    s_and_b32 s53, s3, 1
    s_lshl_b32 s53, s53, 14
    s_lshr_b32 s54, s3, 1
    s_lshl_b32 s54, s54, 16
    s_add_u32 s58, s53, s54
    s_lshl_b32 s53, s40, 8
    s_add_u32 s58, s58, s53
    s_lshl_b32 s53, s43, 18
    s_add_u32 s58, s58, s53
    v_lshrrev_b32 v27, 4, v1
    v_lshlrev_b32 v27, 3, v27
    v_lshl_add_u32 v27, v100, 5, v27
    s_lshl_b32 s53, s3, 8
    v_add_u32 v27, s53, v27
    v_lshrrev_b32 v102, 5, v1
    v_lshl_add_u32 v144, v100, 1, v102
    v_lshlrev_b32 v144, 4, v144
    s_lshl_b32 s53, s3, 2
    v_add_u32 v144, s53, v144
    v_cvt_f32_u32 v114, v102
    v_mov_b32 v115, 0x3e0293ee
    v_lshlrev_b32 v26, 12, v102
    v_and_b32 v103, 3, v101
    v_lshl_add_u32 v26, v103, 8, v26
    v_lshl_add_u32 v26, v100, 4, v26
    v_and_b32 v103, 31, v1
    v_lshlrev_b32 v25, 4, v103
    v_lshl_add_u32 v25, v102, 11, v25
    s_lshl_b32 s53, s3, 9
    v_add_u32 v25, s53, v25
    s_lshl_b32 s53, s3, 10
    s_add_u32 s53, s53, 17408
    v_add_u32 v145, s53, v2
    v_lshl_add_u32 v146, v101, 5, s53
    s_lshl_b32 s53, s42, 5
    v_add_u32 v10, s53, v103
    v_lshlrev_b32 v10, 5, v10
    s_lshr_b32 s53, s2, 3
    s_lshl_b32 s53, s53, 16
    s_lshl_b32 s54, s3, 14
    s_add_u32 s53, s53, s54
    s_and_b32 s54, s2, 6
    s_lshl_b32 s54, s54, 9
    s_add_u32 s53, s53, s54
    s_and_b32 s54, s2, 1
    s_lshl_b32 s54, s54, 7
    s_add_u32 s53, s53, s54
    s_add_u32 s53, s53, 0x100000
    v_add_u32 v26, s53, v26
    s_and_b32 s53, s2, 3
    s_mul_i32 s53, s53, 12288
    s_lshr_b32 s54, s2, 2
    s_lshl_b32 s54, s54, 8
    s_add_u32 s53, s53, s54
    s_add_u32 s57, s53, 0x40000
    s_cmp_ge_u32 s2, 192
    s_cmov_b32 s57, 0x10000000
    s_cmp_lg_u32 s3, 0
    s_cmov_b32 s57, 0x10000000
    v_and_b32 v10, 0xffffff80, v10
    s_mov_b32 s4, 0x40000
    s_mov_b32 s5, 0x43000
    s_mov_b32 s6, 0x46000
    s_mov_b32 s7, 0x49000
    s_waitcnt vmcnt(8)
    v_and_b32 v119, 0xffff0000, v117
    v_lshlrev_b32 v118, 16, v117
    v_and_b32 v117, 0xffff0000, v116
    v_lshlrev_b32 v116, 16, v116
    v_mul_f32 v136, 0xbfb8aa3b, v116
    v_mul_f32 v137, 0xbfb8aa3b, v117
    v_mul_f32 v138, 0xbfb8aa3b, v118
    v_mul_f32 v139, 0xbfb8aa3b, v119
    v_exp_f32 v136, v136
    v_exp_f32 v137, v137
    v_exp_f32 v138, v138
    v_exp_f32 v139, v139
    v_add_f32 v136, 1.0, v136
    v_add_f32 v137, 1.0, v137
    v_add_f32 v138, 1.0, v138
    v_add_f32 v139, 1.0, v139
    v_rcp_f32 v136, v136
    v_rcp_f32 v137, v137
    v_rcp_f32 v138, v138
    v_rcp_f32 v139, v139
    v_pk_mul_f32 v[116:117], v[116:117], v[136:137]
    v_pk_mul_f32 v[118:119], v[118:119], v[138:139]
    v_cvt_pk_bf16_f32 v136, v116, v117
    v_cvt_pk_bf16_f32 v137, v118, v119
    v_lshlrev_b32 v116, 16, v136
    v_and_b32 v117, 0xffff0000, v136
    v_lshlrev_b32 v118, 16, v137
    v_and_b32 v119, 0xffff0000, v137
    s_waitcnt vmcnt(7)
    v_lshlrev_b32 v68, 16, v120
    v_and_b32 v69, 0xffff0000, v120
    v_lshlrev_b32 v70, 16, v121
    v_and_b32 v71, 0xffff0000, v121
    v_lshlrev_b32 v72, 16, v122
    v_and_b32 v73, 0xffff0000, v122
    v_lshlrev_b32 v74, 16, v123
    v_and_b32 v75, 0xffff0000, v123
    v_pk_mul_f32 v[136:137], v[68:69], v[116:117] op_sel_hi:[1,0]
    v_pk_mul_f32 v[138:139], v[70:71], v[116:117] op_sel_hi:[1,0]
    v_pk_mul_f32 v[140:141], v[72:73], v[116:117] op_sel_hi:[1,0]
    v_pk_mul_f32 v[142:143], v[74:75], v[116:117] op_sel_hi:[1,0]
    s_waitcnt vmcnt(6)
    v_lshlrev_b32 v68, 16, v124
    v_and_b32 v69, 0xffff0000, v124
    v_lshlrev_b32 v70, 16, v125
    v_and_b32 v71, 0xffff0000, v125
    v_lshlrev_b32 v72, 16, v126
    v_and_b32 v73, 0xffff0000, v126
    v_lshlrev_b32 v74, 16, v127
    v_and_b32 v75, 0xffff0000, v127
    v_pk_fma_f32 v[136:137], v[68:69], v[116:117], v[136:137] op_sel:[0,1,0]
    v_pk_fma_f32 v[138:139], v[70:71], v[116:117], v[138:139] op_sel:[0,1,0]
    v_pk_fma_f32 v[140:141], v[72:73], v[116:117], v[140:141] op_sel:[0,1,0]
    v_pk_fma_f32 v[142:143], v[74:75], v[116:117], v[142:143] op_sel:[0,1,0]
    s_waitcnt vmcnt(5)
    s_add_u32 m0, s52, 25856
    s_and_b32 s58, s58, 0x3fffff
    buffer_load_dwordx4 v110, s[20:23], s58 offen lds
    s_add_u32 m0, s52, 26912
    s_nop 0
    buffer_load_dwordx4 v111, s[20:23], s58 offen lds
    s_add_u32 s58, s58, 0x40000
    v_lshlrev_b32 v68, 16, v128
    v_and_b32 v69, 0xffff0000, v128
    v_lshlrev_b32 v70, 16, v129
    v_and_b32 v71, 0xffff0000, v129
    v_lshlrev_b32 v72, 16, v130
    v_and_b32 v73, 0xffff0000, v130
    v_lshlrev_b32 v74, 16, v131
    v_and_b32 v75, 0xffff0000, v131
    v_pk_fma_f32 v[136:137], v[68:69], v[118:119], v[136:137] op_sel_hi:[1,0,1]
    v_pk_fma_f32 v[138:139], v[70:71], v[118:119], v[138:139] op_sel_hi:[1,0,1]
    v_pk_fma_f32 v[140:141], v[72:73], v[118:119], v[140:141] op_sel_hi:[1,0,1]
    v_pk_fma_f32 v[142:143], v[74:75], v[118:119], v[142:143] op_sel_hi:[1,0,1]
    s_waitcnt vmcnt(6)
    v_lshlrev_b32 v68, 16, v132
    v_and_b32 v69, 0xffff0000, v132
    v_lshlrev_b32 v70, 16, v133
    v_and_b32 v71, 0xffff0000, v133
    v_lshlrev_b32 v72, 16, v134
    v_and_b32 v73, 0xffff0000, v134
    v_lshlrev_b32 v74, 16, v135
    v_and_b32 v75, 0xffff0000, v135
    v_pk_fma_f32 v[136:137], v[68:69], v[118:119], v[136:137] op_sel:[0,1,0]
    v_pk_fma_f32 v[138:139], v[70:71], v[118:119], v[138:139] op_sel:[0,1,0]
    v_pk_fma_f32 v[140:141], v[72:73], v[118:119], v[140:141] op_sel:[0,1,0]
    v_pk_fma_f32 v[142:143], v[74:75], v[118:119], v[142:143] op_sel:[0,1,0]
    s_nop 0
    v_permlane32_swap_b32 v136, v140
    v_permlane32_swap_b32 v137, v141
    v_permlane32_swap_b32 v138, v142
    v_permlane32_swap_b32 v139, v143
    v_pk_add_f32 v[136:137], v[136:137], v[140:141]
    v_pk_add_f32 v[138:139], v[138:139], v[142:143]
    v_lshlrev_b32 v103, 2, v1
    s_nop 0
    v_permlane16_swap_b32 v136, v138
    v_permlane16_swap_b32 v137, v139
    v_pk_add_f32 v[136:137], v[136:137], v[138:139]
    s_nop 1
    v_add_f32_dpp v136, v136, v136 row_ror:8 row_mask:0xf bank_mask:0xf
    v_add_f32_dpp v137, v137, v137 row_ror:8 row_mask:0xf bank_mask:0xf
    ds_write_b64 v27, v[136:137] offset:21760
    s_waitcnt lgkmcnt(0)
    s_barrier
    s_mul_i32 s66, s66, 1664525
    s_add_u32 s66, s66, 1013904223
    ds_read_b32 v136, v103 offset:21760
    ds_read_b32 v137, v103 offset:22016
    ds_read_b32 v138, v103 offset:22272
    ds_read_b32 v139, v103 offset:22528
    v_mov_b32 v140, 0xff
    s_waitcnt lgkmcnt(0)
    v_add_f32 v136, v136, v137
    v_add_f32 v138, v138, v139
    v_add_f32 v136, v136, v138
    v_bfi_b32 v136, v140, s66, v136
    buffer_store_dword v136, v103, s[24:27], s57 offen sc1
    s_add_u32 m0, s52, 34304
    s_and_b32 s58, s58, 0x3fffff
    buffer_load_dwordx4 v110, s[20:23], s58 offen lds
    s_add_u32 m0, s52, 35360
    s_nop 0
    buffer_load_dwordx4 v111, s[20:23], s58 offen lds
    s_add_u32 s58, s58, 0x40000
    s_add_u32 m0, s52, 42752
    s_and_b32 s58, s58, 0x3fffff
    buffer_load_dwordx4 v110, s[20:23], s58 offen lds
    s_add_u32 m0, s52, 43808
    s_nop 0
    buffer_load_dwordx4 v111, s[20:23], s58 offen lds
    s_add_u32 s58, s58, 0x40000
    s_add_u32 m0, s52, 51200
    s_and_b32 s58, s58, 0x3fffff
    buffer_load_dwordx4 v110, s[20:23], s58 offen lds
    s_add_u32 m0, s52, 52256
    s_nop 0
    buffer_load_dwordx4 v111, s[20:23], s58 offen lds
    s_add_u32 s58, s58, 0x40000
    s_add_u32 m0, s52, 59648
    s_and_b32 s58, s58, 0x3fffff
    buffer_load_dwordx4 v110, s[20:23], s58 offen lds
    s_add_u32 m0, s52, 60704
    s_nop 0
    buffer_load_dwordx4 v111, s[20:23], s58 offen lds
    s_add_u32 s58, s58, 0x40000
    s_waitcnt vmcnt(12)
    v_lshlrev_b32 v52, 16, v28
    v_and_b32 v53, 0xffff0000, v28
    v_lshlrev_b32 v54, 16, v29
    v_and_b32 v55, 0xffff0000, v29
    v_lshlrev_b32 v56, 16, v30
    v_and_b32 v57, 0xffff0000, v30
    v_lshlrev_b32 v58, 16, v31
    v_and_b32 v59, 0xffff0000, v31
    v_lshlrev_b32 v60, 16, v32
    v_and_b32 v61, 0xffff0000, v32
    v_lshlrev_b32 v62, 16, v33
    v_and_b32 v63, 0xffff0000, v33
    v_lshlrev_b32 v64, 16, v34
    v_and_b32 v65, 0xffff0000, v34
    v_lshlrev_b32 v66, 16, v35
    v_and_b32 v67, 0xffff0000, v35
    v_pk_add_f32 v[68:69], v[52:53], v[54:55]
    v_pk_mul_f32 v[70:71], v[52:53], v[52:53]
    v_pk_fma_f32 v[70:71], v[54:55], v[54:55], v[70:71]
    v_pk_add_f32 v[68:69], v[68:69], v[56:57]
    v_pk_fma_f32 v[70:71], v[56:57], v[56:57], v[70:71]
    v_pk_add_f32 v[68:69], v[68:69], v[58:59]
    v_pk_fma_f32 v[70:71], v[58:59], v[58:59], v[70:71]
    v_pk_add_f32 v[68:69], v[68:69], v[60:61]
    v_pk_fma_f32 v[70:71], v[60:61], v[60:61], v[70:71]
    v_pk_add_f32 v[68:69], v[68:69], v[62:63]
    v_pk_fma_f32 v[70:71], v[62:63], v[62:63], v[70:71]
    v_pk_add_f32 v[68:69], v[68:69], v[64:65]
    v_pk_fma_f32 v[70:71], v[64:65], v[64:65], v[70:71]
    v_pk_add_f32 v[68:69], v[68:69], v[66:67]
    v_pk_fma_f32 v[70:71], v[66:67], v[66:67], v[70:71]
    v_add_f32 v102, v68, v69
    v_add_f32 v103, v70, v71
    v_lshlrev_b32 v106, 5, v100
    s_nop 0
    v_permlane32_swap_b32 v102, v103
    v_add_f32 v102, v102, v103
    v_mov_b32 v103, v102
    s_nop 1
    v_permlane16_swap_b32 v102, v103
    v_add_f32 v102, v102, v103
    s_nop 1
    v_add_f32_dpp v102, v102, v102 row_ror:8 row_mask:0xf bank_mask:0xf
    ds_write_b32 v144, v102 offset:21504
    s_waitcnt lgkmcnt(0)
    s_barrier
    ds_read_b128 v[36:39], v106 offset:21504
    ds_read_b128 v[40:43], v106 offset:21520
    s_waitcnt lgkmcnt(0)
    v_add_f32 v36, v36, v37
    v_add_f32 v38, v38, v39
    v_add_f32 v40, v40, v41
    v_add_f32 v42, v42, v43
    v_add_f32 v36, v36, v38
    v_add_f32 v40, v40, v42
    v_mul_f32 v36, 0x3b000000, v36
    v_mul_f32 v40, 0x3b000000, v40
    v_fma_f32 v40, -v36, v36, v40
    v_max_f32 v40, 0, v40
    v_add_f32 v40, 0x3727c5ac, v40
    v_rsq_f32 v108, v40
    v_mov_b32 v109, v36
    s_mov_b32 s49, 0x80000
    buffer_load_dwordx4 v[36:39], v25, s[24:27], s4 offen sc1
    buffer_load_dwordx4 v[40:43], v25, s[24:27], s5 offen sc1
    buffer_load_dwordx4 v[44:47], v25, s[24:27], s6 offen sc1
    buffer_load_dwordx4 v[48:51], v25, s[24:27], s7 offen sc1
    v_pk_add_f32 v[52:53], v[52:53], v[108:109] op_sel:[0,1] neg_lo:[0,1] neg_hi:[0,1]
    v_pk_add_f32 v[54:55], v[54:55], v[108:109] op_sel:[0,1] neg_lo:[0,1] neg_hi:[0,1]
    v_pk_add_f32 v[56:57], v[56:57], v[108:109] op_sel:[0,1] neg_lo:[0,1] neg_hi:[0,1]
    v_pk_add_f32 v[58:59], v[58:59], v[108:109] op_sel:[0,1] neg_lo:[0,1] neg_hi:[0,1]
    v_pk_add_f32 v[60:61], v[60:61], v[108:109] op_sel:[0,1] neg_lo:[0,1] neg_hi:[0,1]
    v_pk_add_f32 v[62:63], v[62:63], v[108:109] op_sel:[0,1] neg_lo:[0,1] neg_hi:[0,1]
    v_pk_add_f32 v[64:65], v[64:65], v[108:109] op_sel:[0,1] neg_lo:[0,1] neg_hi:[0,1]
    v_pk_add_f32 v[66:67], v[66:67], v[108:109] op_sel:[0,1] neg_lo:[0,1] neg_hi:[0,1]
    v_pk_mul_f32 v[52:53], v[52:53], v[108:109] op_sel_hi:[1,0]
    v_pk_mul_f32 v[54:55], v[54:55], v[108:109] op_sel_hi:[1,0]
    v_pk_mul_f32 v[56:57], v[56:57], v[108:109] op_sel_hi:[1,0]
    v_pk_mul_f32 v[58:59], v[58:59], v[108:109] op_sel_hi:[1,0]
    v_pk_mul_f32 v[60:61], v[60:61], v[108:109] op_sel_hi:[1,0]
    v_pk_mul_f32 v[62:63], v[62:63], v[108:109] op_sel_hi:[1,0]
    v_pk_mul_f32 v[64:65], v[64:65], v[108:109] op_sel_hi:[1,0]
    v_pk_mul_f32 v[66:67], v[66:67], v[108:109] op_sel_hi:[1,0]
    s_branch L_tlt_3
L_tl_1:
    buffer_load_dwordx4 v[36:39], v25, s[24:27], s4 offen sc1
    buffer_load_dwordx4 v[40:43], v25, s[24:27], s5 offen sc1
    buffer_load_dwordx4 v[44:47], v25, s[24:27], s6 offen sc1
    buffer_load_dwordx4 v[48:51], v25, s[24:27], s7 offen sc1
L_tlt_3:
    s_sub_u32 s49, s49, 1
    s_waitcnt vmcnt(0)
    s_cbranch_scc1 L_tld_2
    s_and_b32 s45, s66, 0xff
    v_xor_b32 v36, s45, v36
    v_xor_b32 v37, s45, v37
    v_xor_b32 v38, s45, v38
    v_xor_b32 v39, s45, v39
    v_xor_b32 v40, s45, v40
    v_xor_b32 v41, s45, v41
    v_xor_b32 v42, s45, v42
    v_xor_b32 v43, s45, v43
    v_xor_b32 v44, s45, v44
    v_xor_b32 v45, s45, v45
    v_xor_b32 v46, s45, v46
    v_xor_b32 v47, s45, v47
    v_xor_b32 v48, s45, v48
    v_xor_b32 v49, s45, v49
    v_xor_b32 v50, s45, v50
    v_xor_b32 v51, s45, v51
    v_or_b32 v106, v36, v37
    v_or3_b32 v106, v38, v39, v106
    v_or3_b32 v106, v40, v41, v106
    v_or3_b32 v106, v42, v43, v106
    v_or3_b32 v106, v44, v45, v106
    v_or3_b32 v106, v46, v47, v106
    v_or3_b32 v106, v48, v49, v106
    v_or3_b32 v106, v50, v51, v106
    v_and_b32 v106, 0xff, v106
    v_cmp_ne_u32 vcc, 0, v106
    s_cbranch_vccnz L_tl_1
L_tld_2:
    v_pk_add_f32 v[36:37], v[36:37], v[40:41]
    v_pk_add_f32 v[38:39], v[38:39], v[42:43]
    v_pk_add_f32 v[44:45], v[44:45], v[48:49]
    v_pk_add_f32 v[46:47], v[46:47], v[50:51]
    v_pk_add_f32 v[36:37], v[36:37], v[44:45]
    v_pk_add_f32 v[38:39], v[38:39], v[46:47]
    v_cvt_pk_bf16_f32 v40, v36, v37
    v_cvt_pk_bf16_f32 v41, v38, v39
    v_lshlrev_b32 v36, 16, v40
    v_and_b32 v37, 0xffff0000, v40
    v_lshlrev_b32 v38, 16, v41
    v_and_b32 v39, 0xffff0000, v41
    v_pk_add_f32 v[36:37], v[114:115], v[36:37] op_sel_hi:[0,1]
    v_pk_add_f32 v[38:39], v[114:115], v[38:39] op_sel_hi:[0,1]
    v_cvt_pk_bf16_f32 v40, v36, v37
    v_cvt_pk_bf16_f32 v41, v38, v39
    v_lshlrev_b32 v36, 16, v40
    v_and_b32 v37, 0xffff0000, v40
    v_lshlrev_b32 v38, 16, v41
    v_and_b32 v39, 0xffff0000, v41
    v_pk_mul_f32 v[36:37], v[114:115], v[36:37] op_sel:[1,0]
    v_pk_mul_f32 v[38:39], v[114:115], v[38:39] op_sel:[1,0]
    ds_write_b128 v145, v[36:39]
    ds_read_b128 v[84:87], v146 offset:512
    ds_read_b128 v[68:71], v146 offset:0
    ds_read_b128 v[88:91], v146 offset:528
    ds_read_b128 v[72:75], v146 offset:16
    ds_read_b128 v[92:95], v146 offset:768
    ds_read_b128 v[76:79], v146 offset:256
    ds_read_b128 v[96:99], v146 offset:784
    ds_read_b128 v[80:83], v146 offset:272
    s_mov_b32 s57, 8192
    s_waitcnt lgkmcnt(4)
    v_pk_fma_f32 v[52:53], v[52:53], v[84:85], v[68:69]
    v_pk_fma_f32 v[54:55], v[54:55], v[86:87], v[70:71]
    v_pk_fma_f32 v[56:57], v[56:57], v[88:89], v[72:73]
    v_pk_fma_f32 v[58:59], v[58:59], v[90:91], v[74:75]
    v_cvt_pk_bf16_f32 v28, v52, v53
    v_cvt_pk_bf16_f32 v29, v54, v55
    v_cvt_pk_bf16_f32 v30, v56, v57
    v_cvt_pk_bf16_f32 v31, v58, v59
    buffer_store_dwordx4 v[28:31], v26, s[24:27], 0 offen sc1
    s_waitcnt lgkmcnt(0)
    v_pk_fma_f32 v[60:61], v[60:61], v[92:93], v[76:77]
    v_pk_fma_f32 v[62:63], v[62:63], v[94:95], v[78:79]
    v_pk_fma_f32 v[64:65], v[64:65], v[96:97], v[80:81]
    v_pk_fma_f32 v[66:67], v[66:67], v[98:99], v[82:83]
    v_cvt_pk_bf16_f32 v32, v60, v61
    v_cvt_pk_bf16_f32 v33, v62, v63
    v_cvt_pk_bf16_f32 v34, v64, v65
    v_cvt_pk_bf16_f32 v35, v66, v67
    buffer_store_dwordx4 v[32:35], v26, s[24:27], s57 offen sc1
    s_mov_b32 s76, 1024
    s_mov_b32 s79, 1024
    s_mov_b32 s55, 8
    s_mov_b32 s56, 16
    s_and_b32 s54, s2, 3
    s_and_b32 s53, s2, 0x7c
    s_add_u32 s53, s53, s3
    s_cmp_ge_u32 s2, 172
    s_cbranch_scc1 L_rl_w1
    s_cmp_ge_u32 s2, 128
    s_cbranch_scc1 L_rl_w2
    s_lshl_b32 s78, s54, 8
    s_add_u32 s78, s78, s53
    s_lshl_b32 s78, s78, 12
    s_add_u32 s78, s78, 0xb00000
    s_mov_b32 s80, 521216
    s_mov_b32 s81, 1024
    s_branch L_rl_go
L_rl_w2:
    s_mul_i32 s78, s54, 86
    s_add_u32 s78, s78, s53
    s_lshl_b32 s78, s78, 12
    s_add_u32 s78, s78, 0xf00000
    s_mov_b32 s80, 173056
    s_mov_b32 s81, 5120
    s_mov_b32 s55, 16
    s_mov_b32 s56, 4
    s_cmp_ge_u32 s53, 43
    s_cmov_b32 s78, 0x10000000
    s_branch L_rl_go
L_rl_w1:
    s_lshl_b32 s53, s54, 2
    s_add_u32 s53, s53, s3
    s_sub_u32 s54, s2, 172
    s_lshr_b32 s54, s54, 2
    s_mov_b32 s76, 2752
    s_lshl_b32 s78, s54, 7
    s_add_u32 s78, s78, s53
    s_lshl_b32 s78, s78, 10
    s_add_u32 s78, s78, 0x1080000
    s_mov_b32 s79, 16384
    s_mov_b32 s80, 16384
    s_mov_b32 s81, 2752
L_rl_go:
    s_mul_i32 s77, s53, s76
    s_lshl_b32 s77, s77, 5
    s_lshl_b32 s54, s54, 8
    s_add_u32 s77, s77, s54
    s_cmp_ge_u32 s2, 216
    s_cmov_b32 s77, 0x10000000
    s_cmov_b32 s78, 0x10000000
    v_bfe_u32 v7, v1, 4, 1
    v_mul_u32_u24 v7, s55, v7
    v_lshrrev_b32 v16, 5, v1
    v_mad_u32_u24 v7, v16, s56, v7
    v_mul_u32_u24 v7, s76, v7
    v_and_b32 v16, 15, v1
    v_lshl_add_u32 v7, v16, 4, v7
    s_mul_i32 s82, s3, 8448
    s_add_u32 s82, s82, 59648
    v_add_u32 v8, s82, v4
    s_mul_i32 s53, s62, 2
    s_lshr_b32 s54, s61, 1
    s_and_b32 s54, s54, 1
    v_xor_b32 v16, s54, v1
    v_add_u32 v16, s53, v16
    s_and_b32 s55, s61, 1
    s_lshl2_add_u32 s55, s55, s3
    s_lshl_b32 s55, s55, 4
    v_and_or_b32 v16, v16, 15, s55
    s_lshl_b32 s53, s62, 19
    s_add_u32 s53, s53, 0xb00000
    v_lshl_add_u32 v17, v16, 12, s53
    s_lshl_b32 s54, s62, 7
    v_lshl_add_u32 v16, v16, 15, s54
    v_cmp_gt_u32 vcc, 32, v1
    v_lshrrev_b32 v18, 3, v1
    v_and_b32 v19, 7, v1
    v_cndmask_b32 v14, v16, v17, vcc
    v_lshlrev_b32 v18, 12, v18
    v_lshl_add_u32 v9, v19, 4, v18
    s_lshr_b32 s54, s62, 1
    s_add_u32 s53, s55, s54
    v_and_b32 v19, 3, v1
    v_lshl_add_u32 v16, v19, 2, s53
    s_lshl2_add_u32 s56, s62, s3
    s_mul_i32 s55, s56, 3
    s_cmp_ge_u32 s56, 27
    s_subb_u32 s55, s55, s62
    s_cmp_ge_u32 s56, 31
    s_subb_u32 s55, s55, 0
    s_lshl_b32 s69, s55, 5
    s_lshl_b32 s70, s62, 7
    s_and_b32 s53, s61, 3
    s_lshl4_add_u32 s53, s55, s53
    s_lshl_b32 s53, s53, 10
    s_add_u32 s53, s53, 0x1080000
    v_add_u32 v13, s53, v2
    v_bfe_u32 v17, v1, 2, 1
    v_lshl_add_u32 v17, v17, 1, s55
    v_lshrrev_b32 v17, 3, v17
    v_and_b32 v18, 3, v1
    v_lshl_add_u32 v17, v17, 2, v18
    v_add_u32 v17, 172, v17
    v_cmp_gt_u32 vcc, 8, v1
    s_mul_i32 s55, s3, 11
    s_lshr_b32 s55, s55, 2
    v_cndmask_b32 v16, v17, v16, vcc
    v_add_u32 v17, s55, v18
    v_min_u32 v17, 10, v17
    s_add_u32 s54, s54, 128
    v_cmp_gt_u32 vcc, 16, v1
    v_lshl_add_u32 v17, v17, 2, s54
    s_nop 0
    v_cndmask_b32 v16, v17, v16, vcc
    v_cmp_gt_u32 vcc, 32, v1
    v_and_b32 v17, 1, v1
    v_add_u32 v17, 254, v17
    v_cndmask_b32 v16, v17, v16, vcc
    v_lshlrev_b32 v12, 7, v16
    s_add_u32 s45, s66, 2
    v_mov_b32 v107, s66
    v_mov_b32 v106, s45
    s_mov_b64 exec, 1
    s_waitcnt vmcnt(0)
    s_barrier
    buffer_store_dwordx2 v[106:107], v2, s[24:27], s41 offen sc1
    s_mov_b64 exec, -1
    s_cmp_lt_u32 s2, 254
    s_cbranch_scc1 L_tab_skip1
    s_and_b32 s53, s2, 1
    s_lshl_b32 s54, s53, 12
    s_add_u32 s54, s54, 4096
    v_lshl_add_u32 v72, v0, 4, s54
    buffer_load_dwordx4 v[52:55], v72, s[24:27], s4 offen sc1
    buffer_load_dwordx4 v[56:59], v72, s[24:27], s5 offen sc1
    buffer_load_dwordx4 v[60:63], v72, s[24:27], s6 offen sc1
    buffer_load_dwordx4 v[64:67], v72, s[24:27], s7 offen sc1
L_tab_skip1:
    s_add_u32 m0, s52, 68096
    s_and_b32 s58, s58, 0x3fffff
    buffer_load_dwordx4 v110, s[20:23], s58 offen lds
    s_add_u32 m0, s52, 69152
    s_nop 0
    buffer_load_dwordx4 v111, s[20:23], s58 offen lds
    s_add_u32 s58, s58, 0x40000
    s_add_u32 m0, s52, 76544
    s_and_b32 s58, s58, 0x3fffff
    buffer_load_dwordx4 v110, s[20:23], s58 offen lds
    s_add_u32 m0, s52, 77600
    s_nop 0
    buffer_load_dwordx4 v111, s[20:23], s58 offen lds
    s_add_u32 s58, s58, 0x40000
    s_add_u32 m0, s52, 84992
    s_and_b32 s58, s58, 0x3fffff
    buffer_load_dwordx4 v110, s[20:23], s58 offen lds
    s_add_u32 m0, s52, 86048
    s_nop 0
    buffer_load_dwordx4 v111, s[20:23], s58 offen lds
    s_add_u32 s58, s58, 0x40000
    s_add_u32 m0, s52, 93440
    s_and_b32 s58, s58, 0x3fffff
    buffer_load_dwordx4 v110, s[20:23], s58 offen lds
    s_add_u32 m0, s52, 94496
    s_nop 0
    buffer_load_dwordx4 v111, s[20:23], s58 offen lds
    s_add_u32 s58, s58, 0x40000
    s_add_u32 m0, s52, 101888
    s_and_b32 s58, s58, 0x3fffff
    buffer_load_dwordx4 v110, s[20:23], s58 offen lds
    s_add_u32 m0, s52, 102944
    s_nop 0
    buffer_load_dwordx4 v111, s[20:23], s58 offen lds
    s_add_u32 s58, s58, 0x40000
    s_add_u32 m0, s52, 110336
    s_and_b32 s58, s58, 0x3fffff
    buffer_load_dwordx4 v110, s[20:23], s58 offen lds
    s_add_u32 m0, s52, 111392
    s_nop 0
    buffer_load_dwordx4 v111, s[20:23], s58 offen lds
    s_add_u32 s58, s58, 0x40000
    s_cmp_lt_u32 s2, 254
    s_cbranch_scc1 L_tab_skip2
    s_lshr_b32 s54, s3, 1
    s_lshl1_add_u32 s53, s53, s54
    s_cmp_eq_u32 s53, 2
    s_cselect_b32 s57, 1.0, 0
    s_mov_b32 s55, 0x10000000
    s_cmov_b32 s55, 0x52000
    s_cmp_eq_u32 s53, 1
    s_cmov_b32 s55, 0x52400
    s_lshl_b32 s53, s53, 2
    s_lshr_b32 s53, 0x2130, s53
    s_and_b32 s53, s53, 3
    s_lshl_b32 s53, s53, 11
    s_add_u32 s56, s53, 0x52800
    v_and_b32 v76, 127, v0
    v_lshlrev_b32 v73, 4, v76
    v_lshrrev_b32 v76, 3, v76
    v_lshlrev_b32 v76, 6, v76
    v_and_b32 v77, 3, v0
    v_lshl_add_u32 v76, v77, 4, v76
    v_bfe_u32 v77, v0, 2, 1
    v_lshl_add_u32 v74, v77, 3, v76
    s_mov_b32 s49, 0x80000
    s_waitcnt vmcnt(12)
    s_branch L_tab_test
L_tab_again:
    buffer_load_dwordx4 v[52:55], v72, s[24:27], s4 offen sc1
    buffer_load_dwordx4 v[56:59], v72, s[24:27], s5 offen sc1
    buffer_load_dwordx4 v[60:63], v72, s[24:27], s6 offen sc1
    buffer_load_dwordx4 v[64:67], v72, s[24:27], s7 offen sc1
    s_sub_u32 s49, s49, 1
    s_waitcnt vmcnt(0)
    s_cbranch_scc1 L_tab_go
L_tab_test:
    s_and_b32 s45, s66, 0xff
    v_xor_b32 v52, s45, v52
    v_xor_b32 v53, s45, v53
    v_xor_b32 v54, s45, v54
    v_xor_b32 v55, s45, v55
    v_xor_b32 v56, s45, v56
    v_xor_b32 v57, s45, v57
    v_xor_b32 v58, s45, v58
    v_xor_b32 v59, s45, v59
    v_xor_b32 v60, s45, v60
    v_xor_b32 v61, s45, v61
    v_xor_b32 v62, s45, v62
    v_xor_b32 v63, s45, v63
    v_xor_b32 v64, s45, v64
    v_xor_b32 v65, s45, v65
    v_xor_b32 v66, s45, v66
    v_xor_b32 v67, s45, v67
    v_or_b32 v76, v52, v53
    v_or3_b32 v76, v54, v55, v76
    v_or3_b32 v76, v56, v57, v76
    v_or3_b32 v76, v58, v59, v76
    v_or3_b32 v76, v60, v61, v76
    v_or3_b32 v76, v62, v63, v76
    v_or3_b32 v76, v64, v65, v76
    v_or3_b32 v76, v66, v67, v76
    v_and_b32 v76, 0xff, v76
    v_cmp_ne_u32 vcc, 0, v76
    s_cbranch_vccnz L_tab_again
L_tab_go:
    v_pk_add_f32 v[52:53], v[52:53], v[56:57]
    v_pk_add_f32 v[54:55], v[54:55], v[58:59]
    v_pk_add_f32 v[60:61], v[60:61], v[64:65]
    v_pk_add_f32 v[62:63], v[62:63], v[66:67]
    v_pk_add_f32 v[52:53], v[52:53], v[60:61]
    v_pk_add_f32 v[54:55], v[54:55], v[62:63]
    v_cvt_pk_bf16_f32 v56, v52, v53
    v_cvt_pk_bf16_f32 v57, v54, v55
    v_lshlrev_b32 v52, 16, v56
    v_and_b32 v53, 0xffff0000, v56
    v_lshlrev_b32 v54, 16, v57
    v_and_b32 v55, 0xffff0000, v57
    v_add_f32 v52, s57, v52
    v_add_f32 v53, s57, v53
    v_add_f32 v54, s57, v54
    v_add_f32 v55, s57, v55
    v_cvt_pk_bf16_f32 v56, v52, v53
    v_cvt_pk_bf16_f32 v57, v54, v55
    v_lshlrev_b32 v52, 16, v56
    v_and_b32 v53, 0xffff0000, v56
    v_lshlrev_b32 v54, 16, v57
    v_and_b32 v55, 0xffff0000, v57
    buffer_store_dwordx4 v[52:55], v73, s[24:27], s56 offen sc1
    buffer_store_dwordx2 v[56:57], v74, s[24:27], s55 offen sc1
L_tab_skip2:
    s_add_u32 m0, s52, 118784
    s_and_b32 s58, s58, 0x3fffff
    buffer_load_dwordx4 v110, s[20:23], s58 offen lds
    s_add_u32 m0, s52, 119840
    s_nop 0
    buffer_load_dwordx4 v111, s[20:23], s58 offen lds
    s_add_u32 s58, s58, 0x40000
    v_mov_b32 v0, v14
    s_mov_b32 s6, s78
    s_mov_b32 s7, s79
    s_mov_b32 s43, s80
    s_mov_b32 s49, 0x80000
    s_add_u32 s45, s66, 2
    buffer_load_dwordx2 v[18:19], v10, s[24:27], 0 offen sc1
    s_add_u32 m0, s52, 127232
    s_and_b32 s58, s58, 0x3fffff
    buffer_load_dwordx4 v110, s[20:23], s58 offen lds
    s_add_u32 m0, s52, 128288
    s_nop 0
    buffer_load_dwordx4 v111, s[20:23], s58 offen lds
    s_add_u32 s58, s58, 0x40000
    s_add_u32 m0, s52, 135680
    s_and_b32 s58, s58, 0x3fffff
    buffer_load_dwordx4 v110, s[20:23], s58 offen lds
    s_add_u32 m0, s52, 136736
    s_nop 0
    buffer_load_dwordx4 v111, s[20:23], s58 offen lds
    s_add_u32 s58, s58, 0x40000
    s_add_u32 m0, s52, 144128
    s_and_b32 s58, s58, 0x3fffff
    buffer_load_dwordx4 v110, s[20:23], s58 offen lds
    s_add_u32 m0, s52, 145184
    s_nop 0
    buffer_load_dwordx4 v111, s[20:23], s58 offen lds
    s_add_u32 s58, s58, 0x40000
    s_add_u32 m0, s52, 152576
    s_and_b32 s58, s58, 0x3fffff
    buffer_load_dwordx4 v110, s[20:23], s58 offen lds
    s_add_u32 m0, s52, 153632
    s_nop 0
    buffer_load_dwordx4 v111, s[20:23], s58 offen lds
    s_add_u32 s58, s58, 0x40000
    s_load_dwordx2 s[20:21], s[0:1], 32
    s_waitcnt vmcnt(8)
    s_branch L_ptest_6
L_poll_4:
    buffer_load_dwordx2 v[18:19], v10, s[24:27], 0 offen sc1
    s_sub_u32 s49, s49, 1
    s_waitcnt vmcnt(0)
    s_cbranch_scc1 L_polled_5
L_ptest_6:
    v_subrev_u32 v18, s45, v18
    v_lshrrev_b32 v18, 3, v18
    v_bitop3_b32 v18, v19, s66, v18 bitop3:0xbe
    v_cmp_ne_u32 vcc, 0, v18
    s_cbranch_vccnz L_poll_4
L_polled_5:
    buffer_load_dwordx4 a[0:3], v2, s[24:27], s84 offen offset:0 sc1
    buffer_load_dwordx4 a[4:7], v2, s[24:27], s84 offen offset:1024 sc1
    buffer_load_dwordx4 a[8:11], v2, s[24:27], s84 offen offset:2048 sc1
    buffer_load_dwordx4 a[12:15], v2, s[24:27], s84 offen offset:3072 sc1
    buffer_load_dwordx4 a[16:19], v2, s[24:27], s85 offen offset:0 sc1
    buffer_load_dwordx4 a[20:23], v2, s[24:27], s85 offen offset:1024 sc1
    buffer_load_dwordx4 a[24:27], v2, s[24:27], s85 offen offset:2048 sc1
    buffer_load_dwordx4 a[28:31], v2, s[24:27], s85 offen offset:3072 sc1
    s_waitcnt vmcnt(8)
    s_waitcnt lgkmcnt(0)
    s_barrier
    ds_read_b64_tr_b16 a[128:129], v216 offset:0
    ds_read_b64_tr_b16 a[130:131], v216 offset:512
    ds_read_b64_tr_b16 a[132:133], v216 offset:32
    ds_read_b64_tr_b16 a[134:135], v216 offset:544
    ds_read_b64_tr_b16 a[136:137], v216 offset:64
    ds_read_b64_tr_b16 a[138:139], v216 offset:576
    ds_read_b64_tr_b16 a[140:141], v216 offset:96
    ds_read_b64_tr_b16 a[142:143], v216 offset:608
    s_waitcnt vmcnt(7) lgkmcnt(6)
    v_mfma_f32_16x16x32_bf16 v[24:27], a[128:131], a[0:3], 0
    s_waitcnt vmcnt(6)
    ds_read_b64_tr_b16 a[144:145], v216 offset:128
    v_mfma_f32_16x16x32_bf16 v[28:31], a[128:131], a[4:7], 0
    s_waitcnt vmcnt(5)
    ds_read_b64_tr_b16 a[146:147], v216 offset:640
    v_mfma_f32_16x16x32_bf16 v[32:35], a[128:131], a[8:11], 0
    s_waitcnt vmcnt(4)
    ds_read_b64_tr_b16 a[148:149], v216 offset:160
    v_mfma_f32_16x16x32_bf16 v[36:39], a[128:131], a[12:15], 0
    s_waitcnt lgkmcnt(7)
    ds_read_b64_tr_b16 a[150:151], v216 offset:672
    v_mfma_f32_16x16x32_bf16 v[40:43], a[132:135], a[0:3], 0
    ds_read_b64_tr_b16 a[152:153], v216 offset:192
    v_mfma_f32_16x16x32_bf16 v[44:47], a[132:135], a[4:7], 0
    buffer_load_dwordx4 a[32:35], v2, s[24:27], s86 offen offset:0 sc1
    v_mfma_f32_16x16x32_bf16 v[48:51], a[132:135], a[8:11], 0
    ds_read_b64_tr_b16 a[154:155], v216 offset:704
    v_mfma_f32_16x16x32_bf16 v[52:55], a[132:135], a[12:15], 0
    s_waitcnt lgkmcnt(8)
    v_mfma_f32_16x16x32_bf16 v[56:59], a[136:139], a[0:3], 0
    ds_read_b64_tr_b16 a[156:157], v216 offset:224
    v_mfma_f32_16x16x32_bf16 v[60:63], a[136:139], a[4:7], 0
    ds_read_b64_tr_b16 a[158:159], v216 offset:736
    v_mfma_f32_16x16x32_bf16 v[64:67], a[136:139], a[8:11], 0
    buffer_load_dwordx4 a[36:39], v2, s[24:27], s86 offen offset:1024 sc1
    v_mfma_f32_16x16x32_bf16 v[68:71], a[136:139], a[12:15], 0
    s_waitcnt lgkmcnt(8)
    v_mfma_f32_16x16x32_bf16 v[72:75], a[140:143], a[0:3], 0
    ds_read_b64_tr_b16 a[128:129], v217 offset:0
    v_mfma_f32_16x16x32_bf16 v[76:79], a[140:143], a[4:7], 0
    ds_read_b64_tr_b16 a[130:131], v217 offset:512
    v_mfma_f32_16x16x32_bf16 v[80:83], a[140:143], a[8:11], 0
    v_mfma_f32_16x16x32_bf16 v[84:87], a[140:143], a[12:15], 0
    s_waitcnt lgkmcnt(8)
    buffer_load_dwordx4 a[40:43], v2, s[24:27], s86 offen offset:2048 sc1
    v_mfma_f32_16x16x32_bf16 v[88:91], a[144:147], a[0:3], 0
    ds_read_b64_tr_b16 a[132:133], v217 offset:32
    v_mfma_f32_16x16x32_bf16 v[92:95], a[144:147], a[4:7], 0
    ds_read_b64_tr_b16 a[134:135], v217 offset:544
    v_mfma_f32_16x16x32_bf16 v[96:99], a[144:147], a[8:11], 0
    v_mfma_f32_16x16x32_bf16 v[100:103], a[144:147], a[12:15], 0
    s_waitcnt lgkmcnt(8)
    v_mfma_f32_16x16x32_bf16 v[104:107], a[148:151], a[0:3], 0
    buffer_load_dwordx4 a[44:47], v2, s[24:27], s86 offen offset:3072 sc1
    v_mfma_f32_16x16x32_bf16 v[108:111], a[148:151], a[4:7], 0
    ds_read_b64_tr_b16 a[136:137], v217 offset:64
    v_mfma_f32_16x16x32_bf16 v[112:115], a[148:151], a[8:11], 0
    ds_read_b64_tr_b16 a[138:139], v217 offset:576
    v_mfma_f32_16x16x32_bf16 v[116:119], a[148:151], a[12:15], 0
    s_waitcnt lgkmcnt(8)
    v_mfma_f32_16x16x32_bf16 v[120:123], a[152:155], a[0:3], 0
    ds_read_b64_tr_b16 a[140:141], v217 offset:96
    v_mfma_f32_16x16x32_bf16 v[124:127], a[152:155], a[4:7], 0
    buffer_load_dwordx4 a[48:51], v2, s[24:27], s87 offen offset:0 sc1
    v_mfma_f32_16x16x32_bf16 v[128:131], a[152:155], a[8:11], 0
    ds_read_b64_tr_b16 a[142:143], v217 offset:608
    v_mfma_f32_16x16x32_bf16 v[132:135], a[152:155], a[12:15], 0
    s_waitcnt lgkmcnt(8)
    v_mfma_f32_16x16x32_bf16 v[136:139], a[156:159], a[0:3], 0
    ds_read_b64_tr_b16 a[144:145], v217 offset:128
    v_mfma_f32_16x16x32_bf16 v[140:143], a[156:159], a[4:7], 0
    ds_read_b64_tr_b16 a[146:147], v217 offset:640
    v_mfma_f32_16x16x32_bf16 v[144:147], a[156:159], a[8:11], 0
    buffer_load_dwordx4 a[52:55], v2, s[24:27], s87 offen offset:1024 sc1
    v_mfma_f32_16x16x32_bf16 v[148:151], a[156:159], a[12:15], 0
    s_waitcnt vmcnt(9) lgkmcnt(8)
    v_mfma_f32_16x16x32_bf16 v[24:27], a[128:131], a[16:19], v[24:27]
    s_waitcnt vmcnt(8)
    ds_read_b64_tr_b16 a[148:149], v217 offset:160
    v_mfma_f32_16x16x32_bf16 v[28:31], a[128:131], a[20:23], v[28:31]
    s_waitcnt vmcnt(7)
    ds_read_b64_tr_b16 a[150:151], v217 offset:672
    v_mfma_f32_16x16x32_bf16 v[32:35], a[128:131], a[24:27], v[32:35]
    s_waitcnt vmcnt(6)
    v_mfma_f32_16x16x32_bf16 v[36:39], a[128:131], a[28:31], v[36:39]
    s_waitcnt lgkmcnt(8)
    buffer_load_dwordx4 a[56:59], v2, s[24:27], s87 offen offset:2048 sc1
    v_mfma_f32_16x16x32_bf16 v[40:43], a[132:135], a[16:19], v[40:43]
    ds_read_b64_tr_b16 a[152:153], v217 offset:192
    v_mfma_f32_16x16x32_bf16 v[44:47], a[132:135], a[20:23], v[44:47]
    ds_read_b64_tr_b16 a[154:155], v217 offset:704
    v_mfma_f32_16x16x32_bf16 v[48:51], a[132:135], a[24:27], v[48:51]
    v_mfma_f32_16x16x32_bf16 v[52:55], a[132:135], a[28:31], v[52:55]
    s_waitcnt lgkmcnt(8)
    v_mfma_f32_16x16x32_bf16 v[56:59], a[136:139], a[16:19], v[56:59]
    buffer_load_dwordx4 a[60:63], v2, s[24:27], s87 offen offset:3072 sc1
    v_mfma_f32_16x16x32_bf16 v[60:63], a[136:139], a[20:23], v[60:63]
    ds_read_b64_tr_b16 a[156:157], v217 offset:224
    v_mfma_f32_16x16x32_bf16 v[64:67], a[136:139], a[24:27], v[64:67]
    ds_read_b64_tr_b16 a[158:159], v217 offset:736
    v_mfma_f32_16x16x32_bf16 v[68:71], a[136:139], a[28:31], v[68:71]
    s_waitcnt lgkmcnt(8)
    s_lshl2_add_u32 s53, s61, s3
    v_mfma_f32_16x16x32_bf16 v[72:75], a[140:143], a[16:19], v[72:75]
    ds_read_b64_tr_b16 a[128:129], v218 offset:0
    v_mfma_f32_16x16x32_bf16 v[76:79], a[140:143], a[20:23], v[76:79]
    buffer_load_dwordx4 a[64:67], v2, s[24:27], s88 offen offset:0 sc1
    v_mfma_f32_16x16x32_bf16 v[80:83], a[140:143], a[24:27], v[80:83]
    ds_read_b64_tr_b16 a[130:131], v218 offset:512
    v_mfma_f32_16x16x32_bf16 v[84:87], a[140:143], a[28:31], v[84:87]
    s_waitcnt lgkmcnt(8)
    ds_read_b64_tr_b16 a[132:133], v219 offset:0
    v_mfma_f32_16x16x32_bf16 v[88:91], a[144:147], a[16:19], v[88:91]
    ds_read_b64_tr_b16 a[134:135], v219 offset:512
    v_mfma_f32_16x16x32_bf16 v[92:95], a[144:147], a[20:23], v[92:95]
    v_mfma_f32_16x16x32_bf16 v[96:99], a[144:147], a[24:27], v[96:99]
    buffer_load_dwordx4 a[68:71], v2, s[24:27], s88 offen offset:1024 sc1
    v_mfma_f32_16x16x32_bf16 v[100:103], a[144:147], a[28:31], v[100:103]
    s_waitcnt lgkmcnt(8)
    s_lshl_b32 s53, s53, 7
    v_mfma_f32_16x16x32_bf16 v[104:107], a[148:151], a[16:19], v[104:107]
    ds_read_b64_tr_b16 a[136:137], v218 offset:32
    v_mfma_f32_16x16x32_bf16 v[108:111], a[148:151], a[20:23], v[108:111]
    ds_read_b64_tr_b16 a[138:139], v218 offset:544
    v_mfma_f32_16x16x32_bf16 v[112:115], a[148:151], a[24:27], v[112:115]
    ds_read_b64_tr_b16 a[140:141], v219 offset:32
    v_mfma_f32_16x16x32_bf16 v[116:119], a[148:151], a[28:31], v[116:119]
    s_waitcnt lgkmcnt(9)
    buffer_load_dwordx4 a[72:75], v2, s[24:27], s88 offen offset:2048 sc1
    v_mfma_f32_16x16x32_bf16 v[120:123], a[152:155], a[16:19], v[120:123]
    ds_read_b64_tr_b16 a[142:143], v219 offset:544
    v_mfma_f32_16x16x32_bf16 v[124:127], a[152:155], a[20:23], v[124:127]
    s_add_u32 s53, s53, s62
    v_mfma_f32_16x16x32_bf16 v[128:131], a[152:155], a[24:27], v[128:131]
    s_lshl_b32 s53, s53, 7
    v_mfma_f32_16x16x32_bf16 v[132:135], a[152:155], a[28:31], v[132:135]
    s_waitcnt lgkmcnt(8)
    v_mfma_f32_16x16x32_bf16 v[136:139], a[156:159], a[16:19], v[136:139]
    buffer_load_dwordx4 a[76:79], v2, s[24:27], s88 offen offset:3072 sc1
    v_mfma_f32_16x16x32_bf16 v[140:143], a[156:159], a[20:23], v[140:143]
    ds_read_b64_tr_b16 a[144:145], v218 offset:64
    v_mfma_f32_16x16x32_bf16 v[144:147], a[156:159], a[24:27], v[144:147]
    ds_read_b64_tr_b16 a[146:147], v218 offset:576
    v_mfma_f32_16x16x32_bf16 v[148:151], a[156:159], a[28:31], v[148:151]
    s_waitcnt vmcnt(11) lgkmcnt(8)
    ds_read_b64_tr_b16 a[148:149], v219 offset:64
    v_mfma_f32_16x16x32_bf16 v[24:27], a[128:131], a[32:35], v[24:27]
    s_waitcnt vmcnt(7) lgkmcnt(7)
    ds_read_b64_tr_b16 a[150:151], v219 offset:576
    v_mfma_f32_16x16x32_bf16 v[24:27], a[132:135], a[48:51], v[24:27]
    buffer_load_dwordx4 a[80:83], v2, s[24:27], s89 offen offset:0 sc1
    v_mfma_f32_16x16x32_bf16 v[28:31], a[128:131], a[36:39], v[28:31]
    s_waitcnt vmcnt(7)
    v_and_b32 v10, 15, v1
    v_mfma_f32_16x16x32_bf16 v[28:31], a[132:135], a[52:55], v[28:31]
    v_lshl_add_u32 v10, v10, 10, s53
    v_mfma_f32_16x16x32_bf16 v[32:35], a[128:131], a[40:43], v[32:35]
    s_waitcnt vmcnt(6)
    ds_read_b64_tr_b16 a[152:153], v218 offset:96
    v_mfma_f32_16x16x32_bf16 v[32:35], a[132:135], a[56:59], v[32:35]
    ds_read_b64_tr_b16 a[154:155], v218 offset:608
    v_mfma_f32_16x16x32_bf16 v[36:39], a[128:131], a[44:47], v[36:39]
    s_waitcnt vmcnt(5)
    buffer_load_dwordx4 a[84:87], v2, s[24:27], s89 offen offset:1024 sc1
    v_mfma_f32_16x16x32_bf16 v[36:39], a[132:135], a[60:63], v[36:39]
    s_waitcnt lgkmcnt(8)
    ds_read_b64_tr_b16 a[156:157], v219 offset:96
    v_mfma_f32_16x16x32_bf16 v[40:43], a[136:139], a[32:35], v[40:43]
    s_waitcnt lgkmcnt(7)
    ds_read_b64_tr_b16 a[158:159], v219 offset:608
    v_mfma_f32_16x16x32_bf16 v[40:43], a[140:143], a[48:51], v[40:43]
    v_bfe_u32 v16, v1, 4, 1
    v_mfma_f32_16x16x32_bf16 v[44:47], a[136:139], a[36:39], v[44:47]
    v_mfma_f32_16x16x32_bf16 v[44:47], a[140:143], a[52:55], v[44:47]
    buffer_load_dwordx4 a[88:91], v2, s[24:27], s89 offen offset:2048 sc1
    v_mfma_f32_16x16x32_bf16 v[48:51], a[136:139], a[40:43], v[48:51]
    ds_read_b64_tr_b16 a[128:129], v218 offset:128
    v_mfma_f32_16x16x32_bf16 v[48:51], a[140:143], a[56:59], v[48:51]
    ds_read_b64_tr_b16 a[130:131], v218 offset:640
    v_mfma_f32_16x16x32_bf16 v[52:55], a[136:139], a[44:47], v[52:55]
    ds_read_b64_tr_b16 a[132:133], v219 offset:128
    v_mfma_f32_16x16x32_bf16 v[52:55], a[140:143], a[60:63], v[52:55]
    s_waitcnt lgkmcnt(9)
    ds_read_b64_tr_b16 a[134:135], v219 offset:640
    v_mfma_f32_16x16x32_bf16 v[56:59], a[144:147], a[32:35], v[56:59]
    s_waitcnt lgkmcnt(8)
    buffer_load_dwordx4 a[92:95], v2, s[24:27], s89 offen offset:3072 sc1
    v_mfma_f32_16x16x32_bf16 v[56:59], a[148:151], a[48:51], v[56:59]
    v_lshl_add_u32 v10, v16, 5, v10
    v_mfma_f32_16x16x32_bf16 v[60:63], a[144:147], a[36:39], v[60:63]
    v_lshrrev_b32 v16, 5, v1
    v_mfma_f32_16x16x32_bf16 v[60:63], a[148:151], a[52:55], v[60:63]
    v_lshl_add_u32 v10, v16, 4, v10
    v_mfma_f32_16x16x32_bf16 v[64:67], a[144:147], a[40:43], v[64:67]
    ds_read_b64_tr_b16 a[136:137], v218 offset:160
    v_mfma_f32_16x16x32_bf16 v[64:67], a[148:151], a[56:59], v[64:67]
    buffer_load_dwordx4 a[96:99], v2, s[24:27], s90 offen offset:0 sc1
    v_mfma_f32_16x16x32_bf16 v[68:71], a[144:147], a[44:47], v[68:71]
    ds_read_b64_tr_b16 a[138:139], v218 offset:672
    v_mfma_f32_16x16x32_bf16 v[68:71], a[148:151], a[60:63], v[68:71]
    s_waitcnt lgkmcnt(8)
    ds_read_b64_tr_b16 a[140:141], v219 offset:160
    v_mfma_f32_16x16x32_bf16 v[72:75], a[152:155], a[32:35], v[72:75]
    s_waitcnt lgkmcnt(7)
    ds_read_b64_tr_b16 a[142:143], v219 offset:672
    v_mfma_f32_16x16x32_bf16 v[72:75], a[156:159], a[48:51], v[72:75]
    v_mfma_f32_16x16x32_bf16 v[76:79], a[152:155], a[36:39], v[76:79]
    buffer_load_dwordx4 a[100:103], v2, s[24:27], s90 offen offset:1024 sc1
    v_mfma_f32_16x16x32_bf16 v[76:79], a[156:159], a[52:55], v[76:79]
    v_mfma_f32_16x16x32_bf16 v[80:83], a[152:155], a[40:43], v[80:83]
    ds_read_b64_tr_b16 a[144:145], v218 offset:192
    v_mfma_f32_16x16x32_bf16 v[80:83], a[156:159], a[56:59], v[80:83]
    ds_read_b64_tr_b16 a[146:147], v218 offset:704
    v_mfma_f32_16x16x32_bf16 v[84:87], a[152:155], a[44:47], v[84:87]
    ds_read_b64_tr_b16 a[148:149], v219 offset:192
    v_mfma_f32_16x16x32_bf16 v[84:87], a[156:159], a[60:63], v[84:87]
    s_waitcnt lgkmcnt(9)
    buffer_load_dwordx4 a[104:107], v2, s[24:27], s90 offen offset:2048 sc1
    v_mfma_f32_16x16x32_bf16 v[88:91], a[128:131], a[32:35], v[88:91]
    s_waitcnt lgkmcnt(7)
    ds_read_b64_tr_b16 a[150:151], v219 offset:704
    v_mfma_f32_16x16x32_bf16 v[88:91], a[132:135], a[48:51], v[88:91]
    v_mfma_f32_16x16x32_bf16 v[92:95], a[128:131], a[36:39], v[92:95]
    v_mfma_f32_16x16x32_bf16 v[92:95], a[132:135], a[52:55], v[92:95]
    v_mfma_f32_16x16x32_bf16 v[96:99], a[128:131], a[40:43], v[96:99]
    buffer_load_dwordx4 a[108:111], v2, s[24:27], s90 offen offset:3072 sc1
    v_mfma_f32_16x16x32_bf16 v[96:99], a[132:135], a[56:59], v[96:99]
    ds_read_b64_tr_b16 a[152:153], v218 offset:224
    v_mfma_f32_16x16x32_bf16 v[100:103], a[128:131], a[44:47], v[100:103]
    ds_read_b64_tr_b16 a[154:155], v218 offset:736
    v_mfma_f32_16x16x32_bf16 v[100:103], a[132:135], a[60:63], v[100:103]
    s_waitcnt lgkmcnt(8)
    ds_read_b64_tr_b16 a[156:157], v219 offset:224
    v_mfma_f32_16x16x32_bf16 v[104:107], a[136:139], a[32:35], v[104:107]
    s_waitcnt lgkmcnt(7)
    ds_read_b64_tr_b16 a[158:159], v219 offset:736
    v_mfma_f32_16x16x32_bf16 v[104:107], a[140:143], a[48:51], v[104:107]
    buffer_load_dwordx4 a[112:115], v2, s[24:27], s91 offen offset:0 sc1
    v_mfma_f32_16x16x32_bf16 v[108:111], a[136:139], a[36:39], v[108:111]
    v_mfma_f32_16x16x32_bf16 v[108:111], a[140:143], a[52:55], v[108:111]
    v_mfma_f32_16x16x32_bf16 v[112:115], a[136:139], a[40:43], v[112:115]
    ds_read_b64_tr_b16 a[128:129], v220 offset:0
    v_mfma_f32_16x16x32_bf16 v[112:115], a[140:143], a[56:59], v[112:115]
    ds_read_b64_tr_b16 a[130:131], v220 offset:512
    v_mfma_f32_16x16x32_bf16 v[116:119], a[136:139], a[44:47], v[116:119]
    buffer_load_dwordx4 a[116:119], v2, s[24:27], s91 offen offset:1024 sc1
    v_mfma_f32_16x16x32_bf16 v[116:119], a[140:143], a[60:63], v[116:119]
    s_waitcnt lgkmcnt(8)
    ds_read_b64_tr_b16 a[132:133], v221 offset:0
    v_mfma_f32_16x16x32_bf16 v[120:123], a[144:147], a[32:35], v[120:123]
    s_waitcnt lgkmcnt(7)
    ds_read_b64_tr_b16 a[134:135], v221 offset:512
    v_mfma_f32_16x16x32_bf16 v[120:123], a[148:151], a[48:51], v[120:123]
    v_mfma_f32_16x16x32_bf16 v[124:127], a[144:147], a[36:39], v[124:127]
    v_mfma_f32_16x16x32_bf16 v[124:127], a[148:151], a[52:55], v[124:127]
    buffer_load_dwordx4 a[120:123], v2, s[24:27], s91 offen offset:2048 sc1
    v_mfma_f32_16x16x32_bf16 v[128:131], a[144:147], a[40:43], v[128:131]
    ds_read_b64_tr_b16 a[136:137], v220 offset:32
    v_mfma_f32_16x16x32_bf16 v[128:131], a[148:151], a[56:59], v[128:131]
    ds_read_b64_tr_b16 a[138:139], v220 offset:544
    v_mfma_f32_16x16x32_bf16 v[132:135], a[144:147], a[44:47], v[132:135]
    ds_read_b64_tr_b16 a[140:141], v221 offset:32
    v_mfma_f32_16x16x32_bf16 v[132:135], a[148:151], a[60:63], v[132:135]
    s_waitcnt lgkmcnt(9)
    ds_read_b64_tr_b16 a[142:143], v221 offset:544
    v_mfma_f32_16x16x32_bf16 v[136:139], a[152:155], a[32:35], v[136:139]
    s_waitcnt lgkmcnt(8)
    buffer_load_dwordx4 a[124:127], v2, s[24:27], s91 offen offset:3072 sc1
    v_mfma_f32_16x16x32_bf16 v[136:139], a[156:159], a[48:51], v[136:139]
    v_and_b32 v17, 3, v1
    v_mfma_f32_16x16x32_bf16 v[140:143], a[152:155], a[36:39], v[140:143]
    v_cmp_eq_u32 vcc, 0, v17
    v_mfma_f32_16x16x32_bf16 v[140:143], a[156:159], a[52:55], v[140:143]
    v_mov_b32 v17, 0x3f803f80
    v_mfma_f32_16x16x32_bf16 v[144:147], a[152:155], a[40:43], v[144:147]
    ds_read_b64_tr_b16 a[144:145], v220 offset:64
    v_mfma_f32_16x16x32_bf16 v[144:147], a[156:159], a[56:59], v[144:147]
    buffer_load_dwordx4 a[0:3], v2, s[24:27], s92 offen offset:0 sc1
    v_mfma_f32_16x16x32_bf16 v[148:151], a[152:155], a[44:47], v[148:151]
    ds_read_b64_tr_b16 a[146:147], v220 offset:576
    v_mfma_f32_16x16x32_bf16 v[148:151], a[156:159], a[60:63], v[148:151]
    s_waitcnt vmcnt(16) lgkmcnt(8)
    ds_read_b64_tr_b16 a[148:149], v221 offset:64
    v_mfma_f32_16x16x32_bf16 v[24:27], a[128:131], a[64:67], v[24:27]
    s_waitcnt vmcnt(12) lgkmcnt(7)
    ds_read_b64_tr_b16 a[150:151], v221 offset:576
    v_mfma_f32_16x16x32_bf16 v[24:27], a[132:135], a[80:83], v[24:27]
    v_mfma_f32_16x16x32_bf16 v[28:31], a[128:131], a[68:71], v[28:31]
    s_waitcnt vmcnt(11)
    buffer_load_dwordx4 a[4:7], v2, s[24:27], s92 offen offset:1024 sc1
    v_mfma_f32_16x16x32_bf16 v[28:31], a[132:135], a[84:87], v[28:31]
    v_cndmask_b32 v17, 0, v17, vcc
    v_mfma_f32_16x16x32_bf16 v[32:35], a[128:131], a[72:75], v[32:35]
    s_waitcnt vmcnt(11)
    ds_read_b64_tr_b16 a[152:153], v220 offset:96
    v_mfma_f32_16x16x32_bf16 v[32:35], a[132:135], a[88:91], v[32:35]
    ds_read_b64_tr_b16 a[154:155], v220 offset:608
    v_mfma_f32_16x16x32_bf16 v[36:39], a[128:131], a[76:79], v[36:39]
    s_waitcnt vmcnt(10)
    ds_read_b64_tr_b16 a[156:157], v221 offset:96
    v_mfma_f32_16x16x32_bf16 v[36:39], a[132:135], a[92:95], v[36:39]
    s_waitcnt lgkmcnt(9)
    buffer_load_dwordx4 a[8:11], v2, s[24:27], s92 offen offset:2048 sc1
    v_mfma_f32_16x16x32_bf16 v[40:43], a[136:139], a[64:67], v[40:43]
    s_waitcnt lgkmcnt(7)
    ds_read_b64_tr_b16 a[158:159], v221 offset:608
    v_mfma_f32_16x16x32_bf16 v[40:43], a[140:143], a[80:83], v[40:43]
    v_accvgpr_write_b32 a176, v17
    v_mfma_f32_16x16x32_bf16 v[44:47], a[136:139], a[68:71], v[44:47]
    v_accvgpr_write_b32 a177, v17
    v_mfma_f32_16x16x32_bf16 v[44:47], a[140:143], a[84:87], v[44:47]
    v_mfma_f32_16x16x32_bf16 v[48:51], a[136:139], a[72:75], v[48:51]
    buffer_load_dwordx4 a[12:15], v2, s[24:27], s92 offen offset:3072 sc1
    v_mfma_f32_16x16x32_bf16 v[48:51], a[140:143], a[88:91], v[48:51]
    ds_read_b64_tr_b16 a[128:129], v220 offset:128
    v_mfma_f32_16x16x32_bf16 v[52:55], a[136:139], a[76:79], v[52:55]
    ds_read_b64_tr_b16 a[130:131], v220 offset:640
    v_mfma_f32_16x16x32_bf16 v[52:55], a[140:143], a[92:95], v[52:55]
    s_waitcnt lgkmcnt(8)
    ds_read_b64_tr_b16 a[132:133], v221 offset:128
    v_mfma_f32_16x16x32_bf16 v[56:59], a[144:147], a[64:67], v[56:59]
    s_waitcnt lgkmcnt(7)
    ds_read_b64_tr_b16 a[134:135], v221 offset:640
    v_mfma_f32_16x16x32_bf16 v[56:59], a[148:151], a[80:83], v[56:59]
    buffer_load_dwordx4 a[16:19], v2, s[24:27], s93 offen offset:0 sc1
    v_mfma_f32_16x16x32_bf16 v[60:63], a[144:147], a[68:71], v[60:63]
    v_accvgpr_write_b32 a178, v17
    v_mfma_f32_16x16x32_bf16 v[60:63], a[148:151], a[84:87], v[60:63]
    v_accvgpr_write_b32 a179, v17
    v_mfma_f32_16x16x32_bf16 v[64:67], a[144:147], a[72:75], v[64:67]
    ds_read_b64_tr_b16 a[136:137], v220 offset:160
    v_mfma_f32_16x16x32_bf16 v[64:67], a[148:151], a[88:91], v[64:67]
    ds_read_b64_tr_b16 a[138:139], v220 offset:672
    v_mfma_f32_16x16x32_bf16 v[68:71], a[144:147], a[76:79], v[68:71]
    buffer_load_dwordx4 a[20:23], v2, s[24:27], s93 offen offset:1024 sc1
    v_mfma_f32_16x16x32_bf16 v[68:71], a[148:151], a[92:95], v[68:71]
    s_waitcnt lgkmcnt(8)
    ds_read_b64_tr_b16 a[140:141], v221 offset:160
    v_mfma_f32_16x16x32_bf16 v[72:75], a[152:155], a[64:67], v[72:75]
    s_waitcnt lgkmcnt(7)
    ds_read_b64_tr_b16 a[142:143], v221 offset:672
    v_mfma_f32_16x16x32_bf16 v[72:75], a[156:159], a[80:83], v[72:75]
    v_readlane_b32 s67, v0, 42
    v_mfma_f32_16x16x32_bf16 v[76:79], a[152:155], a[68:71], v[76:79]
    v_mfma_f32_16x16x32_bf16 v[76:79], a[156:159], a[84:87], v[76:79]
    buffer_load_dwordx4 a[24:27], v2, s[24:27], s93 offen offset:2048 sc1
    v_mfma_f32_16x16x32_bf16 v[80:83], a[152:155], a[72:75], v[80:83]
    ds_read_b64_tr_b16 a[144:145], v220 offset:192
    v_mfma_f32_16x16x32_bf16 v[80:83], a[156:159], a[88:91], v[80:83]
    ds_read_b64_tr_b16 a[146:147], v220 offset:704
    v_mfma_f32_16x16x32_bf16 v[84:87], a[152:155], a[76:79], v[84:87]
    ds_read_b64_tr_b16 a[148:149], v221 offset:192
    v_mfma_f32_16x16x32_bf16 v[84:87], a[156:159], a[92:95], v[84:87]
    s_waitcnt lgkmcnt(9)
    ds_read_b64_tr_b16 a[150:151], v221 offset:704
    v_mfma_f32_16x16x32_bf16 v[88:91], a[128:131], a[64:67], v[88:91]
    s_waitcnt lgkmcnt(8)
    buffer_load_dwordx4 a[28:31], v2, s[24:27], s93 offen offset:3072 sc1
    v_mfma_f32_16x16x32_bf16 v[88:91], a[132:135], a[80:83], v[88:91]
    v_readlane_b32 s5, v0, 43
    v_mfma_f32_16x16x32_bf16 v[92:95], a[128:131], a[68:71], v[92:95]
    v_readlane_b32 s57, v0, 44
    v_mfma_f32_16x16x32_bf16 v[92:95], a[132:135], a[84:87], v[92:95]
    v_readlane_b32 s58, v0, 45
    v_mfma_f32_16x16x32_bf16 v[96:99], a[128:131], a[72:75], v[96:99]
    ds_read_b64_tr_b16 a[152:153], v220 offset:224
    v_mfma_f32_16x16x32_bf16 v[96:99], a[132:135], a[88:91], v[96:99]
    buffer_load_dwordx4 a[32:35], v2, s[24:27], s94 offen offset:0 sc1
    v_mfma_f32_16x16x32_bf16 v[100:103], a[128:131], a[76:79], v[100:103]
    ds_read_b64_tr_b16 a[154:155], v220 offset:736
    v_mfma_f32_16x16x32_bf16 v[100:103], a[132:135], a[92:95], v[100:103]
    s_waitcnt lgkmcnt(8)
    ds_read_b64_tr_b16 a[156:157], v221 offset:224
    v_mfma_f32_16x16x32_bf16 v[104:107], a[136:139], a[64:67], v[104:107]
    s_waitcnt lgkmcnt(7)
    ds_read_b64_tr_b16 a[158:159], v221 offset:736
    v_mfma_f32_16x16x32_bf16 v[104:107], a[140:143], a[80:83], v[104:107]
    v_mfma_f32_16x16x32_bf16 v[108:111], a[136:139], a[68:71], v[108:111]
    buffer_load_dwordx4 a[36:39], v2, s[24:27], s94 offen offset:1024 sc1
    v_mfma_f32_16x16x32_bf16 v[108:111], a[140:143], a[84:87], v[108:111]
    v_readlane_b32 s63, v0, 46
    v_mfma_f32_16x16x32_bf16 v[112:115], a[136:139], a[72:75], v[112:115]
    ds_read_b64_tr_b16 a[128:129], v222 offset:0
    v_mfma_f32_16x16x32_bf16 v[112:115], a[140:143], a[88:91], v[112:115]
    ds_read_b64_tr_b16 a[130:131], v222 offset:512
    v_mfma_f32_16x16x32_bf16 v[116:119], a[136:139], a[76:79], v[116:119]
    ds_read_b64_tr_b16 a[132:133], v223 offset:0
    v_mfma_f32_16x16x32_bf16 v[116:119], a[140:143], a[92:95], v[116:119]
    s_waitcnt lgkmcnt(9)
    buffer_load_dwordx4 a[40:43], v2, s[24:27], s94 offen offset:2048 sc1
    v_mfma_f32_16x16x32_bf16 v[120:123], a[144:147], a[64:67], v[120:123]
    s_waitcnt lgkmcnt(7)
    ds_read_b64_tr_b16 a[134:135], v223 offset:512
    v_mfma_f32_16x16x32_bf16 v[120:123], a[148:151], a[80:83], v[120:123]
    v_readlane_b32 s49, v0, 47
    v_mfma_f32_16x16x32_bf16 v[124:127], a[144:147], a[68:71], v[124:127]
    s_mul_i32 s4, s3, 25312
    v_mfma_f32_16x16x32_bf16 v[124:127], a[148:151], a[84:87], v[124:127]
    v_mfma_f32_16x16x32_bf16 v[128:131], a[144:147], a[72:75], v[128:131]
    buffer_load_dwordx4 a[44:47], v2, s[24:27], s94 offen offset:3072 sc1
    v_mfma_f32_16x16x32_bf16 v[128:131], a[148:151], a[88:91], v[128:131]
    ds_read_b64_tr_b16 a[136:137], v222 offset:32
    v_mfma_f32_16x16x32_bf16 v[132:135], a[144:147], a[76:79], v[132:135]
    ds_read_b64_tr_b16 a[138:139], v222 offset:544
    v_mfma_f32_16x16x32_bf16 v[132:135], a[148:151], a[92:95], v[132:135]
    s_waitcnt lgkmcnt(8)
    ds_read_b64_tr_b16 a[140:141], v223 offset:32
    v_mfma_f32_16x16x32_bf16 v[136:139], a[152:155], a[64:67], v[136:139]
    s_waitcnt lgkmcnt(7)
    ds_read_b64_tr_b16 a[142:143], v223 offset:544
    v_mfma_f32_16x16x32_bf16 v[136:139], a[156:159], a[80:83], v[136:139]
    buffer_load_dwordx4 a[48:51], v2, s[24:27], s95 offen offset:0 sc1
    v_mfma_f32_16x16x32_bf16 v[140:143], a[152:155], a[68:71], v[140:143]
    s_add_u32 s45, s66, 3
    v_mfma_f32_16x16x32_bf16 v[140:143], a[156:159], a[84:87], v[140:143]
    v_mov_b32 v15, s66
    v_mfma_f32_16x16x32_bf16 v[144:147], a[152:155], a[72:75], v[144:147]
    ds_read_b64_tr_b16 a[144:145], v222 offset:64
    v_mfma_f32_16x16x32_bf16 v[144:147], a[156:159], a[88:91], v[144:147]
    ds_read_b64_tr_b16 a[146:147], v222 offset:576
    v_mfma_f32_16x16x32_bf16 v[148:151], a[152:155], a[76:79], v[148:151]
    buffer_load_dwordx4 a[52:55], v2, s[24:27], s95 offen offset:1024 sc1
    v_mfma_f32_16x16x32_bf16 v[148:151], a[156:159], a[92:95], v[148:151]
    s_waitcnt vmcnt(21) lgkmcnt(8)
    ds_read_b64_tr_b16 a[148:149], v223 offset:64
    v_mfma_f32_16x16x32_bf16 v[24:27], a[128:131], a[96:99], v[24:27]
    s_waitcnt vmcnt(17) lgkmcnt(7)
    ds_read_b64_tr_b16 a[150:151], v223 offset:576
    v_mfma_f32_16x16x32_bf16 v[24:27], a[132:135], a[112:115], v[24:27]
    v_mov_b32 v14, s45
    v_mfma_f32_16x16x32_bf16 v[28:31], a[128:131], a[100:103], v[28:31]
    s_waitcnt vmcnt(16)
    v_mfma_f32_16x16x32_bf16 v[28:31], a[132:135], a[116:119], v[28:31]
    buffer_load_dwordx4 a[56:59], v2, s[24:27], s95 offen offset:2048 sc1
    v_mfma_f32_16x16x32_bf16 v[32:35], a[128:131], a[104:107], v[32:35]
    s_waitcnt vmcnt(16)
    ds_read_b64_tr_b16 a[152:153], v222 offset:96
    v_mfma_f32_16x16x32_bf16 v[32:35], a[132:135], a[120:123], v[32:35]
    ds_read_b64_tr_b16 a[154:155], v222 offset:608
    v_mfma_f32_16x16x32_bf16 v[36:39], a[128:131], a[108:111], v[36:39]
    s_waitcnt vmcnt(15)
    ds_read_b64_tr_b16 a[156:157], v223 offset:96
    v_mfma_f32_16x16x32_bf16 v[36:39], a[132:135], a[124:127], v[36:39]
    s_waitcnt lgkmcnt(9)
    ds_read_b64_tr_b16 a[158:159], v223 offset:608
    v_mfma_f32_16x16x32_bf16 v[40:43], a[136:139], a[96:99], v[40:43]
    s_waitcnt lgkmcnt(8)
    buffer_load_dwordx4 a[60:63], v2, s[24:27], s95 offen offset:3072 sc1
    v_mfma_f32_16x16x32_bf16 v[40:43], a[140:143], a[112:115], v[40:43]
    v_mfma_f32_16x16x32_bf16 v[44:47], a[136:139], a[100:103], v[44:47]
    v_mfma_f32_16x16x32_bf16 v[44:47], a[140:143], a[116:119], v[44:47]
    v_mfma_f32_16x16x32_bf16 v[48:51], a[136:139], a[104:107], v[48:51]
    ds_read_b64_tr_b16 a[128:129], v222 offset:128
    v_mfma_f32_16x16x32_bf16 v[48:51], a[140:143], a[120:123], v[48:51]
    buffer_load_dwordx4 a[64:67], v2, s[24:27], s96 offen offset:0 sc1
    v_mfma_f32_16x16x32_bf16 v[52:55], a[136:139], a[108:111], v[52:55]
    ds_read_b64_tr_b16 a[130:131], v222 offset:640
    v_mfma_f32_16x16x32_bf16 v[52:55], a[140:143], a[124:127], v[52:55]
    s_waitcnt lgkmcnt(8)
    ds_read_b64_tr_b16 a[132:133], v223 offset:128
    v_mfma_f32_16x16x32_bf16 v[56:59], a[144:147], a[96:99], v[56:59]
    s_waitcnt lgkmcnt(7)
    ds_read_b64_tr_b16 a[134:135], v223 offset:640
    v_mfma_f32_16x16x32_bf16 v[56:59], a[148:151], a[112:115], v[56:59]
    v_mfma_f32_16x16x32_bf16 v[60:63], a[144:147], a[100:103], v[60:63]
    buffer_load_dwordx4 a[68:71], v2, s[24:27], s96 offen offset:1024 sc1
    v_mfma_f32_16x16x32_bf16 v[60:63], a[148:151], a[116:119], v[60:63]
    v_mfma_f32_16x16x32_bf16 v[64:67], a[144:147], a[104:107], v[64:67]
    ds_read_b64_tr_b16 a[136:137], v222 offset:160
    v_mfma_f32_16x16x32_bf16 v[64:67], a[148:151], a[120:123], v[64:67]
    ds_read_b64_tr_b16 a[138:139], v222 offset:672
    v_mfma_f32_16x16x32_bf16 v[68:71], a[144:147], a[108:111], v[68:71]
    ds_read_b64_tr_b16 a[140:141], v223 offset:160
    v_mfma_f32_16x16x32_bf16 v[68:71], a[148:151], a[124:127], v[68:71]
    s_waitcnt lgkmcnt(9)
    buffer_load_dwordx4 a[72:75], v2, s[24:27], s96 offen offset:2048 sc1
    v_mfma_f32_16x16x32_bf16 v[72:75], a[152:155], a[96:99], v[72:75]
    s_waitcnt lgkmcnt(7)
    ds_read_b64_tr_b16 a[142:143], v223 offset:672
    v_mfma_f32_16x16x32_bf16 v[72:75], a[156:159], a[112:115], v[72:75]
    v_mfma_f32_16x16x32_bf16 v[76:79], a[152:155], a[100:103], v[76:79]
    v_mfma_f32_16x16x32_bf16 v[76:79], a[156:159], a[116:119], v[76:79]
    v_mfma_f32_16x16x32_bf16 v[80:83], a[152:155], a[104:107], v[80:83]
    buffer_load_dwordx4 a[76:79], v2, s[24:27], s96 offen offset:3072 sc1
    v_mfma_f32_16x16x32_bf16 v[80:83], a[156:159], a[120:123], v[80:83]
    ds_read_b64_tr_b16 a[144:145], v222 offset:192
    v_mfma_f32_16x16x32_bf16 v[84:87], a[152:155], a[108:111], v[84:87]
    ds_read_b64_tr_b16 a[146:147], v222 offset:704
    v_mfma_f32_16x16x32_bf16 v[84:87], a[156:159], a[124:127], v[84:87]
    s_waitcnt lgkmcnt(8)
    ds_read_b64_tr_b16 a[148:149], v223 offset:192
    v_mfma_f32_16x16x32_bf16 v[88:91], a[128:131], a[96:99], v[88:91]
    s_waitcnt lgkmcnt(7)
    ds_read_b64_tr_b16 a[150:151], v223 offset:704
    v_mfma_f32_16x16x32_bf16 v[88:91], a[132:135], a[112:115], v[88:91]
    buffer_load_dwordx4 a[80:83], v2, s[24:27], s97 offen offset:0 sc1
    v_mfma_f32_16x16x32_bf16 v[92:95], a[128:131], a[100:103], v[92:95]
    v_mfma_f32_16x16x32_bf16 v[92:95], a[132:135], a[116:119], v[92:95]
    v_mfma_f32_16x16x32_bf16 v[96:99], a[128:131], a[104:107], v[96:99]
    ds_read_b64_tr_b16 a[152:153], v222 offset:224
    v_mfma_f32_16x16x32_bf16 v[96:99], a[132:135], a[120:123], v[96:99]
    ds_read_b64_tr_b16 a[154:155], v222 offset:736
    v_mfma_f32_16x16x32_bf16 v[100:103], a[128:131], a[108:111], v[100:103]
    buffer_load_dwordx4 a[84:87], v2, s[24:27], s97 offen offset:1024 sc1
    v_mfma_f32_16x16x32_bf16 v[100:103], a[132:135], a[124:127], v[100:103]
    s_waitcnt lgkmcnt(8)
    ds_read_b64_tr_b16 a[156:157], v223 offset:224
    v_mfma_f32_16x16x32_bf16 v[104:107], a[136:139], a[96:99], v[104:107]
    s_waitcnt lgkmcnt(7)
    ds_read_b64_tr_b16 a[158:159], v223 offset:736
    v_mfma_f32_16x16x32_bf16 v[104:107], a[140:143], a[112:115], v[104:107]
    v_mfma_f32_16x16x32_bf16 v[108:111], a[136:139], a[100:103], v[108:111]
    v_mfma_f32_16x16x32_bf16 v[108:111], a[140:143], a[116:119], v[108:111]
    buffer_load_dwordx4 a[88:91], v2, s[24:27], s97 offen offset:2048 sc1
    v_mfma_f32_16x16x32_bf16 v[112:115], a[136:139], a[104:107], v[112:115]
    ds_read_b64_tr_b16 a[128:129], v224 offset:0
    v_mfma_f32_16x16x32_bf16 v[112:115], a[140:143], a[120:123], v[112:115]
    ds_read_b64_tr_b16 a[130:131], v224 offset:512
    v_mfma_f32_16x16x32_bf16 v[116:119], a[136:139], a[108:111], v[116:119]
    ds_read_b64_tr_b16 a[132:133], v225 offset:0
    v_mfma_f32_16x16x32_bf16 v[116:119], a[140:143], a[124:127], v[116:119]
    s_waitcnt lgkmcnt(9)
    ds_read_b64_tr_b16 a[134:135], v225 offset:512
    v_mfma_f32_16x16x32_bf16 v[120:123], a[144:147], a[96:99], v[120:123]
    s_waitcnt lgkmcnt(8)
    buffer_load_dwordx4 a[92:95], v2, s[24:27], s97 offen offset:3072 sc1
    v_mfma_f32_16x16x32_bf16 v[120:123], a[148:151], a[112:115], v[120:123]
    ds_read_b64_tr_b16 a[136:137], v226 offset:0
    v_mfma_f32_16x16x32_bf16 v[124:127], a[144:147], a[100:103], v[124:127]
    ds_read_b64_tr_b16 a[138:139], v226 offset:512
    v_mfma_f32_16x16x32_bf16 v[124:127], a[148:151], a[116:119], v[124:127]
    ds_read_b64_tr_b16 a[140:141], v227 offset:0
    v_mfma_f32_16x16x32_bf16 v[128:131], a[144:147], a[104:107], v[128:131]
    ds_read_b64_tr_b16 a[142:143], v227 offset:512
    v_mfma_f32_16x16x32_bf16 v[128:131], a[148:151], a[120:123], v[128:131]
    v_mfma_f32_16x16x32_bf16 v[132:135], a[144:147], a[108:111], v[132:135]
    v_mfma_f32_16x16x32_bf16 v[132:135], a[148:151], a[124:127], v[132:135]
    s_waitcnt lgkmcnt(10)
    v_mfma_f32_16x16x32_bf16 v[136:139], a[152:155], a[96:99], v[136:139]
    s_waitcnt lgkmcnt(8)
    buffer_load_dwordx4 a[96:99], v2, s[24:27], s98 offen offset:0 sc1
    v_mfma_f32_16x16x32_bf16 v[136:139], a[156:159], a[112:115], v[136:139]
    v_mfma_f32_16x16x32_bf16 v[140:143], a[152:155], a[100:103], v[140:143]
    buffer_load_dwordx4 a[100:103], v2, s[24:27], s98 offen offset:1024 sc1
    v_mfma_f32_16x16x32_bf16 v[140:143], a[156:159], a[116:119], v[140:143]
    v_mfma_f32_16x16x32_bf16 v[144:147], a[152:155], a[104:107], v[144:147]
    ds_read_b64_tr_b16 a[144:145], v224 offset:32
    v_mfma_f32_16x16x32_bf16 v[144:147], a[156:159], a[120:123], v[144:147]
    ds_read_b64_tr_b16 a[146:147], v224 offset:544
    v_mfma_f32_16x16x32_bf16 v[148:151], a[152:155], a[108:111], v[148:151]
    ds_read_b64_tr_b16 a[148:149], v225 offset:32
    v_mfma_f32_16x16x32_bf16 v[148:151], a[156:159], a[124:127], v[148:151]
    s_waitcnt vmcnt(25) lgkmcnt(9)
    buffer_load_dwordx4 a[104:107], v2, s[24:27], s98 offen offset:2048 sc1
    v_mfma_f32_16x16x32_bf16 v[24:27], a[128:131], a[0:3], v[24:27]
    s_waitcnt vmcnt(22) lgkmcnt(7)
    ds_read_b64_tr_b16 a[150:151], v225 offset:544
    v_mfma_f32_16x16x32_bf16 v[24:27], a[132:135], a[16:19], v[24:27]
    s_waitcnt vmcnt(18) lgkmcnt(6)
    ds_read_b64_tr_b16 a[152:153], v226 offset:32
    v_mfma_f32_16x16x32_bf16 v[24:27], a[136:139], a[32:35], v[24:27]
    s_waitcnt vmcnt(14) lgkmcnt(5)
    ds_read_b64_tr_b16 a[154:155], v226 offset:544
    v_mfma_f32_16x16x32_bf16 v[24:27], a[140:143], a[48:51], v[24:27]
    ds_read_b64_tr_b16 a[156:157], v227 offset:32
    v_mfma_f32_16x16x32_bf16 v[28:31], a[128:131], a[4:7], v[28:31]
    buffer_load_dwordx4 a[108:111], v2, s[24:27], s98 offen offset:3072 sc1
    v_mfma_f32_16x16x32_bf16 v[28:31], a[132:135], a[20:23], v[28:31]
    ds_read_b64_tr_b16 a[158:159], v227 offset:544
    v_mfma_f32_16x16x32_bf16 v[28:31], a[136:139], a[36:39], v[28:31]
    s_waitcnt vmcnt(14)
    v_mfma_f32_16x16x32_bf16 v[28:31], a[140:143], a[52:55], v[28:31]
    v_mfma_f32_16x16x32_bf16 v[32:35], a[128:131], a[8:11], v[32:35]
    v_mfma_f32_16x16x32_bf16 v[32:35], a[132:135], a[24:27], v[32:35]
    buffer_load_dwordx4 a[112:115], v2, s[24:27], s99 offen offset:0 sc1
    v_mfma_f32_16x16x32_bf16 v[32:35], a[136:139], a[40:43], v[32:35]
    s_waitcnt vmcnt(14)
    v_mfma_f32_16x16x32_bf16 v[32:35], a[140:143], a[56:59], v[32:35]
    v_mfma_f32_16x16x32_bf16 v[36:39], a[128:131], a[12:15], v[36:39]
    ds_read_b64_tr_b16 a[128:129], v224 offset:64
    v_mfma_f32_16x16x32_bf16 v[36:39], a[132:135], a[28:31], v[36:39]
    ds_read_b64_tr_b16 a[130:131], v224 offset:576
    v_mfma_f32_16x16x32_bf16 v[36:39], a[136:139], a[44:47], v[36:39]
    s_waitcnt vmcnt(13)
    buffer_load_dwordx4 a[116:119], v2, s[24:27], s99 offen offset:1024 sc1
    v_mfma_f32_16x16x32_bf16 v[36:39], a[140:143], a[60:63], v[36:39]
    s_waitcnt lgkmcnt(8)
    ds_read_b64_tr_b16 a[132:133], v225 offset:64
    v_mfma_f32_16x16x32_bf16 v[40:43], a[144:147], a[0:3], v[40:43]
    s_waitcnt lgkmcnt(7)
    ds_read_b64_tr_b16 a[134:135], v225 offset:576
    v_mfma_f32_16x16x32_bf16 v[40:43], a[148:151], a[16:19], v[40:43]
    s_waitcnt lgkmcnt(6)
    ds_read_b64_tr_b16 a[136:137], v226 offset:64
    v_mfma_f32_16x16x32_bf16 v[40:43], a[152:155], a[32:35], v[40:43]
    s_waitcnt lgkmcnt(5)
    ds_read_b64_tr_b16 a[138:139], v226 offset:576
    v_mfma_f32_16x16x32_bf16 v[40:43], a[156:159], a[48:51], v[40:43]
    buffer_load_dwordx4 a[120:123], v2, s[24:27], s99 offen offset:2048 sc1
    v_mfma_f32_16x16x32_bf16 v[44:47], a[144:147], a[4:7], v[44:47]
    ds_read_b64_tr_b16 a[140:141], v227 offset:64
    v_mfma_f32_16x16x32_bf16 v[44:47], a[148:151], a[20:23], v[44:47]
    ds_read_b64_tr_b16 a[142:143], v227 offset:576
    v_mfma_f32_16x16x32_bf16 v[44:47], a[152:155], a[36:39], v[44:47]
    v_mfma_f32_16x16x32_bf16 v[44:47], a[156:159], a[52:55], v[44:47]
    v_mfma_f32_16x16x32_bf16 v[48:51], a[144:147], a[8:11], v[48:51]
    buffer_load_dwordx4 a[124:127], v2, s[24:27], s99 offen offset:3072 sc1
    v_mfma_f32_16x16x32_bf16 v[48:51], a[148:151], a[24:27], v[48:51]
    v_readlane_b32 s84, v0, 0
    v_mfma_f32_16x16x32_bf16 v[48:51], a[152:155], a[40:43], v[48:51]
    v_readlane_b32 s85, v0, 1
    v_readlane_b32 s86, v0, 2
    v_mfma_f32_16x16x32_bf16 v[48:51], a[156:159], a[56:59], v[48:51]
    v_readlane_b32 s87, v0, 3
    v_readlane_b32 s88, v0, 4
    v_mfma_f32_16x16x32_bf16 v[52:55], a[144:147], a[12:15], v[52:55]
    ds_read_b64_tr_b16 a[144:145], v224 offset:96
    v_readlane_b32 s89, v0, 5
    v_mfma_f32_16x16x32_bf16 v[52:55], a[148:151], a[28:31], v[52:55]
    ds_read_b64_tr_b16 a[146:147], v224 offset:608
    v_readlane_b32 s90, v0, 6
    v_mfma_f32_16x16x32_bf16 v[52:55], a[152:155], a[44:47], v[52:55]
    ds_read_b64_tr_b16 a[148:149], v225 offset:96
    v_readlane_b32 s91, v0, 7
    v_mfma_f32_16x16x32_bf16 v[52:55], a[156:159], a[60:63], v[52:55]
    s_waitcnt lgkmcnt(9)
    ds_read_b64_tr_b16 a[150:151], v225 offset:608
    v_readlane_b32 s92, v0, 8
    v_mfma_f32_16x16x32_bf16 v[56:59], a[128:131], a[0:3], v[56:59]
    s_waitcnt lgkmcnt(8)
    ds_read_b64_tr_b16 a[152:153], v226 offset:96
    v_readlane_b32 s93, v0, 9
    v_mfma_f32_16x16x32_bf16 v[56:59], a[132:135], a[16:19], v[56:59]
    s_waitcnt lgkmcnt(7)
    ds_read_b64_tr_b16 a[154:155], v226 offset:608
    v_readlane_b32 s94, v0, 10
    v_mfma_f32_16x16x32_bf16 v[56:59], a[136:139], a[32:35], v[56:59]
    s_waitcnt lgkmcnt(6)
    ds_read_b64_tr_b16 a[156:157], v227 offset:96
    v_readlane_b32 s95, v0, 11
    v_mfma_f32_16x16x32_bf16 v[56:59], a[140:143], a[48:51], v[56:59]
    ds_read_b64_tr_b16 a[158:159], v227 offset:608
    v_readlane_b32 s96, v0, 12
    v_mfma_f32_16x16x32_bf16 v[60:63], a[128:131], a[4:7], v[60:63]
    v_readlane_b32 s97, v0, 13
    v_readlane_b32 s98, v0, 14
    v_mfma_f32_16x16x32_bf16 v[60:63], a[132:135], a[20:23], v[60:63]
    v_readlane_b32 s99, v0, 15
    v_mfma_f32_16x16x32_bf16 v[60:63], a[136:139], a[36:39], v[60:63]
    v_mfma_f32_16x16x32_bf16 v[60:63], a[140:143], a[52:55], v[60:63]
    v_mfma_f32_16x16x32_bf16 v[64:67], a[128:131], a[8:11], v[64:67]
    v_mfma_f32_16x16x32_bf16 v[64:67], a[132:135], a[24:27], v[64:67]
    s_add_u32 m0, s51, 0
    v_mfma_f32_16x16x32_bf16 v[64:67], a[136:139], a[40:43], v[64:67]
    buffer_load_dwordx4 v5, s[12:15], s46 offen lds
    v_mfma_f32_16x16x32_bf16 v[64:67], a[140:143], a[56:59], v[64:67]
    v_mfma_f32_16x16x32_bf16 v[68:71], a[128:131], a[12:15], v[68:71]
    ds_read_b64_tr_b16 a[128:129], v224 offset:128
    v_mfma_f32_16x16x32_bf16 v[68:71], a[132:135], a[28:31], v[68:71]
    ds_read_b64_tr_b16 a[130:131], v224 offset:640
    v_mfma_f32_16x16x32_bf16 v[68:71], a[136:139], a[44:47], v[68:71]
    ds_read_b64_tr_b16 a[132:133], v225 offset:128
    v_mfma_f32_16x16x32_bf16 v[68:71], a[140:143], a[60:63], v[68:71]
    s_waitcnt lgkmcnt(9)
    ds_read_b64_tr_b16 a[134:135], v225 offset:640
    v_mfma_f32_16x16x32_bf16 v[72:75], a[144:147], a[0:3], v[72:75]
    s_waitcnt lgkmcnt(8)
    ds_read_b64_tr_b16 a[136:137], v226 offset:128
    v_mfma_f32_16x16x32_bf16 v[72:75], a[148:151], a[16:19], v[72:75]
    s_waitcnt lgkmcnt(7)
    ds_read_b64_tr_b16 a[138:139], v226 offset:640
    v_mfma_f32_16x16x32_bf16 v[72:75], a[152:155], a[32:35], v[72:75]
    s_waitcnt lgkmcnt(6)
    ds_read_b64_tr_b16 a[140:141], v227 offset:128
    v_mfma_f32_16x16x32_bf16 v[72:75], a[156:159], a[48:51], v[72:75]
    s_add_u32 m0, s51, 832
    ds_read_b64_tr_b16 a[142:143], v227 offset:640
    v_mfma_f32_16x16x32_bf16 v[76:79], a[144:147], a[4:7], v[76:79]
    buffer_load_dwordx4 v5, s[12:15], s46 offen offset:256 lds
    v_mfma_f32_16x16x32_bf16 v[76:79], a[148:151], a[20:23], v[76:79]
    s_add_u32 s59, s59, 8192
    v_mfma_f32_16x16x32_bf16 v[76:79], a[152:155], a[36:39], v[76:79]
    s_and_b32 s59, s59, 0x1ffff
    v_mfma_f32_16x16x32_bf16 v[76:79], a[156:159], a[52:55], v[76:79]
    s_add_u32 s46, s44, s59
    v_mfma_f32_16x16x32_bf16 v[80:83], a[144:147], a[8:11], v[80:83]
    v_mfma_f32_16x16x32_bf16 v[80:83], a[148:151], a[24:27], v[80:83]
    s_add_u32 m0, s51, 8704
    v_mfma_f32_16x16x32_bf16 v[80:83], a[152:155], a[40:43], v[80:83]
    buffer_load_dwordx4 v5, s[12:15], s46 offen lds
    v_mfma_f32_16x16x32_bf16 v[80:83], a[156:159], a[56:59], v[80:83]
    v_mfma_f32_16x16x32_bf16 v[84:87], a[144:147], a[12:15], v[84:87]
    ds_read_b64_tr_b16 a[144:145], v224 offset:160
    v_mfma_f32_16x16x32_bf16 v[84:87], a[148:151], a[28:31], v[84:87]
    ds_read_b64_tr_b16 a[146:147], v224 offset:672
    v_mfma_f32_16x16x32_bf16 v[84:87], a[152:155], a[44:47], v[84:87]
    ds_read_b64_tr_b16 a[148:149], v225 offset:160
    v_mfma_f32_16x16x32_bf16 v[84:87], a[156:159], a[60:63], v[84:87]
    s_waitcnt lgkmcnt(9)
    ds_read_b64_tr_b16 a[150:151], v225 offset:672
    v_mfma_f32_16x16x32_bf16 v[88:91], a[128:131], a[0:3], v[88:91]
    s_waitcnt lgkmcnt(8)
    ds_read_b64_tr_b16 a[152:153], v226 offset:160
    v_mfma_f32_16x16x32_bf16 v[88:91], a[132:135], a[16:19], v[88:91]
    s_waitcnt lgkmcnt(7)
    ds_read_b64_tr_b16 a[154:155], v226 offset:672
    v_mfma_f32_16x16x32_bf16 v[88:91], a[136:139], a[32:35], v[88:91]
    s_waitcnt lgkmcnt(6)
    ds_read_b64_tr_b16 a[156:157], v227 offset:160
    v_mfma_f32_16x16x32_bf16 v[88:91], a[140:143], a[48:51], v[88:91]
    s_add_u32 m0, s51, 9536
    ds_read_b64_tr_b16 a[158:159], v227 offset:672
    v_mfma_f32_16x16x32_bf16 v[92:95], a[128:131], a[4:7], v[92:95]
    buffer_load_dwordx4 v5, s[12:15], s46 offen offset:256 lds
    v_mfma_f32_16x16x32_bf16 v[92:95], a[132:135], a[20:23], v[92:95]
    s_add_u32 s59, s59, 8192
    v_mfma_f32_16x16x32_bf16 v[92:95], a[136:139], a[36:39], v[92:95]
    s_and_b32 s59, s59, 0x1ffff
    v_mfma_f32_16x16x32_bf16 v[92:95], a[140:143], a[52:55], v[92:95]
    s_add_u32 s46, s44, s59
    v_mfma_f32_16x16x32_bf16 v[96:99], a[128:131], a[8:11], v[96:99]
    v_mfma_f32_16x16x32_bf16 v[96:99], a[132:135], a[24:27], v[96:99]
    s_add_u32 m0, s52, 17408
    v_mfma_f32_16x16x32_bf16 v[96:99], a[136:139], a[40:43], v[96:99]
    buffer_load_dwordx4 v6, s[16:19], s47 offen lds
    v_mfma_f32_16x16x32_bf16 v[96:99], a[140:143], a[56:59], v[96:99]
    v_mfma_f32_16x16x32_bf16 v[100:103], a[128:131], a[12:15], v[100:103]
    ds_read_b64_tr_b16 a[128:129], v224 offset:192
    v_mfma_f32_16x16x32_bf16 v[100:103], a[132:135], a[28:31], v[100:103]
    ds_read_b64_tr_b16 a[130:131], v224 offset:704
    v_mfma_f32_16x16x32_bf16 v[100:103], a[136:139], a[44:47], v[100:103]
    ds_read_b64_tr_b16 a[132:133], v225 offset:192
    v_mfma_f32_16x16x32_bf16 v[100:103], a[140:143], a[60:63], v[100:103]
    s_waitcnt lgkmcnt(9)
    ds_read_b64_tr_b16 a[134:135], v225 offset:704
    v_mfma_f32_16x16x32_bf16 v[104:107], a[144:147], a[0:3], v[104:107]
    s_waitcnt lgkmcnt(8)
    ds_read_b64_tr_b16 a[136:137], v226 offset:192
    v_mfma_f32_16x16x32_bf16 v[104:107], a[148:151], a[16:19], v[104:107]
    s_waitcnt lgkmcnt(7)
    ds_read_b64_tr_b16 a[138:139], v226 offset:704
    v_mfma_f32_16x16x32_bf16 v[104:107], a[152:155], a[32:35], v[104:107]
    s_waitcnt lgkmcnt(6)
    ds_read_b64_tr_b16 a[140:141], v227 offset:192
    v_mfma_f32_16x16x32_bf16 v[104:107], a[156:159], a[48:51], v[104:107]
    s_add_u32 m0, s52, 18208
    ds_read_b64_tr_b16 a[142:143], v227 offset:704
    v_mfma_f32_16x16x32_bf16 v[108:111], a[144:147], a[4:7], v[108:111]
    buffer_load_dwordx4 v6, s[16:19], s47 offen offset:256 lds
    v_mfma_f32_16x16x32_bf16 v[108:111], a[148:151], a[20:23], v[108:111]
    s_add_u32 s60, s60, 8192
    v_mfma_f32_16x16x32_bf16 v[108:111], a[152:155], a[36:39], v[108:111]
    s_and_b32 s60, s60, 0x1ffff
    v_mfma_f32_16x16x32_bf16 v[108:111], a[156:159], a[52:55], v[108:111]
    s_add_u32 s47, s44, s60
    v_mfma_f32_16x16x32_bf16 v[112:115], a[144:147], a[8:11], v[112:115]
    v_mfma_f32_16x16x32_bf16 v[112:115], a[148:151], a[24:27], v[112:115]
    v_mfma_f32_16x16x32_bf16 v[112:115], a[152:155], a[40:43], v[112:115]
    v_mfma_f32_16x16x32_bf16 v[112:115], a[156:159], a[56:59], v[112:115]
    v_mfma_f32_16x16x32_bf16 v[116:119], a[144:147], a[12:15], v[116:119]
    ds_read_b64_tr_b16 a[144:145], v224 offset:224
    v_mfma_f32_16x16x32_bf16 v[116:119], a[148:151], a[28:31], v[116:119]
    ds_read_b64_tr_b16 a[146:147], v224 offset:736
    v_mfma_f32_16x16x32_bf16 v[116:119], a[152:155], a[44:47], v[116:119]
    ds_read_b64_tr_b16 a[148:149], v225 offset:224
    v_mfma_f32_16x16x32_bf16 v[116:119], a[156:159], a[60:63], v[116:119]
    s_waitcnt lgkmcnt(9)
    ds_read_b64_tr_b16 a[150:151], v225 offset:736
    v_mfma_f32_16x16x32_bf16 v[120:123], a[128:131], a[0:3], v[120:123]
    s_waitcnt lgkmcnt(8)
    ds_read_b64_tr_b16 a[152:153], v226 offset:224
    v_mfma_f32_16x16x32_bf16 v[120:123], a[132:135], a[16:19], v[120:123]
    s_waitcnt lgkmcnt(7)
    ds_read_b64_tr_b16 a[154:155], v226 offset:736
    v_mfma_f32_16x16x32_bf16 v[120:123], a[136:139], a[32:35], v[120:123]
    s_waitcnt lgkmcnt(6)
    ds_read_b64_tr_b16 a[156:157], v227 offset:224
    v_mfma_f32_16x16x32_bf16 v[120:123], a[140:143], a[48:51], v[120:123]
    ds_read_b64_tr_b16 a[158:159], v227 offset:736
    v_mfma_f32_16x16x32_bf16 v[124:127], a[128:131], a[4:7], v[124:127]
    v_mfma_f32_16x16x32_bf16 v[124:127], a[132:135], a[20:23], v[124:127]
    v_mfma_f32_16x16x32_bf16 v[124:127], a[136:139], a[36:39], v[124:127]
    v_mfma_f32_16x16x32_bf16 v[124:127], a[140:143], a[52:55], v[124:127]
    v_mfma_f32_16x16x32_bf16 v[128:131], a[128:131], a[8:11], v[128:131]
    v_mfma_f32_16x16x32_bf16 v[128:131], a[132:135], a[24:27], v[128:131]
    v_mfma_f32_16x16x32_bf16 v[128:131], a[136:139], a[40:43], v[128:131]
    v_mfma_f32_16x16x32_bf16 v[128:131], a[140:143], a[56:59], v[128:131]
    v_mfma_f32_16x16x32_bf16 v[132:135], a[128:131], a[12:15], v[132:135]
    ds_read_b64_tr_b16 a[128:129], v228 offset:0
    v_mfma_f32_16x16x32_bf16 v[132:135], a[132:135], a[28:31], v[132:135]
    ds_read_b64_tr_b16 a[130:131], v228 offset:512
    v_mfma_f32_16x16x32_bf16 v[132:135], a[136:139], a[44:47], v[132:135]
    ds_read_b64_tr_b16 a[132:133], v229 offset:0
    v_mfma_f32_16x16x32_bf16 v[132:135], a[140:143], a[60:63], v[132:135]
    s_waitcnt lgkmcnt(9)
    ds_read_b64_tr_b16 a[134:135], v229 offset:512
    v_mfma_f32_16x16x32_bf16 v[136:139], a[144:147], a[0:3], v[136:139]
    s_waitcnt lgkmcnt(8)
    ds_read_b64_tr_b16 a[136:137], v230 offset:0
    v_mfma_f32_16x16x32_bf16 v[136:139], a[148:151], a[16:19], v[136:139]
    s_waitcnt lgkmcnt(7)
    ds_read_b64_tr_b16 a[138:139], v230 offset:512
    v_mfma_f32_16x16x32_bf16 v[136:139], a[152:155], a[32:35], v[136:139]
    s_waitcnt lgkmcnt(6)
    ds_read_b64_tr_b16 a[140:141], v231 offset:0
    v_mfma_f32_16x16x32_bf16 v[136:139], a[156:159], a[48:51], v[136:139]
    ds_read_b64_tr_b16 a[142:143], v231 offset:512
    v_mfma_f32_16x16x32_bf16 v[140:143], a[144:147], a[4:7], v[140:143]
    v_mfma_f32_16x16x32_bf16 v[140:143], a[148:151], a[20:23], v[140:143]
    v_mfma_f32_16x16x32_bf16 v[140:143], a[152:155], a[36:39], v[140:143]
    v_mfma_f32_16x16x32_bf16 v[140:143], a[156:159], a[52:55], v[140:143]
    v_mfma_f32_16x16x32_bf16 v[144:147], a[144:147], a[8:11], v[144:147]
    v_mfma_f32_16x16x32_bf16 v[144:147], a[148:151], a[24:27], v[144:147]
    v_mfma_f32_16x16x32_bf16 v[144:147], a[152:155], a[40:43], v[144:147]
    v_mfma_f32_16x16x32_bf16 v[144:147], a[156:159], a[56:59], v[144:147]
    v_mfma_f32_16x16x32_bf16 v[148:151], a[144:147], a[12:15], v[148:151]
    ds_read_b64_tr_b16 a[144:145], v228 offset:32
    v_mfma_f32_16x16x32_bf16 v[148:151], a[148:151], a[28:31], v[148:151]
    ds_read_b64_tr_b16 a[146:147], v228 offset:544
    v_mfma_f32_16x16x32_bf16 v[148:151], a[152:155], a[44:47], v[148:151]
    ds_read_b64_tr_b16 a[148:149], v229 offset:32
    v_mfma_f32_16x16x32_bf16 v[148:151], a[156:159], a[60:63], v[148:151]
    s_waitcnt vmcnt(21) lgkmcnt(9)
    ds_read_b64_tr_b16 a[150:151], v229 offset:544
    v_mfma_f32_16x16x32_bf16 v[24:27], a[128:131], a[64:67], v[24:27]
    s_waitcnt vmcnt(17) lgkmcnt(8)
    ds_read_b64_tr_b16 a[152:153], v230 offset:32
    v_mfma_f32_16x16x32_bf16 v[24:27], a[132:135], a[80:83], v[24:27]
    s_waitcnt vmcnt(13) lgkmcnt(7)
    ds_read_b64_tr_b16 a[154:155], v230 offset:544
    v_mfma_f32_16x16x32_bf16 v[24:27], a[136:139], a[96:99], v[24:27]
    s_waitcnt vmcnt(9) lgkmcnt(6)
    ds_read_b64_tr_b16 a[156:157], v231 offset:32
    v_mfma_f32_16x16x32_bf16 v[24:27], a[140:143], a[112:115], v[24:27]
    ds_read_b64_tr_b16 a[158:159], v231 offset:544
    v_mfma_f32_16x16x32_bf16 v[28:31], a[128:131], a[68:71], v[28:31]
    v_mfma_f32_16x16x32_bf16 v[28:31], a[132:135], a[84:87], v[28:31]
    v_mfma_f32_16x16x32_bf16 v[28:31], a[136:139], a[100:103], v[28:31]
    s_waitcnt vmcnt(8)
    v_mfma_f32_16x16x32_bf16 v[28:31], a[140:143], a[116:119], v[28:31]
    v_mfma_f32_16x16x32_bf16 v[32:35], a[128:131], a[72:75], v[32:35]
    v_mfma_f32_16x16x32_bf16 v[32:35], a[132:135], a[88:91], v[32:35]
    v_mfma_f32_16x16x32_bf16 v[32:35], a[136:139], a[104:107], v[32:35]
    s_waitcnt vmcnt(7)
    v_mfma_f32_16x16x32_bf16 v[32:35], a[140:143], a[120:123], v[32:35]
    v_cvt_pk_bf16_f32 v152, v24, v25
    v_cvt_pk_bf16_f32 v153, v26, v27
    v_mfma_f32_16x16x32_bf16 v[36:39], a[128:131], a[76:79], v[36:39]
    ds_read_b64_tr_b16 a[128:129], v228 offset:64
    v_mfma_f32_16x16x32_bf16 v[36:39], a[132:135], a[92:95], v[36:39]
    ds_read_b64_tr_b16 a[130:131], v228 offset:576
    v_mfma_f32_16x16x32_bf16 v[36:39], a[136:139], a[108:111], v[36:39]
    s_waitcnt vmcnt(6)
    ds_read_b64_tr_b16 a[132:133], v229 offset:64
    v_mfma_f32_16x16x32_bf16 v[36:39], a[140:143], a[124:127], v[36:39]
    s_waitcnt lgkmcnt(9)
    ds_read_b64_tr_b16 a[134:135], v229 offset:576
    v_cvt_pk_bf16_f32 v168, v28, v29
    v_mfma_f32_16x16x32_bf16 v[40:43], a[144:147], a[64:67], v[40:43]
    s_waitcnt lgkmcnt(8)
    ds_read_b64_tr_b16 a[136:137], v230 offset:64
    v_cvt_pk_bf16_f32 v169, v30, v31
    v_mfma_f32_16x16x32_bf16 v[40:43], a[148:151], a[80:83], v[40:43]
    s_waitcnt lgkmcnt(7)
    ds_read_b64_tr_b16 a[138:139], v230 offset:576
    v_mfma_f32_16x16x32_bf16 v[40:43], a[152:155], a[96:99], v[40:43]
    s_waitcnt lgkmcnt(6)
    ds_read_b64_tr_b16 a[140:141], v231 offset:64
    v_mfma_f32_16x16x32_bf16 v[40:43], a[156:159], a[112:115], v[40:43]
    ds_read_b64_tr_b16 a[142:143], v231 offset:576
    v_cvt_pk_bf16_f32 v184, v32, v33
    v_mfma_f32_16x16x32_bf16 v[44:47], a[144:147], a[68:71], v[44:47]
    s_lshr_b32 s64, s2, 3
    s_lshl2_add_u32 s64, s64, s3
    s_lshl_b32 s64, s64, 7
    s_add_u32 s64, s64, 2048
    s_min_u32 s64, s64, L_code_end - L_ct_1 - 64
    s_getpc_b64 s[100:101]
L_ct_1:
    s_add_u32 s100, s100, s64
    s_addc_u32 s101, s101, 0
    global_load_ubyte v23, v1, s[100:101]
    v_mfma_f32_16x16x32_bf16 v[44:47], a[148:151], a[84:87], v[44:47]
    v_cvt_pk_bf16_f32 v185, v34, v35
    v_mfma_f32_16x16x32_bf16 v[44:47], a[152:155], a[100:103], v[44:47]
    v_mfma_f32_16x16x32_bf16 v[44:47], a[156:159], a[116:119], v[44:47]
    v_cvt_pk_bf16_f32 v200, v36, v37
    v_cvt_pk_bf16_f32 v201, v38, v39
    v_mfma_f32_16x16x32_bf16 v[48:51], a[144:147], a[72:75], v[48:51]
    v_mfma_f32_16x16x32_bf16 v[48:51], a[148:151], a[88:91], v[48:51]
    v_mfma_f32_16x16x32_bf16 v[48:51], a[152:155], a[104:107], v[48:51]
    v_mfma_f32_16x16x32_bf16 v[48:51], a[156:159], a[120:123], v[48:51]
    v_cvt_pk_bf16_f32 v154, v40, v41
    v_cvt_pk_bf16_f32 v155, v42, v43
    v_mfma_f32_16x16x32_bf16 v[52:55], a[144:147], a[76:79], v[52:55]
    ds_read_b64_tr_b16 a[144:145], v228 offset:96
    v_mfma_f32_16x16x32_bf16 v[52:55], a[148:151], a[92:95], v[52:55]
    ds_read_b64_tr_b16 a[146:147], v228 offset:608
    v_permlane16_swap_b32 v152, v154
    v_mfma_f32_16x16x32_bf16 v[52:55], a[152:155], a[108:111], v[52:55]
    ds_read_b64_tr_b16 a[148:149], v229 offset:96
    v_permlane16_swap_b32 v153, v155
    v_mfma_f32_16x16x32_bf16 v[52:55], a[156:159], a[124:127], v[52:55]
    s_waitcnt lgkmcnt(9)
    ds_read_b64_tr_b16 a[150:151], v229 offset:608
    v_cvt_pk_bf16_f32 v170, v44, v45
    v_mfma_f32_16x16x32_bf16 v[56:59], a[128:131], a[64:67], v[56:59]
    s_waitcnt lgkmcnt(8)
    ds_read_b64_tr_b16 a[152:153], v230 offset:96
    v_cvt_pk_bf16_f32 v171, v46, v47
    v_mfma_f32_16x16x32_bf16 v[56:59], a[132:135], a[80:83], v[56:59]
    s_waitcnt lgkmcnt(7)
    ds_read_b64_tr_b16 a[154:155], v230 offset:608
    v_mfma_f32_16x16x32_bf16 v[56:59], a[136:139], a[96:99], v[56:59]
    s_waitcnt lgkmcnt(6)
    ds_read_b64_tr_b16 a[156:157], v231 offset:96
    v_permlane16_swap_b32 v168, v170
    v_mfma_f32_16x16x32_bf16 v[56:59], a[140:143], a[112:115], v[56:59]
    ds_read_b64_tr_b16 a[158:159], v231 offset:608
    v_permlane16_swap_b32 v169, v171
    v_mfma_f32_16x16x32_bf16 v[60:63], a[128:131], a[68:71], v[60:63]
    v_cvt_pk_bf16_f32 v186, v48, v49
    v_cvt_pk_bf16_f32 v187, v50, v51
    v_mfma_f32_16x16x32_bf16 v[60:63], a[132:135], a[84:87], v[60:63]
    v_mfma_f32_16x16x32_bf16 v[60:63], a[136:139], a[100:103], v[60:63]
    v_permlane16_swap_b32 v184, v186
    v_permlane16_swap_b32 v185, v187
    v_mfma_f32_16x16x32_bf16 v[60:63], a[140:143], a[116:119], v[60:63]
    v_cvt_pk_bf16_f32 v202, v52, v53
    v_cvt_pk_bf16_f32 v203, v54, v55
    v_mfma_f32_16x16x32_bf16 v[64:67], a[128:131], a[72:75], v[64:67]
    v_mfma_f32_16x16x32_bf16 v[64:67], a[132:135], a[88:91], v[64:67]
    v_permlane16_swap_b32 v200, v202
    v_permlane16_swap_b32 v201, v203
    v_mfma_f32_16x16x32_bf16 v[64:67], a[136:139], a[104:107], v[64:67]
    v_mfma_f32_16x16x32_bf16 v[64:67], a[140:143], a[120:123], v[64:67]
    v_cvt_pk_bf16_f32 v156, v56, v57
    v_cvt_pk_bf16_f32 v157, v58, v59
    v_mfma_f32_16x16x32_bf16 v[68:71], a[128:131], a[76:79], v[68:71]
    ds_read_b64_tr_b16 a[128:129], v228 offset:128
    v_mfma_f32_16x16x32_bf16 v[68:71], a[132:135], a[92:95], v[68:71]
    ds_read_b64_tr_b16 a[130:131], v228 offset:640
    v_mfma_f32_16x16x32_bf16 v[68:71], a[136:139], a[108:111], v[68:71]
    ds_read_b64_tr_b16 a[132:133], v229 offset:128
    v_mfma_f32_16x16x32_bf16 v[68:71], a[140:143], a[124:127], v[68:71]
    s_waitcnt lgkmcnt(9)
    ds_read_b64_tr_b16 a[134:135], v229 offset:640
    v_cvt_pk_bf16_f32 v172, v60, v61
    v_mfma_f32_16x16x32_bf16 v[72:75], a[144:147], a[64:67], v[72:75]
    s_waitcnt vmcnt(5) lgkmcnt(8)
    s_barrier
    ds_read_b64_tr_b16 a[136:137], v230 offset:128
    v_mfma_f32_16x16x32_bf16 v[72:75], a[148:151], a[80:83], v[72:75]
    s_waitcnt lgkmcnt(7)
    ds_read_b64_tr_b16 a[138:139], v230 offset:640
    v_cvt_pk_bf16_f32 v173, v62, v63
    v_mfma_f32_16x16x32_bf16 v[72:75], a[152:155], a[96:99], v[72:75]
    s_waitcnt lgkmcnt(6)
    ds_read_b64_tr_b16 a[140:141], v231 offset:128
    v_mfma_f32_16x16x32_bf16 v[72:75], a[156:159], a[112:115], v[72:75]
    s_add_u32 m0, s52, 34496
    ds_read_b64_tr_b16 a[142:143], v231 offset:640
    v_cvt_pk_bf16_f32 v188, v64, v65
    v_mfma_f32_16x16x32_bf16 v[76:79], a[144:147], a[68:71], v[76:79]
    buffer_load_dwordx4 v6, s[16:19], s47 offen lds
    v_mfma_f32_16x16x32_bf16 v[76:79], a[148:151], a[84:87], v[76:79]
    v_cvt_pk_bf16_f32 v189, v66, v67
    v_mfma_f32_16x16x32_bf16 v[76:79], a[152:155], a[100:103], v[76:79]
    s_add_u32 m0, s52, 35296
    v_mfma_f32_16x16x32_bf16 v[76:79], a[156:159], a[116:119], v[76:79]
    buffer_load_dwordx4 v6, s[16:19], s47 offen offset:256 lds
    v_mfma_f32_16x16x32_bf16 v[80:83], a[144:147], a[72:75], v[80:83]
    s_add_u32 s60, s60, 8192
    v_cvt_pk_bf16_f32 v204, v68, v69
    v_cvt_pk_bf16_f32 v205, v70, v71
    v_mfma_f32_16x16x32_bf16 v[80:83], a[148:151], a[88:91], v[80:83]
    s_and_b32 s60, s60, 0x1ffff
    v_mfma_f32_16x16x32_bf16 v[80:83], a[152:155], a[104:107], v[80:83]
    s_add_u32 s47, s44, s60
    v_mfma_f32_16x16x32_bf16 v[80:83], a[156:159], a[120:123], v[80:83]
    v_cvt_pk_bf16_f32 v158, v72, v73
    v_cvt_pk_bf16_f32 v159, v74, v75
    v_mfma_f32_16x16x32_bf16 v[84:87], a[144:147], a[76:79], v[84:87]
    ds_read_b64_tr_b16 a[144:145], v228 offset:160
    v_mfma_f32_16x16x32_bf16 v[84:87], a[148:151], a[92:95], v[84:87]
    ds_read_b64_tr_b16 a[146:147], v228 offset:672
    v_permlane16_swap_b32 v156, v158
    v_mfma_f32_16x16x32_bf16 v[84:87], a[152:155], a[108:111], v[84:87]
    ds_read_b64_tr_b16 a[148:149], v229 offset:160
    v_permlane16_swap_b32 v157, v159
    v_mfma_f32_16x16x32_bf16 v[84:87], a[156:159], a[124:127], v[84:87]
    s_waitcnt lgkmcnt(9)
    ds_read_b64_tr_b16 a[150:151], v229 offset:672
    v_cvt_pk_bf16_f32 v174, v76, v77
    v_mfma_f32_16x16x32_bf16 v[88:91], a[128:131], a[64:67], v[88:91]
    s_waitcnt lgkmcnt(8)
    ds_read_b64_tr_b16 a[152:153], v230 offset:160
    v_cvt_pk_bf16_f32 v175, v78, v79
    v_mfma_f32_16x16x32_bf16 v[88:91], a[132:135], a[80:83], v[88:91]
    s_waitcnt lgkmcnt(7)
    ds_read_b64_tr_b16 a[154:155], v230 offset:672
    v_mfma_f32_16x16x32_bf16 v[88:91], a[136:139], a[96:99], v[88:91]
    s_waitcnt lgkmcnt(6)
    ds_read_b64_tr_b16 a[156:157], v231 offset:160
    v_permlane16_swap_b32 v172, v174
    v_mfma_f32_16x16x32_bf16 v[88:91], a[140:143], a[112:115], v[88:91]
    s_add_u32 m0, s51, 25856
    ds_read_b64_tr_b16 a[158:159], v231 offset:672
    v_permlane16_swap_b32 v173, v175
    v_mfma_f32_16x16x32_bf16 v[92:95], a[128:131], a[68:71], v[92:95]
    buffer_load_dwordx4 v5, s[12:15], s46 offen lds
    v_mfma_f32_16x16x32_bf16 v[92:95], a[132:135], a[84:87], v[92:95]
    v_cvt_pk_bf16_f32 v190, v80, v81
    v_cvt_pk_bf16_f32 v191, v82, v83
    v_mfma_f32_16x16x32_bf16 v[92:95], a[136:139], a[100:103], v[92:95]
    s_add_u32 m0, s51, 26688
    v_mfma_f32_16x16x32_bf16 v[92:95], a[140:143], a[116:119], v[92:95]
    buffer_load_dwordx4 v5, s[12:15], s46 offen offset:256 lds
    v_mfma_f32_16x16x32_bf16 v[96:99], a[128:131], a[72:75], v[96:99]
    s_add_u32 s59, s59, 8192
    v_permlane16_swap_b32 v188, v190
    v_permlane16_swap_b32 v189, v191
    v_mfma_f32_16x16x32_bf16 v[96:99], a[132:135], a[88:91], v[96:99]
    s_and_b32 s59, s59, 0x1ffff
    v_cvt_pk_bf16_f32 v206, v84, v85
    v_cvt_pk_bf16_f32 v207, v86, v87
    v_mfma_f32_16x16x32_bf16 v[96:99], a[136:139], a[104:107], v[96:99]
    s_add_u32 s46, s44, s59
    v_mfma_f32_16x16x32_bf16 v[96:99], a[140:143], a[120:123], v[96:99]
    v_permlane16_swap_b32 v204, v206
    v_permlane16_swap_b32 v205, v207
    v_mfma_f32_16x16x32_bf16 v[100:103], a[128:131], a[76:79], v[100:103]
    ds_read_b64_tr_b16 a[128:129], v228 offset:192
    v_cvt_pk_bf16_f32 v160, v88, v89
    v_mfma_f32_16x16x32_bf16 v[100:103], a[132:135], a[92:95], v[100:103]
    ds_read_b64_tr_b16 a[130:131], v228 offset:704
    v_cvt_pk_bf16_f32 v161, v90, v91
    v_mfma_f32_16x16x32_bf16 v[100:103], a[136:139], a[108:111], v[100:103]
    ds_read_b64_tr_b16 a[132:133], v229 offset:192
    v_mfma_f32_16x16x32_bf16 v[100:103], a[140:143], a[124:127], v[100:103]
    s_waitcnt lgkmcnt(9)
    ds_read_b64_tr_b16 a[134:135], v229 offset:704
    ds_read_b128 a[192:195], v3 offset:0
    v_cvt_pk_bf16_f32 v176, v92, v93
    v_mfma_f32_16x16x32_bf16 v[104:107], a[144:147], a[64:67], v[104:107]
    s_waitcnt lgkmcnt(9)
    ds_read_b64_tr_b16 a[136:137], v230 offset:192
    ds_read_b128 a[196:199], v3 offset:64
    v_cvt_pk_bf16_f32 v177, v94, v95
    v_mfma_f32_16x16x32_bf16 v[104:107], a[148:151], a[80:83], v[104:107]
    s_waitcnt lgkmcnt(9)
    ds_read_b64_tr_b16 a[138:139], v230 offset:704
    ds_read_b128 a[200:203], v3 offset:128
    v_mfma_f32_16x16x32_bf16 v[104:107], a[152:155], a[96:99], v[104:107]
    s_waitcnt lgkmcnt(9)
    ds_read_b64_tr_b16 a[140:141], v231 offset:192
    v_mfma_f32_16x16x32_bf16 v[104:107], a[156:159], a[112:115], v[104:107]
    s_add_u32 m0, s82, 0
    ds_read_b64_tr_b16 a[142:143], v231 offset:704
    v_cvt_pk_bf16_f32 v192, v96, v97
    v_mfma_f32_16x16x32_bf16 v[108:111], a[144:147], a[68:71], v[108:111]
    buffer_load_dwordx4 v7, s[72:75], s77 offen lds
    v_mfma_f32_16x16x32_bf16 v[108:111], a[148:151], a[84:87], v[108:111]
    s_add_u32 s77, s77, s76
    ds_read_b128 a[204:207], v3 offset:192
    v_cvt_pk_bf16_f32 v193, v98, v99
    v_mfma_f32_16x16x32_bf16 v[108:111], a[152:155], a[100:103], v[108:111]
    ds_read_b128 a[208:211], v3 offset:4352
    v_mfma_f32_16x16x32_bf16 v[108:111], a[156:159], a[116:119], v[108:111]
    s_add_u32 m0, s82, 1056
    ds_read_b128 a[212:215], v3 offset:4416
    v_cvt_pk_bf16_f32 v208, v100, v101
    v_mfma_f32_16x16x32_bf16 v[112:115], a[144:147], a[72:75], v[112:115]
    buffer_load_dwordx4 v7, s[72:75], s77 offen lds
    v_mfma_f32_16x16x32_bf16 v[112:115], a[148:151], a[88:91], v[112:115]
    s_add_u32 s77, s77, s76
    ds_read_b128 a[216:219], v3 offset:4480
    v_cvt_pk_bf16_f32 v209, v102, v103
    v_mfma_f32_16x16x32_bf16 v[112:115], a[152:155], a[104:107], v[112:115]
    ds_read_b128 a[220:223], v3 offset:4544
    v_mfma_f32_16x16x32_bf16 v[112:115], a[156:159], a[120:123], v[112:115]
    v_cvt_pk_bf16_f32 v162, v104, v105
    v_cvt_pk_bf16_f32 v163, v106, v107
    v_mfma_f32_16x16x32_bf16 v[116:119], a[144:147], a[76:79], v[116:119]
    ds_read_b64_tr_b16 a[144:145], v228 offset:224
    v_mfma_f32_16x16x32_bf16 v[116:119], a[148:151], a[92:95], v[116:119]
    ds_read_b64_tr_b16 a[146:147], v228 offset:736
    v_permlane16_swap_b32 v160, v162
    v_mfma_f32_16x16x32_bf16 v[116:119], a[152:155], a[108:111], v[116:119]
    ds_read_b64_tr_b16 a[148:149], v229 offset:224
    v_permlane16_swap_b32 v161, v163
    v_mfma_f32_16x16x32_bf16 v[116:119], a[156:159], a[124:127], v[116:119]
    s_waitcnt lgkmcnt(15)
    ds_read_b64_tr_b16 a[150:151], v229 offset:736
    v_cvt_pk_bf16_f32 v178, v108, v109
    v_mfma_f32_16x16x32_bf16 v[120:123], a[128:131], a[64:67], v[120:123]
    ds_read_b64_tr_b16 a[152:153], v230 offset:224
    v_cvt_pk_bf16_f32 v179, v110, v111
    v_mfma_f32_16x16x32_bf16 v[120:123], a[132:135], a[80:83], v[120:123]
    s_waitcnt lgkmcnt(13)
    ds_read_b64_tr_b16 a[154:155], v230 offset:736
    v_mfma_f32_16x16x32_bf16 v[120:123], a[136:139], a[96:99], v[120:123]
    s_waitcnt lgkmcnt(11)
    ds_read_b64_tr_b16 a[156:157], v231 offset:224
    v_permlane16_swap_b32 v176, v178
    v_mfma_f32_16x16x32_bf16 v[120:123], a[140:143], a[112:115], v[120:123]
    s_add_u32 m0, s82, 2112
    ds_read_b64_tr_b16 a[158:159], v231 offset:736
    v_permlane16_swap_b32 v177, v179
    v_mfma_f32_16x16x32_bf16 v[124:127], a[128:131], a[68:71], v[124:127]
    buffer_load_dwordx4 v7, s[72:75], s77 offen lds
    v_mfma_f32_16x16x32_bf16 v[124:127], a[132:135], a[84:87], v[124:127]
    s_add_u32 s77, s77, s76
    v_cvt_pk_bf16_f32 v194, v112, v113
    v_cvt_pk_bf16_f32 v195, v114, v115
    v_mfma_f32_16x16x32_bf16 v[124:127], a[136:139], a[100:103], v[124:127]
    v_mfma_f32_16x16x32_bf16 v[124:127], a[140:143], a[116:119], v[124:127]
    s_add_u32 m0, s82, 3168
    v_permlane16_swap_b32 v192, v194
    v_permlane16_swap_b32 v193, v195
    v_mfma_f32_16x16x32_bf16 v[128:131], a[128:131], a[72:75], v[128:131]
    buffer_load_dwordx4 v7, s[72:75], s77 offen lds
    v_mfma_f32_16x16x32_bf16 v[128:131], a[132:135], a[88:91], v[128:131]
    s_add_u32 s77, s77, s81
    v_cvt_pk_bf16_f32 v210, v116, v117
    v_cvt_pk_bf16_f32 v211, v118, v119
    v_mfma_f32_16x16x32_bf16 v[128:131], a[136:139], a[104:107], v[128:131]
    v_mfma_f32_16x16x32_bf16 v[128:131], a[140:143], a[120:123], v[128:131]
    s_add_u32 m0, s82, 4224
    v_permlane16_swap_b32 v208, v210
    v_permlane16_swap_b32 v209, v211
    v_mfma_f32_16x16x32_bf16 v[132:135], a[128:131], a[76:79], v[132:135]
    buffer_load_dwordx4 v7, s[72:75], s77 offen lds
    v_mfma_f32_16x16x32_bf16 v[132:135], a[132:135], a[92:95], v[132:135]
    s_add_u32 s77, s77, s76
    v_cvt_pk_bf16_f32 v164, v120, v121
    v_cvt_pk_bf16_f32 v165, v122, v123
    v_mfma_f32_16x16x32_bf16 v[132:135], a[136:139], a[108:111], v[132:135]
    v_mfma_f32_16x16x32_bf16 v[132:135], a[140:143], a[124:127], v[132:135]
    s_waitcnt lgkmcnt(6)
    s_add_u32 m0, s82, 5280
    v_cvt_pk_bf16_f32 v180, v124, v125
    v_cvt_pk_bf16_f32 v181, v126, v127
    v_mfma_f32_16x16x32_bf16 v[136:139], a[144:147], a[64:67], v[136:139]
    s_waitcnt lgkmcnt(4)
    buffer_load_dwordx4 v7, s[72:75], s77 offen lds
    v_mfma_f32_16x16x32_bf16 v[136:139], a[148:151], a[80:83], v[136:139]
    s_waitcnt lgkmcnt(2)
    s_add_u32 s77, s77, s76
    v_mfma_f32_16x16x32_bf16 v[136:139], a[152:155], a[96:99], v[136:139]
    s_waitcnt lgkmcnt(0)
    v_mfma_f32_16x16x32_bf16 v[136:139], a[156:159], a[112:115], v[136:139]
    s_add_u32 m0, s82, 6336
    v_cvt_pk_bf16_f32 v196, v128, v129
    v_cvt_pk_bf16_f32 v197, v130, v131
    v_mfma_f32_16x16x32_bf16 v[140:143], a[144:147], a[68:71], v[140:143]
    buffer_load_dwordx4 v7, s[72:75], s77 offen lds
    v_mfma_f32_16x16x32_bf16 v[140:143], a[148:151], a[84:87], v[140:143]
    s_add_u32 s77, s77, s76
    v_mfma_f32_16x16x32_bf16 v[140:143], a[152:155], a[100:103], v[140:143]
    v_mfma_f32_16x16x32_bf16 v[140:143], a[156:159], a[116:119], v[140:143]
    s_add_u32 m0, s82, 7392
    v_cvt_pk_bf16_f32 v212, v132, v133
    v_cvt_pk_bf16_f32 v213, v134, v135
    v_mfma_f32_16x16x32_bf16 v[144:147], a[144:147], a[72:75], v[144:147]
    buffer_load_dwordx4 v7, s[72:75], s77 offen lds
    v_mfma_f32_16x16x32_bf16 v[144:147], a[148:151], a[88:91], v[144:147]
    s_add_u32 s77, s77, s76
    v_mfma_f32_16x16x32_bf16 v[144:147], a[152:155], a[104:107], v[144:147]
    v_mfma_f32_16x16x32_bf16 v[144:147], a[156:159], a[120:123], v[144:147]
    v_cvt_pk_bf16_f32 v166, v136, v137
    v_cvt_pk_bf16_f32 v167, v138, v139
    v_mfma_f32_16x16x32_bf16 v[148:151], a[144:147], a[76:79], v[148:151]
    v_mfma_f32_16x16x32_bf16 v[148:151], a[148:151], a[92:95], v[148:151]
    v_permlane16_swap_b32 v164, v166
    v_permlane16_swap_b32 v165, v167
    v_mfma_f32_16x16x32_bf16 v[148:151], a[152:155], a[108:111], v[148:151]
    v_cvt_pk_bf16_f32 v182, v140, v141
    v_cvt_pk_bf16_f32 v183, v142, v143
    v_mfma_f32_16x16x32_bf16 v[148:151], a[156:159], a[124:127], v[148:151]
    v_mfma_f32_16x16x32_bf16 v[216:219], a[192:195], v[152:155], 0
    v_permlane16_swap_b32 v180, v182
    v_permlane16_swap_b32 v181, v183
    v_mfma_f32_16x16x32_bf16 v[216:219], a[196:199], v[156:159], v[216:219]
    v_cvt_pk_bf16_f32 v198, v144, v145
    v_cvt_pk_bf16_f32 v199, v146, v147
    v_mfma_f32_16x16x32_bf16 v[216:219], a[200:203], v[160:163], v[216:219]
    v_mfma_f32_16x16x32_bf16 v[220:223], a[192:195], v[168:171], 0
    v_permlane16_swap_b32 v196, v198
    v_permlane16_swap_b32 v197, v199
    v_mfma_f32_16x16x32_bf16 v[220:223], a[196:199], v[172:175], v[220:223]
    v_mfma_f32_16x16x32_bf16 v[220:223], a[200:203], v[176:179], v[220:223]
    v_cvt_pk_bf16_f32 v214, v148, v149
    v_cvt_pk_bf16_f32 v215, v150, v151
    v_mfma_f32_16x16x32_bf16 v[224:227], a[192:195], v[184:187], 0
    v_mfma_f32_16x16x32_bf16 v[224:227], a[196:199], v[188:191], v[224:227]
    v_permlane16_swap_b32 v212, v214
    v_permlane16_swap_b32 v213, v215
    v_mfma_f32_16x16x32_bf16 v[224:227], a[200:203], v[192:195], v[224:227]
    v_mfma_f32_16x16x32_bf16 v[228:231], a[192:195], v[200:203], 0
    v_mfma_f32_16x16x32_bf16 v[228:231], a[196:199], v[204:207], v[228:231]
    v_mfma_f32_16x16x32_bf16 v[228:231], a[200:203], v[208:211], v[228:231]
    v_mfma_f32_16x16x32_bf16 v[216:219], a[204:207], v[164:167], v[216:219]
    v_mfma_f32_16x16x32_bf16 v[220:223], a[204:207], v[180:183], v[220:223]
    v_mfma_f32_16x16x32_bf16 v[224:227], a[204:207], v[196:199], v[224:227]
    v_mfma_f32_16x16x32_bf16 v[228:231], a[204:207], v[212:215], v[228:231]
    s_nop 4
    v_max3_f32 v16, v216, v217, v218
    v_max_f32 v16, v16, v219
    v_mov_b32 v20, v16
    v_max3_f32 v17, v220, v221, v222
    v_max_f32 v17, v17, v223
    v_permlane32_swap_b32 v16, v20
    v_max_f32 v16, v16, v20
    v_mov_b32 v20, v16
    v_max3_f32 v18, v224, v225, v226
    v_max_f32 v18, v18, v227
    v_permlane16_swap_b32 v16, v20
    v_max_f32 v16, v16, v20
    v_max3_f32 v19, v228, v229, v230
    v_max_f32 v19, v19, v231
L_att_setc:
    v_sub_f32 v240, 0, v16
    v_sub_f32 v241, 0, v16
    v_sub_f32 v242, 0, v16
    v_sub_f32 v243, 0, v16
    v_mov_b32 v232, v17
    v_mov_b32 v233, v18
    v_mfma_f32_16x16x32_bf16 v[216:219], a[192:195], v[152:155], v[240:243]
    v_mov_b32 v234, v19
    v_permlane32_swap_b32 v17, v232
    v_permlane32_swap_b32 v18, v233
    v_permlane32_swap_b32 v19, v234
    v_mfma_f32_16x16x32_bf16 v[216:219], a[196:199], v[156:159], v[216:219]
    v_max_f32 v17, v17, v232
    v_max_f32 v18, v18, v233
    v_max_f32 v19, v19, v234
    v_mfma_f32_16x16x32_bf16 v[216:219], a[200:203], v[160:163], v[216:219]
    v_mov_b32 v232, v17
    v_mov_b32 v233, v18
    v_mov_b32 v234, v19
    v_permlane16_swap_b32 v17, v232
    v_mfma_f32_16x16x32_bf16 v[216:219], a[204:207], v[164:167], v[216:219]
    v_permlane16_swap_b32 v18, v233
    v_permlane16_swap_b32 v19, v234
    v_max_f32 v17, v17, v232
    v_mfma_f32_16x16x32_bf16 v[220:223], a[208:211], v[152:155], v[240:243]
    v_max_f32 v18, v18, v233
    v_max_f32 v19, v19, v234
    v_sub_f32 v244, 0, v17
    v_sub_f32 v245, 0, v17
    v_mfma_f32_16x16x32_bf16 v[220:223], a[212:215], v[156:159], v[220:223]
    v_sub_f32 v246, 0, v17
    v_sub_f32 v247, 0, v17
    v_sub_f32 v248, 0, v18
    v_mfma_f32_16x16x32_bf16 v[220:223], a[216:219], v[160:163], v[220:223]
    v_sub_f32 v249, 0, v18
    v_sub_f32 v250, 0, v18
    v_sub_f32 v251, 0, v18
    v_sub_f32 v252, 0, v19
    v_mfma_f32_16x16x32_bf16 v[220:223], a[220:223], v[164:167], v[220:223]
    v_sub_f32 v253, 0, v19
    v_sub_f32 v254, 0, v19
    v_sub_f32 v255, 0, v19
    v_mfma_f32_16x16x32_bf16 v[224:227], a[192:195], v[168:171], v[244:247]
    s_waitcnt vmcnt(13)
    s_barrier
    v_mfma_f32_16x16x32_bf16 v[224:227], a[196:199], v[172:175], v[224:227]
    ds_read_b64_tr_b16 a[224:225], v4 offset:17408
    ds_read_b64_tr_b16 a[226:227], v4 offset:17920
    v_exp_f32 v216, v216
    v_mfma_f32_16x16x32_bf16 v[224:227], a[200:203], v[176:179], v[224:227]
    ds_read_b64_tr_b16 a[228:229], v4 offset:17440
    ds_read_b64_tr_b16 a[230:231], v4 offset:17952
    v_exp_f32 v217, v217
    v_mfma_f32_16x16x32_bf16 v[224:227], a[204:207], v[180:183], v[224:227]
    ds_read_b64_tr_b16 a[232:233], v4 offset:17472
    ds_read_b64_tr_b16 a[234:235], v4 offset:17984
    v_exp_f32 v218, v218
    v_mfma_f32_16x16x32_bf16 v[228:231], a[208:211], v[168:171], v[244:247]
    ds_read_b64_tr_b16 a[236:237], v4 offset:17504
    ds_read_b64_tr_b16 a[238:239], v4 offset:18016
    v_exp_f32 v219, v219
    v_cvt_pk_bf16_f32 v232, v216, v217
    v_mfma_f32_16x16x32_bf16 v[228:231], a[212:215], v[172:175], v[228:231]
    v_exp_f32 v220, v220
    v_cvt_pk_bf16_f32 v233, v218, v219
    v_exp_f32 v221, v221
    v_mfma_f32_16x16x32_bf16 v[228:231], a[216:219], v[176:179], v[228:231]
    v_exp_f32 v222, v222
    v_exp_f32 v223, v223
    v_mfma_f32_16x16x32_bf16 v[228:231], a[220:223], v[180:183], v[228:231]
    v_cvt_pk_bf16_f32 v234, v220, v221
    v_cvt_pk_bf16_f32 v235, v222, v223
    v_mfma_f32_16x16x32_bf16 v[216:219], a[192:195], v[184:187], v[248:251]
    s_add_u32 m0, s52, 42912
    ds_read_b64_tr_b16 a[240:241], v4 offset:17536
    ds_read_b64_tr_b16 a[242:243], v4 offset:18048
    v_mfma_f32_16x16x32_bf16 v[216:219], a[196:199], v[188:191], v[216:219]
    buffer_load_dwordx4 v6, s[16:19], s47 offen lds
    v_mfma_f32_16x16x32_bf16 v[216:219], a[200:203], v[192:195], v[216:219]
    v_exp_f32 v224, v224
    v_mfma_f32_16x16x32_bf16 v[216:219], a[204:207], v[196:199], v[216:219]
    ds_read_b64_tr_b16 a[244:245], v4 offset:17568
    ds_read_b64_tr_b16 a[246:247], v4 offset:18080
    v_mfma_f32_16x16x32_bf16 v[220:223], a[208:211], v[184:187], v[248:251]
    v_exp_f32 v225, v225
    v_mfma_f32_16x16x32_bf16 v[220:223], a[212:215], v[188:191], v[220:223]
    ds_read_b64_tr_b16 a[248:249], v4 offset:17600
    ds_read_b64_tr_b16 a[250:251], v4 offset:18112
    v_mfma_f32_16x16x32_bf16 v[220:223], a[216:219], v[192:195], v[220:223]
    s_add_u32 m0, s52, 43712
    v_exp_f32 v226, v226
    v_mfma_f32_16x16x32_bf16 v[220:223], a[220:223], v[196:199], v[220:223]
    s_waitcnt lgkmcnt(10)
    ds_read_b64_tr_b16 a[252:253], v4 offset:17632
    ds_read_b64_tr_b16 a[254:255], v4 offset:18144
    v_mfma_f32_16x16x32_bf16 v[24:27], a[224:227], v[232:235], 0
    buffer_load_dwordx4 v6, s[16:19], s47 offen offset:256 lds
    v_mfma_f32_16x16x32_bf16 v[40:43], a[228:231], v[232:235], 0
    s_waitcnt lgkmcnt(8)
    v_exp_f32 v227, v227
    v_mfma_f32_16x16x32_bf16 v[56:59], a[232:235], v[232:235], 0
    s_add_u32 s60, s60, 8192
    v_exp_f32 v228, v228
    v_mfma_f32_16x16x32_bf16 v[72:75], a[236:239], v[232:235], 0
    s_waitcnt lgkmcnt(4)
    v_cvt_pk_bf16_f32 v236, v224, v225
    v_cvt_pk_bf16_f32 v237, v226, v227
    v_mfma_f32_16x16x32_bf16 v[88:91], a[240:243], v[232:235], 0
    s_and_b32 s60, s60, 0x1ffff
    v_exp_f32 v229, v229
    v_mfma_f32_16x16x32_bf16 v[104:107], a[244:247], v[232:235], 0
    s_waitcnt lgkmcnt(0)
    v_exp_f32 v230, v230
    v_mfma_f32_16x16x32_bf16 v[120:123], a[248:251], v[232:235], 0
    s_add_u32 s47, s44, s60
    v_exp_f32 v231, v231
    v_mfma_f32_16x16x32_bf16 v[136:139], a[252:255], v[232:235], 0
    v_cvt_pk_bf16_f32 v238, v228, v229
    v_cvt_pk_bf16_f32 v239, v230, v231
    v_mfma_f32_16x16x32_bf16 a[160:163], a[176:179], v[232:235], 0
    s_add_u32 m0, s51, 0
    v_mfma_f32_16x16x32_bf16 v[224:227], a[192:195], v[200:203], v[252:255]
    buffer_load_dwordx4 v5, s[12:15], s46 offen lds
    v_mfma_f32_16x16x32_bf16 v[224:227], a[196:199], v[204:207], v[224:227]
    v_exp_f32 v216, v216
    v_mfma_f32_16x16x32_bf16 v[224:227], a[200:203], v[208:211], v[224:227]
    v_exp_f32 v217, v217
    v_mfma_f32_16x16x32_bf16 v[224:227], a[204:207], v[212:215], v[224:227]
    ds_read_b128 a[192:195], v3 offset:8704
    ds_read_b128 a[196:199], v3 offset:8768
    v_mfma_f32_16x16x32_bf16 v[228:231], a[208:211], v[200:203], v[252:255]
    v_exp_f32 v218, v218
    v_mfma_f32_16x16x32_bf16 v[228:231], a[212:215], v[204:207], v[228:231]
    v_exp_f32 v219, v219
    v_mfma_f32_16x16x32_bf16 v[228:231], a[216:219], v[208:211], v[228:231]
    s_add_u32 m0, s51, 832
    ds_read_b128 a[200:203], v3 offset:8832
    ds_read_b128 a[204:207], v3 offset:8896
    v_mfma_f32_16x16x32_bf16 v[228:231], a[220:223], v[212:215], v[228:231]
    buffer_load_dwordx4 v5, s[12:15], s46 offen offset:256 lds
    v_mfma_f32_16x16x32_bf16 v[28:31], a[224:227], v[236:239], 0
    s_add_u32 s59, s59, 8192
    v_cvt_pk_bf16_f32 v232, v216, v217
    v_cvt_pk_bf16_f32 v233, v218, v219
    v_mfma_f32_16x16x32_bf16 v[44:47], a[228:231], v[236:239], 0
    s_and_b32 s59, s59, 0x1ffff
    v_exp_f32 v220, v220
    v_mfma_f32_16x16x32_bf16 v[60:63], a[232:235], v[236:239], 0
    s_add_u32 s46, s44, s59
    ds_read_b128 a[208:211], v3 offset:13056
    ds_read_b128 a[212:215], v3 offset:13120
    v_mfma_f32_16x16x32_bf16 v[76:79], a[236:239], v[236:239], 0
    v_exp_f32 v221, v221
    v_mfma_f32_16x16x32_bf16 v[92:95], a[240:243], v[236:239], 0
    v_exp_f32 v222, v222
    v_mfma_f32_16x16x32_bf16 v[108:111], a[244:247], v[236:239], 0
    v_exp_f32 v223, v223
    v_mfma_f32_16x16x32_bf16 v[124:127], a[248:251], v[236:239], 0
    ds_read_b128 a[216:219], v3 offset:13184
    ds_read_b128 a[220:223], v3 offset:13248
    v_mfma_f32_16x16x32_bf16 v[140:143], a[252:255], v[236:239], 0
    s_waitcnt vmcnt(4)
    ds_read_b64_tr_b16 a[0:1], v8 offset:0
    ds_read_b64_tr_b16 a[2:3], v8 offset:512
    v_mfma_f32_16x16x32_bf16 a[164:167], a[176:179], v[236:239], 0
    s_waitcnt lgkmcnt(8)
    v_cvt_pk_bf16_f32 v234, v220, v221
    v_cvt_pk_bf16_f32 v235, v222, v223
    v_mfma_f32_16x16x32_bf16 v[216:219], a[192:195], v[152:155], v[240:243]
    v_exp_f32 v224, v224
    v_mfma_f32_16x16x32_bf16 v[216:219], a[196:199], v[156:159], v[216:219]
    s_waitcnt lgkmcnt(6)
    v_exp_f32 v225, v225
    v_mfma_f32_16x16x32_bf16 v[216:219], a[200:203], v[160:163], v[216:219]
    v_exp_f32 v226, v226
    v_mfma_f32_16x16x32_bf16 v[216:219], a[204:207], v[164:167], v[216:219]
    s_waitcnt lgkmcnt(4)
    v_exp_f32 v227, v227
    v_mfma_f32_16x16x32_bf16 v[220:223], a[208:211], v[152:155], v[240:243]
    v_cvt_pk_bf16_f32 v236, v224, v225
    v_cvt_pk_bf16_f32 v237, v226, v227
    v_mfma_f32_16x16x32_bf16 v[220:223], a[212:215], v[156:159], v[220:223]
    s_waitcnt lgkmcnt(2)
    ds_read_b64_tr_b16 a[4:5], v8 offset:32
    ds_read_b64_tr_b16 a[6:7], v8 offset:544
    v_mfma_f32_16x16x32_bf16 v[220:223], a[216:219], v[160:163], v[220:223]
    ds_read_b64_tr_b16 a[8:9], v8 offset:64
    ds_read_b64_tr_b16 a[10:11], v8 offset:576
    v_mfma_f32_16x16x32_bf16 v[220:223], a[220:223], v[164:167], v[220:223]
    v_exp_f32 v228, v228
    v_mfma_f32_16x16x32_bf16 v[32:35], a[224:227], v[232:235], 0
    v_exp_f32 v229, v229
    v_mfma_f32_16x16x32_bf16 v[48:51], a[228:231], v[232:235], 0
    v_exp_f32 v230, v230
    v_mfma_f32_16x16x32_bf16 v[64:67], a[232:235], v[232:235], 0
    v_exp_f32 v231, v231
    v_mfma_f32_16x16x32_bf16 v[80:83], a[236:239], v[232:235], 0
    v_cvt_pk_bf16_f32 v238, v228, v229
    v_cvt_pk_bf16_f32 v239, v230, v231
    v_mfma_f32_16x16x32_bf16 v[96:99], a[240:243], v[232:235], 0
    ds_read_b64_tr_b16 a[12:13], v8 offset:96
    ds_read_b64_tr_b16 a[14:15], v8 offset:608
    v_mfma_f32_16x16x32_bf16 v[112:115], a[244:247], v[232:235], 0
    ds_read_b64_tr_b16 a[16:17], v8 offset:128
    ds_read_b64_tr_b16 a[18:19], v8 offset:640
    v_mfma_f32_16x16x32_bf16 v[128:131], a[248:251], v[232:235], 0
    ds_read_b64_tr_b16 a[20:21], v8 offset:160
    ds_read_b64_tr_b16 a[22:23], v8 offset:672
    v_mfma_f32_16x16x32_bf16 v[144:147], a[252:255], v[232:235], 0
    ds_read_b64_tr_b16 a[24:25], v8 offset:192
    ds_read_b64_tr_b16 a[26:27], v8 offset:704
    v_mfma_f32_16x16x32_bf16 a[168:171], a[176:179], v[232:235], 0
    ds_read_b64_tr_b16 a[28:29], v8 offset:224
    ds_read_b64_tr_b16 a[30:31], v8 offset:736
    v_mfma_f32_16x16x32_bf16 v[224:227], a[192:195], v[168:171], v[244:247]
    s_waitcnt lgkmcnt(0)
    s_barrier
    v_mfma_f32_16x16x32_bf16 v[224:227], a[196:199], v[172:175], v[224:227]
    v_exp_f32 v216, v216
    v_mfma_f32_16x16x32_bf16 v[224:227], a[200:203], v[176:179], v[224:227]
    v_exp_f32 v217, v217
    v_mfma_f32_16x16x32_bf16 v[224:227], a[204:207], v[180:183], v[224:227]
    v_exp_f32 v218, v218
    v_mfma_f32_16x16x32_bf16 v[228:231], a[208:211], v[168:171], v[244:247]
    v_exp_f32 v219, v219
    v_mfma_f32_16x16x32_bf16 v[228:231], a[212:215], v[172:175], v[228:231]
    v_cvt_pk_bf16_f32 v232, v216, v217
    v_cvt_pk_bf16_f32 v233, v218, v219
    v_mfma_f32_16x16x32_bf16 v[228:231], a[216:219], v[176:179], v[228:231]
    s_add_u32 m0, s52, 17408
    v_mfma_f32_16x16x32_bf16 v[228:231], a[220:223], v[180:183], v[228:231]
    buffer_load_dwordx4 v6, s[16:19], s47 offen lds
    v_mfma_f32_16x16x32_bf16 v[36:39], a[224:227], v[236:239], 0
    v_exp_f32 v220, v220
    v_mfma_f32_16x16x32_bf16 v[52:55], a[228:231], v[236:239], 0
    ds_read_b64_tr_b16 a[224:225], v4 offset:34496
    ds_read_b64_tr_b16 a[226:227], v4 offset:35008
    v_mfma_f32_16x16x32_bf16 v[68:71], a[232:235], v[236:239], 0
    v_exp_f32 v221, v221
    v_mfma_f32_16x16x32_bf16 v[84:87], a[236:239], v[236:239], 0
    ds_read_b64_tr_b16 a[228:229], v4 offset:34528
    ds_read_b64_tr_b16 a[230:231], v4 offset:35040
    v_mfma_f32_16x16x32_bf16 v[100:103], a[240:243], v[236:239], 0
    buffer_store_dwordx4 a[0:3], v2, s[24:27], s6 offen sc1
    v_exp_f32 v222, v222
    v_mfma_f32_16x16x32_bf16 v[116:119], a[244:247], v[236:239], 0
    s_add_u32 s6, s6, s7
    ds_read_b64_tr_b16 a[232:233], v4 offset:34560
    ds_read_b64_tr_b16 a[234:235], v4 offset:35072
    v_mfma_f32_16x16x32_bf16 v[132:135], a[248:251], v[236:239], 0
    v_exp_f32 v223, v223
    v_mfma_f32_16x16x32_bf16 v[148:151], a[252:255], v[236:239], 0
    ds_read_b64_tr_b16 a[236:237], v4 offset:34592
    ds_read_b64_tr_b16 a[238:239], v4 offset:35104
    v_mfma_f32_16x16x32_bf16 a[172:175], a[176:179], v[236:239], 0
    v_cvt_pk_bf16_f32 v234, v220, v221
    v_cvt_pk_bf16_f32 v235, v222, v223
    v_mfma_f32_16x16x32_bf16 v[216:219], a[192:195], v[184:187], v[248:251]
    s_add_u32 m0, s52, 18208
    ds_read_b64_tr_b16 a[240:241], v4 offset:34624
    ds_read_b64_tr_b16 a[242:243], v4 offset:35136
    v_mfma_f32_16x16x32_bf16 v[216:219], a[196:199], v[188:191], v[216:219]
    buffer_load_dwordx4 v6, s[16:19], s47 offen offset:256 lds
    v_mfma_f32_16x16x32_bf16 v[216:219], a[200:203], v[192:195], v[216:219]
    s_add_u32 s60, s60, 8192
    v_exp_f32 v224, v224
    v_mfma_f32_16x16x32_bf16 v[216:219], a[204:207], v[196:199], v[216:219]
    s_and_b32 s60, s60, 0x1ffff
    ds_read_b64_tr_b16 a[244:245], v4 offset:34656
    ds_read_b64_tr_b16 a[246:247], v4 offset:35168
    v_mfma_f32_16x16x32_bf16 v[220:223], a[208:211], v[184:187], v[248:251]
    s_add_u32 s47, s44, s60
    v_exp_f32 v225, v225
    v_mfma_f32_16x16x32_bf16 v[220:223], a[212:215], v[188:191], v[220:223]
    s_add_u32 m0, s4, 51328
    ds_read_b64_tr_b16 a[248:249], v4 offset:34688
    ds_read_b64_tr_b16 a[250:251], v4 offset:35200
    v_mfma_f32_16x16x32_bf16 v[220:223], a[216:219], v[192:195], v[220:223]
    buffer_load_dwordx4 v9, s[20:23], s67 offen offset:0 lds
    v_exp_f32 v226, v226
    v_mfma_f32_16x16x32_bf16 v[220:223], a[220:223], v[196:199], v[220:223]
    s_waitcnt lgkmcnt(10)
    s_add_u32 m0, s51, 8704
    ds_read_b64_tr_b16 a[252:253], v4 offset:34720
    ds_read_b64_tr_b16 a[254:255], v4 offset:35232
    v_mfma_f32_16x16x32_bf16 v[24:27], a[224:227], v[232:235], v[24:27]
    buffer_load_dwordx4 v5, s[12:15], s46 offen lds
    v_mfma_f32_16x16x32_bf16 v[40:43], a[228:231], v[232:235], v[40:43]
    s_waitcnt lgkmcnt(8)
    v_exp_f32 v227, v227
    v_mfma_f32_16x16x32_bf16 v[56:59], a[232:235], v[232:235], v[56:59]
    v_exp_f32 v228, v228
    v_mfma_f32_16x16x32_bf16 v[72:75], a[236:239], v[232:235], v[72:75]
    s_waitcnt lgkmcnt(4)
    v_cvt_pk_bf16_f32 v236, v224, v225
    v_cvt_pk_bf16_f32 v237, v226, v227
    v_mfma_f32_16x16x32_bf16 v[88:91], a[240:243], v[232:235], v[88:91]
    v_exp_f32 v229, v229
    v_mfma_f32_16x16x32_bf16 v[104:107], a[244:247], v[232:235], v[104:107]
    s_waitcnt lgkmcnt(0)
    v_exp_f32 v230, v230
    v_mfma_f32_16x16x32_bf16 v[120:123], a[248:251], v[232:235], v[120:123]
    v_exp_f32 v231, v231
    v_mfma_f32_16x16x32_bf16 v[136:139], a[252:255], v[232:235], v[136:139]
    v_cvt_pk_bf16_f32 v238, v228, v229
    v_cvt_pk_bf16_f32 v239, v230, v231
    v_mfma_f32_16x16x32_bf16 a[160:163], a[176:179], v[232:235], a[160:163]
    s_add_u32 m0, s51, 9536
    v_mfma_f32_16x16x32_bf16 v[224:227], a[192:195], v[200:203], v[252:255]
    buffer_load_dwordx4 v5, s[12:15], s46 offen offset:256 lds
    v_mfma_f32_16x16x32_bf16 v[224:227], a[196:199], v[204:207], v[224:227]
    s_add_u32 s59, s59, 8192
    v_exp_f32 v216, v216
    v_mfma_f32_16x16x32_bf16 v[224:227], a[200:203], v[208:211], v[224:227]
    s_and_b32 s59, s59, 0x1ffff
    v_exp_f32 v217, v217
    v_mfma_f32_16x16x32_bf16 v[224:227], a[204:207], v[212:215], v[224:227]
    s_add_u32 s46, s44, s59
    ds_read_b128 a[192:195], v3 offset:25856
    ds_read_b128 a[196:199], v3 offset:25920
    v_mfma_f32_16x16x32_bf16 v[228:231], a[208:211], v[200:203], v[252:255]
    v_exp_f32 v218, v218
    v_mfma_f32_16x16x32_bf16 v[228:231], a[212:215], v[204:207], v[228:231]
    v_exp_f32 v219, v219
    v_mfma_f32_16x16x32_bf16 v[228:231], a[216:219], v[208:211], v[228:231]
    ds_read_b128 a[200:203], v3 offset:25984
    ds_read_b128 a[204:207], v3 offset:26048
    v_mfma_f32_16x16x32_bf16 v[228:231], a[220:223], v[212:215], v[228:231]
    buffer_store_dwordx4 a[4:7], v2, s[24:27], s6 offen sc1
    v_mfma_f32_16x16x32_bf16 v[28:31], a[224:227], v[236:239], v[28:31]
    s_add_u32 s6, s6, s7
    v_cvt_pk_bf16_f32 v232, v216, v217
    v_cvt_pk_bf16_f32 v233, v218, v219
    v_mfma_f32_16x16x32_bf16 v[44:47], a[228:231], v[236:239], v[44:47]
    v_exp_f32 v220, v220
    v_mfma_f32_16x16x32_bf16 v[60:63], a[232:235], v[236:239], v[60:63]
    s_add_u32 m0, s4, 51360
    ds_read_b128 a[208:211], v3 offset:30208
    ds_read_b128 a[212:215], v3 offset:30272
    v_mfma_f32_16x16x32_bf16 v[76:79], a[236:239], v[236:239], v[76:79]
    buffer_load_dwordx4 v9, s[20:23], s67 offen offset:1024 lds
    v_exp_f32 v221, v221
    v_mfma_f32_16x16x32_bf16 v[92:95], a[240:243], v[236:239], v[92:95]
    v_exp_f32 v222, v222
    v_mfma_f32_16x16x32_bf16 v[108:111], a[244:247], v[236:239], v[108:111]
    v_exp_f32 v223, v223
    v_mfma_f32_16x16x32_bf16 v[124:127], a[248:251], v[236:239], v[124:127]
    ds_read_b128 a[216:219], v3 offset:30336
    ds_read_b128 a[220:223], v3 offset:30400
    v_mfma_f32_16x16x32_bf16 v[140:143], a[252:255], v[236:239], v[140:143]
    buffer_store_dwordx4 a[8:11], v2, s[24:27], s6 offen sc1
    v_mfma_f32_16x16x32_bf16 a[164:167], a[176:179], v[236:239], a[164:167]
    s_waitcnt lgkmcnt(6)
    v_cvt_pk_bf16_f32 v234, v220, v221
    v_cvt_pk_bf16_f32 v235, v222, v223
    v_mfma_f32_16x16x32_bf16 v[216:219], a[192:195], v[152:155], v[240:243]
    s_add_u32 s6, s6, s7
    v_exp_f32 v224, v224
    v_mfma_f32_16x16x32_bf16 v[216:219], a[196:199], v[156:159], v[216:219]
    s_waitcnt lgkmcnt(4)
    v_exp_f32 v225, v225
    v_mfma_f32_16x16x32_bf16 v[216:219], a[200:203], v[160:163], v[216:219]
    v_exp_f32 v226, v226
    v_mfma_f32_16x16x32_bf16 v[216:219], a[204:207], v[164:167], v[216:219]
    s_waitcnt lgkmcnt(2)
    v_exp_f32 v227, v227
    v_mfma_f32_16x16x32_bf16 v[220:223], a[208:211], v[152:155], v[240:243]
    v_cvt_pk_bf16_f32 v236, v224, v225
    v_cvt_pk_bf16_f32 v237, v226, v227
    v_mfma_f32_16x16x32_bf16 v[220:223], a[212:215], v[156:159], v[220:223]
    s_waitcnt lgkmcnt(0)
    v_mfma_f32_16x16x32_bf16 v[220:223], a[216:219], v[160:163], v[220:223]
    buffer_store_dwordx4 a[12:15], v2, s[24:27], s6 offen sc1
    v_mfma_f32_16x16x32_bf16 v[220:223], a[220:223], v[164:167], v[220:223]
    s_add_u32 s6, s6, s43
    v_exp_f32 v228, v228
    v_mfma_f32_16x16x32_bf16 v[32:35], a[224:227], v[232:235], v[32:35]
    v_exp_f32 v229, v229
    v_mfma_f32_16x16x32_bf16 v[48:51], a[228:231], v[232:235], v[48:51]
    v_exp_f32 v230, v230
    v_mfma_f32_16x16x32_bf16 v[64:67], a[232:235], v[232:235], v[64:67]
    v_exp_f32 v231, v231
    v_mfma_f32_16x16x32_bf16 v[80:83], a[236:239], v[232:235], v[80:83]
    v_cvt_pk_bf16_f32 v238, v228, v229
    v_cvt_pk_bf16_f32 v239, v230, v231
    v_mfma_f32_16x16x32_bf16 v[96:99], a[240:243], v[232:235], v[96:99]
    s_add_u32 m0, s4, 51392
    v_add_u32 v7, 152576, v4
    v_mfma_f32_16x16x32_bf16 v[112:115], a[244:247], v[232:235], v[112:115]
    buffer_load_dwordx4 v9, s[20:23], s67 offen offset:2048 lds
    v_mfma_f32_16x16x32_bf16 v[128:131], a[248:251], v[232:235], v[128:131]
    v_mfma_f32_16x16x32_bf16 v[144:147], a[252:255], v[232:235], v[144:147]
    v_mfma_f32_16x16x32_bf16 a[168:171], a[176:179], v[232:235], a[168:171]
    s_add_u32 m0, s4, 51424
    buffer_store_dwordx4 a[16:19], v2, s[24:27], s6 offen sc1
    v_mfma_f32_16x16x32_bf16 v[224:227], a[192:195], v[168:171], v[244:247]
    s_waitcnt vmcnt(12)
    s_barrier
    v_mfma_f32_16x16x32_bf16 v[224:227], a[196:199], v[172:175], v[224:227]
    s_add_u32 s6, s6, s7
    buffer_load_dwordx4 v9, s[20:23], s67 offen offset:3072 lds
    v_exp_f32 v216, v216
    v_mfma_f32_16x16x32_bf16 v[224:227], a[200:203], v[176:179], v[224:227]
    v_exp_f32 v217, v217
    v_mfma_f32_16x16x32_bf16 v[224:227], a[204:207], v[180:183], v[224:227]
    v_exp_f32 v218, v218
    v_mfma_f32_16x16x32_bf16 v[228:231], a[208:211], v[168:171], v[244:247]
    v_exp_f32 v219, v219
    v_mfma_f32_16x16x32_bf16 v[228:231], a[212:215], v[172:175], v[228:231]
    v_cvt_pk_bf16_f32 v232, v216, v217
    v_cvt_pk_bf16_f32 v233, v218, v219
    v_mfma_f32_16x16x32_bf16 v[228:231], a[216:219], v[176:179], v[228:231]
    s_add_u32 m0, s52, 34496
    v_mfma_f32_16x16x32_bf16 v[228:231], a[220:223], v[180:183], v[228:231]
    buffer_load_dwordx4 v6, s[16:19], s47 offen lds
    v_mfma_f32_16x16x32_bf16 v[36:39], a[224:227], v[236:239], v[36:39]
    v_exp_f32 v220, v220
    v_mfma_f32_16x16x32_bf16 v[52:55], a[228:231], v[236:239], v[52:55]
    ds_read_b64_tr_b16 a[224:225], v4 offset:42912
    ds_read_b64_tr_b16 a[226:227], v4 offset:43424
    v_mfma_f32_16x16x32_bf16 v[68:71], a[232:235], v[236:239], v[68:71]
    v_exp_f32 v221, v221
    v_mfma_f32_16x16x32_bf16 v[84:87], a[236:239], v[236:239], v[84:87]
    ds_read_b64_tr_b16 a[228:229], v4 offset:42944
    ds_read_b64_tr_b16 a[230:231], v4 offset:43456
    v_mfma_f32_16x16x32_bf16 v[100:103], a[240:243], v[236:239], v[100:103]
    buffer_store_dwordx4 a[20:23], v2, s[24:27], s6 offen sc1
    v_exp_f32 v222, v222
    v_mfma_f32_16x16x32_bf16 v[116:119], a[244:247], v[236:239], v[116:119]
    s_add_u32 s6, s6, s7
    ds_read_b64_tr_b16 a[232:233], v4 offset:42976
    ds_read_b64_tr_b16 a[234:235], v4 offset:43488
    v_mfma_f32_16x16x32_bf16 v[132:135], a[248:251], v[236:239], v[132:135]
    v_exp_f32 v223, v223
    v_mfma_f32_16x16x32_bf16 v[148:151], a[252:255], v[236:239], v[148:151]
    ds_read_b64_tr_b16 a[236:237], v4 offset:43008
    ds_read_b64_tr_b16 a[238:239], v4 offset:43520
    v_mfma_f32_16x16x32_bf16 a[172:175], a[176:179], v[236:239], a[172:175]
    v_cvt_pk_bf16_f32 v234, v220, v221
    v_cvt_pk_bf16_f32 v235, v222, v223
    v_mfma_f32_16x16x32_bf16 v[216:219], a[192:195], v[184:187], v[248:251]
    s_add_u32 m0, s52, 35296
    ds_read_b64_tr_b16 a[240:241], v4 offset:43040
    ds_read_b64_tr_b16 a[242:243], v4 offset:43552
    v_mfma_f32_16x16x32_bf16 v[216:219], a[196:199], v[188:191], v[216:219]
    buffer_load_dwordx4 v6, s[16:19], s47 offen offset:256 lds
    v_mfma_f32_16x16x32_bf16 v[216:219], a[200:203], v[192:195], v[216:219]
    s_add_u32 s60, s60, 8192
    v_exp_f32 v224, v224
    v_mfma_f32_16x16x32_bf16 v[216:219], a[204:207], v[196:199], v[216:219]
    s_and_b32 s60, s60, 0x1ffff
    ds_read_b64_tr_b16 a[244:245], v4 offset:43072
    ds_read_b64_tr_b16 a[246:247], v4 offset:43584
    v_mfma_f32_16x16x32_bf16 v[220:223], a[208:211], v[184:187], v[248:251]
    s_add_u32 s47, s44, s60
    v_exp_f32 v225, v225
    v_mfma_f32_16x16x32_bf16 v[220:223], a[212:215], v[188:191], v[220:223]
    s_add_u32 m0, s4, 55552
    ds_read_b64_tr_b16 a[248:249], v4 offset:43104
    ds_read_b64_tr_b16 a[250:251], v4 offset:43616
    v_mfma_f32_16x16x32_bf16 v[220:223], a[216:219], v[192:195], v[220:223]
    buffer_load_dwordx4 v9, s[20:23], s5 offen offset:0 lds
    v_exp_f32 v226, v226
    v_mfma_f32_16x16x32_bf16 v[220:223], a[220:223], v[196:199], v[220:223]
    s_waitcnt lgkmcnt(10)
    s_add_u32 m0, s51, 25856
    ds_read_b64_tr_b16 a[252:253], v4 offset:43136
    ds_read_b64_tr_b16 a[254:255], v4 offset:43648
    v_mfma_f32_16x16x32_bf16 v[24:27], a[224:227], v[232:235], v[24:27]
    buffer_load_dwordx4 v5, s[12:15], s46 offen lds
    v_mfma_f32_16x16x32_bf16 v[40:43], a[228:231], v[232:235], v[40:43]
    s_waitcnt lgkmcnt(8)
    v_exp_f32 v227, v227
    v_mfma_f32_16x16x32_bf16 v[56:59], a[232:235], v[232:235], v[56:59]
    v_exp_f32 v228, v228
    v_mfma_f32_16x16x32_bf16 v[72:75], a[236:239], v[232:235], v[72:75]
    s_waitcnt lgkmcnt(4)
    v_cvt_pk_bf16_f32 v236, v224, v225
    v_cvt_pk_bf16_f32 v237, v226, v227
    v_mfma_f32_16x16x32_bf16 v[88:91], a[240:243], v[232:235], v[88:91]
    v_exp_f32 v229, v229
    v_mfma_f32_16x16x32_bf16 v[104:107], a[244:247], v[232:235], v[104:107]
    s_waitcnt lgkmcnt(0)
    v_exp_f32 v230, v230
    v_mfma_f32_16x16x32_bf16 v[120:123], a[248:251], v[232:235], v[120:123]
    v_exp_f32 v231, v231
    v_mfma_f32_16x16x32_bf16 v[136:139], a[252:255], v[232:235], v[136:139]
    v_cvt_pk_bf16_f32 v238, v228, v229
    v_cvt_pk_bf16_f32 v239, v230, v231
    v_mfma_f32_16x16x32_bf16 a[160:163], a[176:179], v[232:235], a[160:163]
    s_add_u32 m0, s51, 26688
    v_mfma_f32_16x16x32_bf16 v[224:227], a[192:195], v[200:203], v[252:255]
    buffer_load_dwordx4 v5, s[12:15], s46 offen offset:256 lds
    v_mfma_f32_16x16x32_bf16 v[224:227], a[196:199], v[204:207], v[224:227]
    s_add_u32 s59, s59, 8192
    v_exp_f32 v216, v216
    v_mfma_f32_16x16x32_bf16 v[224:227], a[200:203], v[208:211], v[224:227]
    s_and_b32 s59, s59, 0x1ffff
    v_exp_f32 v217, v217
    v_mfma_f32_16x16x32_bf16 v[224:227], a[204:207], v[212:215], v[224:227]
    s_add_u32 s46, s44, s59
    ds_read_b128 a[192:195], v3 offset:0
    ds_read_b128 a[196:199], v3 offset:64
    v_mfma_f32_16x16x32_bf16 v[228:231], a[208:211], v[200:203], v[252:255]
    v_exp_f32 v218, v218
    v_mfma_f32_16x16x32_bf16 v[228:231], a[212:215], v[204:207], v[228:231]
    v_exp_f32 v219, v219
    v_mfma_f32_16x16x32_bf16 v[228:231], a[216:219], v[208:211], v[228:231]
    ds_read_b128 a[200:203], v3 offset:128
    ds_read_b128 a[204:207], v3 offset:192
    v_mfma_f32_16x16x32_bf16 v[228:231], a[220:223], v[212:215], v[228:231]
    buffer_store_dwordx4 a[24:27], v2, s[24:27], s6 offen sc1
    v_mfma_f32_16x16x32_bf16 v[28:31], a[224:227], v[236:239], v[28:31]
    s_add_u32 s6, s6, s7
    v_cvt_pk_bf16_f32 v232, v216, v217
    v_cvt_pk_bf16_f32 v233, v218, v219
    v_mfma_f32_16x16x32_bf16 v[44:47], a[228:231], v[236:239], v[44:47]
    v_exp_f32 v220, v220
    v_mfma_f32_16x16x32_bf16 v[60:63], a[232:235], v[236:239], v[60:63]
    ds_read_b128 a[208:211], v3 offset:4352
    ds_read_b128 a[212:215], v3 offset:4416
    v_mfma_f32_16x16x32_bf16 v[76:79], a[236:239], v[236:239], v[76:79]
    buffer_store_dwordx4 a[28:31], v2, s[24:27], s6 offen sc1
    v_exp_f32 v221, v221
    v_mfma_f32_16x16x32_bf16 v[92:95], a[240:243], v[236:239], v[92:95]
    s_add_u32 s6, s6, s7
    v_exp_f32 v222, v222
    v_mfma_f32_16x16x32_bf16 v[108:111], a[244:247], v[236:239], v[108:111]
    v_exp_f32 v223, v223
    v_mfma_f32_16x16x32_bf16 v[124:127], a[248:251], v[236:239], v[124:127]
    s_add_u32 m0, s4, 55584
    ds_read_b128 a[216:219], v3 offset:4480
    ds_read_b128 a[220:223], v3 offset:4544
    v_mfma_f32_16x16x32_bf16 v[140:143], a[252:255], v[236:239], v[140:143]
    buffer_load_dwordx4 v9, s[20:23], s5 offen offset:1024 lds
    v_mfma_f32_16x16x32_bf16 a[164:167], a[176:179], v[236:239], a[164:167]
    s_waitcnt lgkmcnt(6)
    v_cvt_pk_bf16_f32 v234, v220, v221
    v_cvt_pk_bf16_f32 v235, v222, v223
    v_mfma_f32_16x16x32_bf16 v[216:219], a[192:195], v[152:155], v[240:243]
    v_exp_f32 v224, v224
    v_mfma_f32_16x16x32_bf16 v[216:219], a[196:199], v[156:159], v[216:219]
    s_waitcnt lgkmcnt(4)
    v_exp_f32 v225, v225
    v_mfma_f32_16x16x32_bf16 v[216:219], a[200:203], v[160:163], v[216:219]
    v_exp_f32 v226, v226
    v_mfma_f32_16x16x32_bf16 v[216:219], a[204:207], v[164:167], v[216:219]
    s_waitcnt lgkmcnt(2)
    v_exp_f32 v227, v227
    v_mfma_f32_16x16x32_bf16 v[220:223], a[208:211], v[152:155], v[240:243]
    s_add_u32 m0, s4, 55616
    v_cvt_pk_bf16_f32 v236, v224, v225
    v_cvt_pk_bf16_f32 v237, v226, v227
    v_mfma_f32_16x16x32_bf16 v[220:223], a[212:215], v[156:159], v[220:223]
    s_waitcnt lgkmcnt(0)
    v_mfma_f32_16x16x32_bf16 v[220:223], a[216:219], v[160:163], v[220:223]
    buffer_load_dwordx4 v9, s[20:23], s5 offen offset:2048 lds
    v_mfma_f32_16x16x32_bf16 v[220:223], a[220:223], v[164:167], v[220:223]
    v_exp_f32 v228, v228
    v_mfma_f32_16x16x32_bf16 v[32:35], a[224:227], v[232:235], v[32:35]
    v_exp_f32 v229, v229
    v_mfma_f32_16x16x32_bf16 v[48:51], a[228:231], v[232:235], v[48:51]
    v_exp_f32 v230, v230
    v_mfma_f32_16x16x32_bf16 v[64:67], a[232:235], v[232:235], v[64:67]
    v_exp_f32 v231, v231
    v_mfma_f32_16x16x32_bf16 v[80:83], a[236:239], v[232:235], v[80:83]
    v_cvt_pk_bf16_f32 v238, v228, v229
    v_cvt_pk_bf16_f32 v239, v230, v231
    v_mfma_f32_16x16x32_bf16 v[96:99], a[240:243], v[232:235], v[96:99]
    s_add_u32 m0, s4, 55648
    v_mfma_f32_16x16x32_bf16 v[112:115], a[244:247], v[232:235], v[112:115]
    buffer_load_dwordx4 v9, s[20:23], s5 offen offset:3072 lds
    v_mfma_f32_16x16x32_bf16 v[128:131], a[248:251], v[232:235], v[128:131]
    v_mfma_f32_16x16x32_bf16 v[144:147], a[252:255], v[232:235], v[144:147]
    v_mfma_f32_16x16x32_bf16 a[168:171], a[176:179], v[232:235], a[168:171]
    v_mfma_f32_16x16x32_bf16 v[224:227], a[192:195], v[168:171], v[244:247]
    s_waitcnt vmcnt(18)
    s_barrier
    v_mfma_f32_16x16x32_bf16 v[224:227], a[196:199], v[172:175], v[224:227]
    v_exp_f32 v216, v216
    v_mfma_f32_16x16x32_bf16 v[224:227], a[200:203], v[176:179], v[224:227]
    v_exp_f32 v217, v217
    v_mfma_f32_16x16x32_bf16 v[224:227], a[204:207], v[180:183], v[224:227]
    v_exp_f32 v218, v218
    v_mfma_f32_16x16x32_bf16 v[228:231], a[208:211], v[168:171], v[244:247]
    v_exp_f32 v219, v219
    v_mfma_f32_16x16x32_bf16 v[228:231], a[212:215], v[172:175], v[228:231]
    v_cvt_pk_bf16_f32 v232, v216, v217
    v_cvt_pk_bf16_f32 v233, v218, v219
    v_mfma_f32_16x16x32_bf16 v[228:231], a[216:219], v[176:179], v[228:231]
    s_add_u32 m0, s52, 42912
    v_mfma_f32_16x16x32_bf16 v[228:231], a[220:223], v[180:183], v[228:231]
    buffer_load_dwordx4 v6, s[16:19], s47 offen lds
    v_mfma_f32_16x16x32_bf16 v[36:39], a[224:227], v[236:239], v[36:39]
    v_exp_f32 v220, v220
    v_mfma_f32_16x16x32_bf16 v[52:55], a[228:231], v[236:239], v[52:55]
    ds_read_b64_tr_b16 a[224:225], v4 offset:17408
    ds_read_b64_tr_b16 a[226:227], v4 offset:17920
    v_mfma_f32_16x16x32_bf16 v[68:71], a[232:235], v[236:239], v[68:71]
    v_exp_f32 v221, v221
    v_mfma_f32_16x16x32_bf16 v[84:87], a[236:239], v[236:239], v[84:87]
    ds_read_b64_tr_b16 a[228:229], v4 offset:17440
    ds_read_b64_tr_b16 a[230:231], v4 offset:17952
    v_mfma_f32_16x16x32_bf16 v[100:103], a[240:243], v[236:239], v[100:103]
    v_exp_f32 v222, v222
    v_mfma_f32_16x16x32_bf16 v[116:119], a[244:247], v[236:239], v[116:119]
    ds_read_b64_tr_b16 a[232:233], v4 offset:17472
    ds_read_b64_tr_b16 a[234:235], v4 offset:17984
    v_mfma_f32_16x16x32_bf16 v[132:135], a[248:251], v[236:239], v[132:135]
    v_exp_f32 v223, v223
    v_mfma_f32_16x16x32_bf16 v[148:151], a[252:255], v[236:239], v[148:151]
    ds_read_b64_tr_b16 a[236:237], v4 offset:17504
    ds_read_b64_tr_b16 a[238:239], v4 offset:18016
    v_mfma_f32_16x16x32_bf16 a[172:175], a[176:179], v[236:239], a[172:175]
    v_cvt_pk_bf16_f32 v234, v220, v221
    v_cvt_pk_bf16_f32 v235, v222, v223
    v_mfma_f32_16x16x32_bf16 v[216:219], a[192:195], v[184:187], v[248:251]
    s_add_u32 m0, s52, 43712
    ds_read_b64_tr_b16 a[240:241], v4 offset:17536
    ds_read_b64_tr_b16 a[242:243], v4 offset:18048
    v_mfma_f32_16x16x32_bf16 v[216:219], a[196:199], v[188:191], v[216:219]
    buffer_load_dwordx4 v6, s[16:19], s47 offen offset:256 lds
    v_mfma_f32_16x16x32_bf16 v[216:219], a[200:203], v[192:195], v[216:219]
    s_add_u32 s60, s60, 8192
    v_exp_f32 v224, v224
    v_mfma_f32_16x16x32_bf16 v[216:219], a[204:207], v[196:199], v[216:219]
    s_and_b32 s60, s60, 0x1ffff
    ds_read_b64_tr_b16 a[244:245], v4 offset:17568
    ds_read_b64_tr_b16 a[246:247], v4 offset:18080
    v_mfma_f32_16x16x32_bf16 v[220:223], a[208:211], v[184:187], v[248:251]
    s_add_u32 s47, s44, s60
    v_exp_f32 v225, v225
    v_mfma_f32_16x16x32_bf16 v[220:223], a[212:215], v[188:191], v[220:223]
    s_add_u32 m0, s4, 59776
    ds_read_b64_tr_b16 a[248:249], v4 offset:17600
    ds_read_b64_tr_b16 a[250:251], v4 offset:18112
    v_mfma_f32_16x16x32_bf16 v[220:223], a[216:219], v[192:195], v[220:223]
    buffer_load_dwordx4 v9, s[20:23], s57 offen offset:0 lds
    v_exp_f32 v226, v226
    v_mfma_f32_16x16x32_bf16 v[220:223], a[220:223], v[196:199], v[220:223]
    s_waitcnt lgkmcnt(10)
    s_add_u32 m0, s51, 0
    ds_read_b64_tr_b16 a[252:253], v4 offset:17632
    ds_read_b64_tr_b16 a[254:255], v4 offset:18144
    v_mfma_f32_16x16x32_bf16 v[24:27], a[224:227], v[232:235], v[24:27]
    buffer_load_dwordx4 v5, s[12:15], s46 offen lds
    v_mfma_f32_16x16x32_bf16 v[40:43], a[228:231], v[232:235], v[40:43]
    s_waitcnt lgkmcnt(8)
    v_exp_f32 v227, v227
    v_mfma_f32_16x16x32_bf16 v[56:59], a[232:235], v[232:235], v[56:59]
    v_exp_f32 v228, v228
    v_mfma_f32_16x16x32_bf16 v[72:75], a[236:239], v[232:235], v[72:75]
    s_waitcnt lgkmcnt(4)
    v_cvt_pk_bf16_f32 v236, v224, v225
    v_cvt_pk_bf16_f32 v237, v226, v227
    v_mfma_f32_16x16x32_bf16 v[88:91], a[240:243], v[232:235], v[88:91]
    v_exp_f32 v229, v229
    v_mfma_f32_16x16x32_bf16 v[104:107], a[244:247], v[232:235], v[104:107]
    s_waitcnt lgkmcnt(0)
    v_exp_f32 v230, v230
    v_mfma_f32_16x16x32_bf16 v[120:123], a[248:251], v[232:235], v[120:123]
    v_exp_f32 v231, v231
    v_mfma_f32_16x16x32_bf16 v[136:139], a[252:255], v[232:235], v[136:139]
    v_cvt_pk_bf16_f32 v238, v228, v229
    v_cvt_pk_bf16_f32 v239, v230, v231
    v_mfma_f32_16x16x32_bf16 a[160:163], a[176:179], v[232:235], a[160:163]
    s_add_u32 m0, s51, 832
    v_mfma_f32_16x16x32_bf16 v[224:227], a[192:195], v[200:203], v[252:255]
    buffer_load_dwordx4 v5, s[12:15], s46 offen offset:256 lds
    v_mfma_f32_16x16x32_bf16 v[224:227], a[196:199], v[204:207], v[224:227]
    s_add_u32 s59, s59, 8192
    v_exp_f32 v216, v216
    v_mfma_f32_16x16x32_bf16 v[224:227], a[200:203], v[208:211], v[224:227]
    s_and_b32 s59, s59, 0x1ffff
    v_exp_f32 v217, v217
    v_mfma_f32_16x16x32_bf16 v[224:227], a[204:207], v[212:215], v[224:227]
    s_add_u32 s46, s44, s59
    ds_read_b128 a[192:195], v3 offset:8704
    ds_read_b128 a[196:199], v3 offset:8768
    v_mfma_f32_16x16x32_bf16 v[228:231], a[208:211], v[200:203], v[252:255]
    v_exp_f32 v218, v218
    v_mfma_f32_16x16x32_bf16 v[228:231], a[212:215], v[204:207], v[228:231]
    v_exp_f32 v219, v219
    v_mfma_f32_16x16x32_bf16 v[228:231], a[216:219], v[208:211], v[228:231]
    s_add_u32 m0, s4, 59808
    ds_read_b128 a[200:203], v3 offset:8832
    ds_read_b128 a[204:207], v3 offset:8896
    v_mfma_f32_16x16x32_bf16 v[228:231], a[220:223], v[212:215], v[228:231]
    buffer_load_dwordx4 v9, s[20:23], s57 offen offset:1024 lds
    v_mfma_f32_16x16x32_bf16 v[28:31], a[224:227], v[236:239], v[28:31]
    v_cvt_pk_bf16_f32 v232, v216, v217
    v_cvt_pk_bf16_f32 v233, v218, v219
    v_mfma_f32_16x16x32_bf16 v[44:47], a[228:231], v[236:239], v[44:47]
    v_exp_f32 v220, v220
    v_mfma_f32_16x16x32_bf16 v[60:63], a[232:235], v[236:239], v[60:63]
    ds_read_b128 a[208:211], v3 offset:13056
    ds_read_b128 a[212:215], v3 offset:13120
    v_mfma_f32_16x16x32_bf16 v[76:79], a[236:239], v[236:239], v[76:79]
    v_exp_f32 v221, v221
    v_mfma_f32_16x16x32_bf16 v[92:95], a[240:243], v[236:239], v[92:95]
    v_exp_f32 v222, v222
    v_mfma_f32_16x16x32_bf16 v[108:111], a[244:247], v[236:239], v[108:111]
    v_exp_f32 v223, v223
    v_mfma_f32_16x16x32_bf16 v[124:127], a[248:251], v[236:239], v[124:127]
    s_add_u32 m0, s4, 59840
    ds_read_b128 a[216:219], v3 offset:13184
    ds_read_b128 a[220:223], v3 offset:13248
    v_mfma_f32_16x16x32_bf16 v[140:143], a[252:255], v[236:239], v[140:143]
    buffer_load_dwordx4 v9, s[20:23], s57 offen offset:2048 lds
    v_mfma_f32_16x16x32_bf16 a[164:167], a[176:179], v[236:239], a[164:167]
    s_waitcnt lgkmcnt(6)
    v_cvt_pk_bf16_f32 v234, v220, v221
    v_cvt_pk_bf16_f32 v235, v222, v223
    v_mfma_f32_16x16x32_bf16 v[216:219], a[192:195], v[152:155], v[240:243]
    v_exp_f32 v224, v224
    v_mfma_f32_16x16x32_bf16 v[216:219], a[196:199], v[156:159], v[216:219]
    s_waitcnt lgkmcnt(4)
    v_exp_f32 v225, v225
    v_mfma_f32_16x16x32_bf16 v[216:219], a[200:203], v[160:163], v[216:219]
    v_exp_f32 v226, v226
    v_mfma_f32_16x16x32_bf16 v[216:219], a[204:207], v[164:167], v[216:219]
    s_waitcnt lgkmcnt(2)
    v_exp_f32 v227, v227
    v_mfma_f32_16x16x32_bf16 v[220:223], a[208:211], v[152:155], v[240:243]
    v_cvt_pk_bf16_f32 v236, v224, v225
    v_cvt_pk_bf16_f32 v237, v226, v227
    v_mfma_f32_16x16x32_bf16 v[220:223], a[212:215], v[156:159], v[220:223]
    s_waitcnt lgkmcnt(0)
    v_mfma_f32_16x16x32_bf16 v[220:223], a[216:219], v[160:163], v[220:223]
    v_mfma_f32_16x16x32_bf16 v[220:223], a[220:223], v[164:167], v[220:223]
    v_exp_f32 v228, v228
    v_mfma_f32_16x16x32_bf16 v[32:35], a[224:227], v[232:235], v[32:35]
    v_exp_f32 v229, v229
    v_mfma_f32_16x16x32_bf16 v[48:51], a[228:231], v[232:235], v[48:51]
    v_exp_f32 v230, v230
    v_mfma_f32_16x16x32_bf16 v[64:67], a[232:235], v[232:235], v[64:67]
    v_exp_f32 v231, v231
    v_mfma_f32_16x16x32_bf16 v[80:83], a[236:239], v[232:235], v[80:83]
    v_cvt_pk_bf16_f32 v238, v228, v229
    v_cvt_pk_bf16_f32 v239, v230, v231
    v_mfma_f32_16x16x32_bf16 v[96:99], a[240:243], v[232:235], v[96:99]
    s_add_u32 m0, s4, 59872
    v_mfma_f32_16x16x32_bf16 v[112:115], a[244:247], v[232:235], v[112:115]
    buffer_load_dwordx4 v9, s[20:23], s57 offen offset:3072 lds
    v_mfma_f32_16x16x32_bf16 v[128:131], a[248:251], v[232:235], v[128:131]
    v_mfma_f32_16x16x32_bf16 v[144:147], a[252:255], v[232:235], v[144:147]
    v_mfma_f32_16x16x32_bf16 a[168:171], a[176:179], v[232:235], a[168:171]
    v_mfma_f32_16x16x32_bf16 v[224:227], a[192:195], v[168:171], v[244:247]
    s_waitcnt vmcnt(11)
    s_barrier
    v_mfma_f32_16x16x32_bf16 v[224:227], a[196:199], v[172:175], v[224:227]
    v_exp_f32 v216, v216
    v_mfma_f32_16x16x32_bf16 v[224:227], a[200:203], v[176:179], v[224:227]
    v_exp_f32 v217, v217
    v_mfma_f32_16x16x32_bf16 v[224:227], a[204:207], v[180:183], v[224:227]
    v_exp_f32 v218, v218
    v_mfma_f32_16x16x32_bf16 v[228:231], a[208:211], v[168:171], v[244:247]
    v_exp_f32 v219, v219
    v_mfma_f32_16x16x32_bf16 v[228:231], a[212:215], v[172:175], v[228:231]
    v_cvt_pk_bf16_f32 v232, v216, v217
    v_cvt_pk_bf16_f32 v233, v218, v219
    v_mfma_f32_16x16x32_bf16 v[228:231], a[216:219], v[176:179], v[228:231]
    s_add_u32 m0, s52, 17408
    v_mfma_f32_16x16x32_bf16 v[228:231], a[220:223], v[180:183], v[228:231]
    buffer_load_dwordx4 v6, s[16:19], s47 offen lds
    v_mfma_f32_16x16x32_bf16 v[36:39], a[224:227], v[236:239], v[36:39]
    v_exp_f32 v220, v220
    v_mfma_f32_16x16x32_bf16 v[52:55], a[228:231], v[236:239], v[52:55]
    ds_read_b64_tr_b16 a[224:225], v4 offset:34496
    ds_read_b64_tr_b16 a[226:227], v4 offset:35008
    v_mfma_f32_16x16x32_bf16 v[68:71], a[232:235], v[236:239], v[68:71]
    v_exp_f32 v221, v221
    v_mfma_f32_16x16x32_bf16 v[84:87], a[236:239], v[236:239], v[84:87]
    ds_read_b64_tr_b16 a[228:229], v4 offset:34528
    ds_read_b64_tr_b16 a[230:231], v4 offset:35040
    v_mfma_f32_16x16x32_bf16 v[100:103], a[240:243], v[236:239], v[100:103]
    s_mov_b64 exec, 1
    buffer_store_dwordx2 v[14:15], v2, s[24:27], s41 offen sc1
    s_mov_b64 exec, -1
    v_exp_f32 v222, v222
    v_mfma_f32_16x16x32_bf16 v[116:119], a[244:247], v[236:239], v[116:119]
    ds_read_b64_tr_b16 a[232:233], v4 offset:34560
    ds_read_b64_tr_b16 a[234:235], v4 offset:35072
    v_mfma_f32_16x16x32_bf16 v[132:135], a[248:251], v[236:239], v[132:135]
    v_exp_f32 v223, v223
    v_mfma_f32_16x16x32_bf16 v[148:151], a[252:255], v[236:239], v[148:151]
    ds_read_b64_tr_b16 a[236:237], v4 offset:34592
    ds_read_b64_tr_b16 a[238:239], v4 offset:35104
    v_mfma_f32_16x16x32_bf16 a[172:175], a[176:179], v[236:239], a[172:175]
    v_cvt_pk_bf16_f32 v234, v220, v221
    v_cvt_pk_bf16_f32 v235, v222, v223
    v_mfma_f32_16x16x32_bf16 v[216:219], a[192:195], v[184:187], v[248:251]
    s_add_u32 m0, s52, 18208
    ds_read_b64_tr_b16 a[240:241], v4 offset:34624
    ds_read_b64_tr_b16 a[242:243], v4 offset:35136
    v_mfma_f32_16x16x32_bf16 v[216:219], a[196:199], v[188:191], v[216:219]
    buffer_load_dwordx4 v6, s[16:19], s47 offen offset:256 lds
    v_mfma_f32_16x16x32_bf16 v[216:219], a[200:203], v[192:195], v[216:219]
    s_add_u32 s60, s60, 8192
    v_exp_f32 v224, v224
    v_mfma_f32_16x16x32_bf16 v[216:219], a[204:207], v[196:199], v[216:219]
    s_and_b32 s60, s60, 0x1ffff
    ds_read_b64_tr_b16 a[244:245], v4 offset:34656
    ds_read_b64_tr_b16 a[246:247], v4 offset:35168
    v_mfma_f32_16x16x32_bf16 v[220:223], a[208:211], v[184:187], v[248:251]
    s_add_u32 s47, s44, s60
    v_exp_f32 v225, v225
    v_mfma_f32_16x16x32_bf16 v[220:223], a[212:215], v[188:191], v[220:223]
    s_add_u32 m0, s4, 64000
    ds_read_b64_tr_b16 a[248:249], v4 offset:34688
    ds_read_b64_tr_b16 a[250:251], v4 offset:35200
    v_mfma_f32_16x16x32_bf16 v[220:223], a[216:219], v[192:195], v[220:223]
    buffer_load_dwordx4 v9, s[20:23], s58 offen offset:0 lds
    v_exp_f32 v226, v226
    v_mfma_f32_16x16x32_bf16 v[220:223], a[220:223], v[196:199], v[220:223]
    s_waitcnt lgkmcnt(10)
    s_add_u32 m0, s51, 8704
    ds_read_b64_tr_b16 a[252:253], v4 offset:34720
    ds_read_b64_tr_b16 a[254:255], v4 offset:35232
    v_mfma_f32_16x16x32_bf16 v[24:27], a[224:227], v[232:235], v[24:27]
    buffer_load_dwordx4 v5, s[12:15], s46 offen lds
    v_mfma_f32_16x16x32_bf16 v[40:43], a[228:231], v[232:235], v[40:43]
    s_waitcnt lgkmcnt(8)
    v_exp_f32 v227, v227
    v_mfma_f32_16x16x32_bf16 v[56:59], a[232:235], v[232:235], v[56:59]
    v_exp_f32 v228, v228
    v_mfma_f32_16x16x32_bf16 v[72:75], a[236:239], v[232:235], v[72:75]
    s_waitcnt lgkmcnt(4)
    v_cvt_pk_bf16_f32 v236, v224, v225
    v_cvt_pk_bf16_f32 v237, v226, v227
    v_mfma_f32_16x16x32_bf16 v[88:91], a[240:243], v[232:235], v[88:91]
    v_exp_f32 v229, v229
    v_mfma_f32_16x16x32_bf16 v[104:107], a[244:247], v[232:235], v[104:107]
    s_waitcnt lgkmcnt(0)
    v_exp_f32 v230, v230
    v_mfma_f32_16x16x32_bf16 v[120:123], a[248:251], v[232:235], v[120:123]
    v_exp_f32 v231, v231
    v_mfma_f32_16x16x32_bf16 v[136:139], a[252:255], v[232:235], v[136:139]
    v_cvt_pk_bf16_f32 v238, v228, v229
    v_cvt_pk_bf16_f32 v239, v230, v231
    v_mfma_f32_16x16x32_bf16 a[160:163], a[176:179], v[232:235], a[160:163]
    s_add_u32 m0, s51, 9536
    v_mfma_f32_16x16x32_bf16 v[224:227], a[192:195], v[200:203], v[252:255]
    buffer_load_dwordx4 v5, s[12:15], s46 offen offset:256 lds
    v_mfma_f32_16x16x32_bf16 v[224:227], a[196:199], v[204:207], v[224:227]
    s_add_u32 s59, s59, 8192
    v_exp_f32 v216, v216
    v_mfma_f32_16x16x32_bf16 v[224:227], a[200:203], v[208:211], v[224:227]
    s_and_b32 s59, s59, 0x1ffff
    v_exp_f32 v217, v217
    v_mfma_f32_16x16x32_bf16 v[224:227], a[204:207], v[212:215], v[224:227]
    s_add_u32 s46, s44, s59
    ds_read_b128 a[192:195], v3 offset:25856
    ds_read_b128 a[196:199], v3 offset:25920
    v_mfma_f32_16x16x32_bf16 v[228:231], a[208:211], v[200:203], v[252:255]
    v_exp_f32 v218, v218
    v_mfma_f32_16x16x32_bf16 v[228:231], a[212:215], v[204:207], v[228:231]
    v_exp_f32 v219, v219
    v_mfma_f32_16x16x32_bf16 v[228:231], a[216:219], v[208:211], v[228:231]
    s_add_u32 m0, s4, 64032
    ds_read_b128 a[200:203], v3 offset:25984
    ds_read_b128 a[204:207], v3 offset:26048
    v_mfma_f32_16x16x32_bf16 v[228:231], a[220:223], v[212:215], v[228:231]
    buffer_load_dwordx4 v9, s[20:23], s58 offen offset:1024 lds
    v_mfma_f32_16x16x32_bf16 v[28:31], a[224:227], v[236:239], v[28:31]
    v_cvt_pk_bf16_f32 v232, v216, v217
    v_cvt_pk_bf16_f32 v233, v218, v219
    v_mfma_f32_16x16x32_bf16 v[44:47], a[228:231], v[236:239], v[44:47]
    v_exp_f32 v220, v220
    v_mfma_f32_16x16x32_bf16 v[60:63], a[232:235], v[236:239], v[60:63]
    ds_read_b128 a[208:211], v3 offset:30208
    ds_read_b128 a[212:215], v3 offset:30272
    v_mfma_f32_16x16x32_bf16 v[76:79], a[236:239], v[236:239], v[76:79]
    v_exp_f32 v221, v221
    v_mfma_f32_16x16x32_bf16 v[92:95], a[240:243], v[236:239], v[92:95]
    v_exp_f32 v222, v222
    v_mfma_f32_16x16x32_bf16 v[108:111], a[244:247], v[236:239], v[108:111]
    v_exp_f32 v223, v223
    v_mfma_f32_16x16x32_bf16 v[124:127], a[248:251], v[236:239], v[124:127]
    s_add_u32 m0, s4, 64064
    ds_read_b128 a[216:219], v3 offset:30336
    ds_read_b128 a[220:223], v3 offset:30400
    v_mfma_f32_16x16x32_bf16 v[140:143], a[252:255], v[236:239], v[140:143]
    buffer_load_dwordx4 v9, s[20:23], s58 offen offset:2048 lds
    v_mfma_f32_16x16x32_bf16 a[164:167], a[176:179], v[236:239], a[164:167]
    s_waitcnt lgkmcnt(6)
    v_cvt_pk_bf16_f32 v234, v220, v221
    v_cvt_pk_bf16_f32 v235, v222, v223
    v_mfma_f32_16x16x32_bf16 v[216:219], a[192:195], v[152:155], v[240:243]
    v_exp_f32 v224, v224
    v_mfma_f32_16x16x32_bf16 v[216:219], a[196:199], v[156:159], v[216:219]
    s_waitcnt lgkmcnt(4)
    v_exp_f32 v225, v225
    v_mfma_f32_16x16x32_bf16 v[216:219], a[200:203], v[160:163], v[216:219]
    v_exp_f32 v226, v226
    v_mfma_f32_16x16x32_bf16 v[216:219], a[204:207], v[164:167], v[216:219]
    s_waitcnt lgkmcnt(2)
    v_exp_f32 v227, v227
    v_mfma_f32_16x16x32_bf16 v[220:223], a[208:211], v[152:155], v[240:243]
    v_cvt_pk_bf16_f32 v236, v224, v225
    v_cvt_pk_bf16_f32 v237, v226, v227
    v_mfma_f32_16x16x32_bf16 v[220:223], a[212:215], v[156:159], v[220:223]
    s_waitcnt lgkmcnt(0)
    v_mfma_f32_16x16x32_bf16 v[220:223], a[216:219], v[160:163], v[220:223]
    v_mfma_f32_16x16x32_bf16 v[220:223], a[220:223], v[164:167], v[220:223]
    v_exp_f32 v228, v228
    v_mfma_f32_16x16x32_bf16 v[32:35], a[224:227], v[232:235], v[32:35]
    v_exp_f32 v229, v229
    v_mfma_f32_16x16x32_bf16 v[48:51], a[228:231], v[232:235], v[48:51]
    v_exp_f32 v230, v230
    v_mfma_f32_16x16x32_bf16 v[64:67], a[232:235], v[232:235], v[64:67]
    v_exp_f32 v231, v231
    v_mfma_f32_16x16x32_bf16 v[80:83], a[236:239], v[232:235], v[80:83]
    v_cvt_pk_bf16_f32 v238, v228, v229
    v_cvt_pk_bf16_f32 v239, v230, v231
    v_mfma_f32_16x16x32_bf16 v[96:99], a[240:243], v[232:235], v[96:99]
    s_add_u32 m0, s4, 64096
    v_mfma_f32_16x16x32_bf16 v[112:115], a[244:247], v[232:235], v[112:115]
    buffer_load_dwordx4 v9, s[20:23], s58 offen offset:3072 lds
    v_mfma_f32_16x16x32_bf16 v[128:131], a[248:251], v[232:235], v[128:131]
    v_mfma_f32_16x16x32_bf16 v[144:147], a[252:255], v[232:235], v[144:147]
    v_mfma_f32_16x16x32_bf16 a[168:171], a[176:179], v[232:235], a[168:171]
    v_mfma_f32_16x16x32_bf16 v[224:227], a[192:195], v[168:171], v[244:247]
    s_waitcnt vmcnt(12)
    s_barrier
    v_mfma_f32_16x16x32_bf16 v[224:227], a[196:199], v[172:175], v[224:227]
    v_exp_f32 v216, v216
    v_mfma_f32_16x16x32_bf16 v[224:227], a[200:203], v[176:179], v[224:227]
    v_exp_f32 v217, v217
    v_mfma_f32_16x16x32_bf16 v[224:227], a[204:207], v[180:183], v[224:227]
    v_exp_f32 v218, v218
    v_mfma_f32_16x16x32_bf16 v[228:231], a[208:211], v[168:171], v[244:247]
    v_exp_f32 v219, v219
    v_mfma_f32_16x16x32_bf16 v[228:231], a[212:215], v[172:175], v[228:231]
    v_cvt_pk_bf16_f32 v232, v216, v217
    v_cvt_pk_bf16_f32 v233, v218, v219
    v_mfma_f32_16x16x32_bf16 v[228:231], a[216:219], v[176:179], v[228:231]
    s_add_u32 m0, s52, 34496
    v_mfma_f32_16x16x32_bf16 v[228:231], a[220:223], v[180:183], v[228:231]
    buffer_load_dwordx4 v6, s[16:19], s47 offen lds
    v_mfma_f32_16x16x32_bf16 v[36:39], a[224:227], v[236:239], v[36:39]
    v_exp_f32 v220, v220
    v_mfma_f32_16x16x32_bf16 v[52:55], a[228:231], v[236:239], v[52:55]
    ds_read_b64_tr_b16 a[224:225], v4 offset:42912
    ds_read_b64_tr_b16 a[226:227], v4 offset:43424
    v_mfma_f32_16x16x32_bf16 v[68:71], a[232:235], v[236:239], v[68:71]
    v_exp_f32 v221, v221
    v_mfma_f32_16x16x32_bf16 v[84:87], a[236:239], v[236:239], v[84:87]
    ds_read_b64_tr_b16 a[228:229], v4 offset:42944
    ds_read_b64_tr_b16 a[230:231], v4 offset:43456
    v_mfma_f32_16x16x32_bf16 v[100:103], a[240:243], v[236:239], v[100:103]
    buffer_load_dwordx4 a[180:183], v2, s[32:35], s69 offen
    v_exp_f32 v222, v222
    v_mfma_f32_16x16x32_bf16 v[116:119], a[244:247], v[236:239], v[116:119]
    ds_read_b64_tr_b16 a[232:233], v4 offset:42976
    ds_read_b64_tr_b16 a[234:235], v4 offset:43488
    v_mfma_f32_16x16x32_bf16 v[132:135], a[248:251], v[236:239], v[132:135]
    v_exp_f32 v223, v223
    v_mfma_f32_16x16x32_bf16 v[148:151], a[252:255], v[236:239], v[148:151]
    ds_read_b64_tr_b16 a[236:237], v4 offset:43008
    ds_read_b64_tr_b16 a[238:239], v4 offset:43520
    v_mfma_f32_16x16x32_bf16 a[172:175], a[176:179], v[236:239], a[172:175]
    v_cvt_pk_bf16_f32 v234, v220, v221
    v_cvt_pk_bf16_f32 v235, v222, v223
    v_mfma_f32_16x16x32_bf16 v[216:219], a[192:195], v[184:187], v[248:251]
    s_add_u32 m0, s52, 35296
    ds_read_b64_tr_b16 a[240:241], v4 offset:43040
    ds_read_b64_tr_b16 a[242:243], v4 offset:43552
    v_mfma_f32_16x16x32_bf16 v[216:219], a[196:199], v[188:191], v[216:219]
    buffer_load_dwordx4 v6, s[16:19], s47 offen offset:256 lds
    v_mfma_f32_16x16x32_bf16 v[216:219], a[200:203], v[192:195], v[216:219]
    s_add_u32 s60, s60, 8192
    v_exp_f32 v224, v224
    v_mfma_f32_16x16x32_bf16 v[216:219], a[204:207], v[196:199], v[216:219]
    s_and_b32 s60, s60, 0x1ffff
    ds_read_b64_tr_b16 a[244:245], v4 offset:43072
    ds_read_b64_tr_b16 a[246:247], v4 offset:43584
    v_mfma_f32_16x16x32_bf16 v[220:223], a[208:211], v[184:187], v[248:251]
    s_add_u32 s47, s44, s60
    v_exp_f32 v225, v225
    v_mfma_f32_16x16x32_bf16 v[220:223], a[212:215], v[188:191], v[220:223]
    s_add_u32 m0, s4, 68224
    ds_read_b64_tr_b16 a[248:249], v4 offset:43104
    ds_read_b64_tr_b16 a[250:251], v4 offset:43616
    v_mfma_f32_16x16x32_bf16 v[220:223], a[216:219], v[192:195], v[220:223]
    buffer_load_dwordx4 v9, s[20:23], s63 offen offset:0 lds
    v_exp_f32 v226, v226
    v_mfma_f32_16x16x32_bf16 v[220:223], a[220:223], v[196:199], v[220:223]
    s_waitcnt lgkmcnt(10)
    s_add_u32 m0, s51, 25856
    ds_read_b64_tr_b16 a[252:253], v4 offset:43136
    ds_read_b64_tr_b16 a[254:255], v4 offset:43648
    v_mfma_f32_16x16x32_bf16 v[24:27], a[224:227], v[232:235], v[24:27]
    buffer_load_dwordx4 v5, s[12:15], s46 offen lds
    v_mfma_f32_16x16x32_bf16 v[40:43], a[228:231], v[232:235], v[40:43]
    s_waitcnt lgkmcnt(8)
    v_exp_f32 v227, v227
    v_mfma_f32_16x16x32_bf16 v[56:59], a[232:235], v[232:235], v[56:59]
    v_exp_f32 v228, v228
    v_mfma_f32_16x16x32_bf16 v[72:75], a[236:239], v[232:235], v[72:75]
    s_waitcnt lgkmcnt(4)
    v_cvt_pk_bf16_f32 v236, v224, v225
    v_cvt_pk_bf16_f32 v237, v226, v227
    v_mfma_f32_16x16x32_bf16 v[88:91], a[240:243], v[232:235], v[88:91]
    v_exp_f32 v229, v229
    v_mfma_f32_16x16x32_bf16 v[104:107], a[244:247], v[232:235], v[104:107]
    s_waitcnt lgkmcnt(0)
    v_exp_f32 v230, v230
    v_mfma_f32_16x16x32_bf16 v[120:123], a[248:251], v[232:235], v[120:123]
    v_exp_f32 v231, v231
    v_mfma_f32_16x16x32_bf16 v[136:139], a[252:255], v[232:235], v[136:139]
    v_cvt_pk_bf16_f32 v238, v228, v229
    v_cvt_pk_bf16_f32 v239, v230, v231
    v_mfma_f32_16x16x32_bf16 a[160:163], a[176:179], v[232:235], a[160:163]
    s_add_u32 m0, s51, 26688
    v_mfma_f32_16x16x32_bf16 v[224:227], a[192:195], v[200:203], v[252:255]
    buffer_load_dwordx4 v5, s[12:15], s46 offen offset:256 lds
    v_mfma_f32_16x16x32_bf16 v[224:227], a[196:199], v[204:207], v[224:227]
    s_add_u32 s59, s59, 8192
    v_exp_f32 v216, v216
    v_mfma_f32_16x16x32_bf16 v[224:227], a[200:203], v[208:211], v[224:227]
    s_and_b32 s59, s59, 0x1ffff
    v_exp_f32 v217, v217
    v_mfma_f32_16x16x32_bf16 v[224:227], a[204:207], v[212:215], v[224:227]
    s_add_u32 s46, s44, s59
    ds_read_b128 a[192:195], v3 offset:0
    ds_read_b128 a[196:199], v3 offset:64
    v_mfma_f32_16x16x32_bf16 v[228:231], a[208:211], v[200:203], v[252:255]
    v_exp_f32 v218, v218
    v_mfma_f32_16x16x32_bf16 v[228:231], a[212:215], v[204:207], v[228:231]
    v_exp_f32 v219, v219
    v_mfma_f32_16x16x32_bf16 v[228:231], a[216:219], v[208:211], v[228:231]
    ds_read_b128 a[200:203], v3 offset:128
    ds_read_b128 a[204:207], v3 offset:192
    v_mfma_f32_16x16x32_bf16 v[228:231], a[220:223], v[212:215], v[228:231]
    buffer_load_dwordx4 a[184:187], v2, s[36:39], s70 offen
    v_mfma_f32_16x16x32_bf16 v[28:31], a[224:227], v[236:239], v[28:31]
    v_cvt_pk_bf16_f32 v232, v216, v217
    v_cvt_pk_bf16_f32 v233, v218, v219
    v_mfma_f32_16x16x32_bf16 v[44:47], a[228:231], v[236:239], v[44:47]
    v_exp_f32 v220, v220
    v_mfma_f32_16x16x32_bf16 v[60:63], a[232:235], v[236:239], v[60:63]
    s_add_u32 m0, s4, 68256
    ds_read_b128 a[208:211], v3 offset:4352
    ds_read_b128 a[212:215], v3 offset:4416
    v_mfma_f32_16x16x32_bf16 v[76:79], a[236:239], v[236:239], v[76:79]
    buffer_load_dwordx4 v9, s[20:23], s63 offen offset:1024 lds
    v_exp_f32 v221, v221
    v_mfma_f32_16x16x32_bf16 v[92:95], a[240:243], v[236:239], v[92:95]
    v_exp_f32 v222, v222
    v_mfma_f32_16x16x32_bf16 v[108:111], a[244:247], v[236:239], v[108:111]
    v_exp_f32 v223, v223
    v_mfma_f32_16x16x32_bf16 v[124:127], a[248:251], v[236:239], v[124:127]
    s_add_u32 m0, s4, 68288
    ds_read_b128 a[216:219], v3 offset:4480
    ds_read_b128 a[220:223], v3 offset:4544
    v_mfma_f32_16x16x32_bf16 v[140:143], a[252:255], v[236:239], v[140:143]
    buffer_load_dwordx4 v9, s[20:23], s63 offen offset:2048 lds
    v_mfma_f32_16x16x32_bf16 a[164:167], a[176:179], v[236:239], a[164:167]
    s_waitcnt lgkmcnt(6)
    v_cvt_pk_bf16_f32 v234, v220, v221
    v_cvt_pk_bf16_f32 v235, v222, v223
    v_mfma_f32_16x16x32_bf16 v[216:219], a[192:195], v[152:155], v[240:243]
    v_exp_f32 v224, v224
    v_mfma_f32_16x16x32_bf16 v[216:219], a[196:199], v[156:159], v[216:219]
    s_waitcnt lgkmcnt(4)
    v_exp_f32 v225, v225
    v_mfma_f32_16x16x32_bf16 v[216:219], a[200:203], v[160:163], v[216:219]
    v_exp_f32 v226, v226
    v_mfma_f32_16x16x32_bf16 v[216:219], a[204:207], v[164:167], v[216:219]
    s_waitcnt lgkmcnt(2)
    v_exp_f32 v227, v227
    v_mfma_f32_16x16x32_bf16 v[220:223], a[208:211], v[152:155], v[240:243]
    v_cvt_pk_bf16_f32 v236, v224, v225
    v_cvt_pk_bf16_f32 v237, v226, v227
    v_mfma_f32_16x16x32_bf16 v[220:223], a[212:215], v[156:159], v[220:223]
    s_waitcnt lgkmcnt(0)
    v_mfma_f32_16x16x32_bf16 v[220:223], a[216:219], v[160:163], v[220:223]
    v_mfma_f32_16x16x32_bf16 v[220:223], a[220:223], v[164:167], v[220:223]
    v_exp_f32 v228, v228
    v_mfma_f32_16x16x32_bf16 v[32:35], a[224:227], v[232:235], v[32:35]
    v_exp_f32 v229, v229
    v_mfma_f32_16x16x32_bf16 v[48:51], a[228:231], v[232:235], v[48:51]
    v_exp_f32 v230, v230
    v_mfma_f32_16x16x32_bf16 v[64:67], a[232:235], v[232:235], v[64:67]
    v_exp_f32 v231, v231
    v_mfma_f32_16x16x32_bf16 v[80:83], a[236:239], v[232:235], v[80:83]
    v_cvt_pk_bf16_f32 v238, v228, v229
    v_cvt_pk_bf16_f32 v239, v230, v231
    v_mfma_f32_16x16x32_bf16 v[96:99], a[240:243], v[232:235], v[96:99]
    s_add_u32 m0, s4, 68320
    v_mfma_f32_16x16x32_bf16 v[112:115], a[244:247], v[232:235], v[112:115]
    buffer_load_dwordx4 v9, s[20:23], s63 offen offset:3072 lds
    v_mfma_f32_16x16x32_bf16 v[128:131], a[248:251], v[232:235], v[128:131]
    v_mfma_f32_16x16x32_bf16 v[144:147], a[252:255], v[232:235], v[144:147]
    v_mfma_f32_16x16x32_bf16 a[168:171], a[176:179], v[232:235], a[168:171]
    v_mfma_f32_16x16x32_bf16 v[224:227], a[192:195], v[168:171], v[244:247]
    s_waitcnt vmcnt(13)
    s_barrier
    v_mfma_f32_16x16x32_bf16 v[224:227], a[196:199], v[172:175], v[224:227]
    v_exp_f32 v216, v216
    v_mfma_f32_16x16x32_bf16 v[224:227], a[200:203], v[176:179], v[224:227]
    v_exp_f32 v217, v217
    v_mfma_f32_16x16x32_bf16 v[224:227], a[204:207], v[180:183], v[224:227]
    v_exp_f32 v218, v218
    v_mfma_f32_16x16x32_bf16 v[228:231], a[208:211], v[168:171], v[244:247]
    v_exp_f32 v219, v219
    v_mfma_f32_16x16x32_bf16 v[228:231], a[212:215], v[172:175], v[228:231]
    v_cvt_pk_bf16_f32 v232, v216, v217
    v_cvt_pk_bf16_f32 v233, v218, v219
    v_mfma_f32_16x16x32_bf16 v[228:231], a[216:219], v[176:179], v[228:231]
    s_add_u32 m0, s52, 42912
    v_mfma_f32_16x16x32_bf16 v[228:231], a[220:223], v[180:183], v[228:231]
    buffer_load_dwordx4 v6, s[16:19], s47 offen lds
    v_mfma_f32_16x16x32_bf16 v[36:39], a[224:227], v[236:239], v[36:39]
    v_exp_f32 v220, v220
    v_mfma_f32_16x16x32_bf16 v[52:55], a[228:231], v[236:239], v[52:55]
    ds_read_b64_tr_b16 a[224:225], v4 offset:17408
    ds_read_b64_tr_b16 a[226:227], v4 offset:17920
    v_mfma_f32_16x16x32_bf16 v[68:71], a[232:235], v[236:239], v[68:71]
    v_exp_f32 v221, v221
    v_mfma_f32_16x16x32_bf16 v[84:87], a[236:239], v[236:239], v[84:87]
    ds_read_b64_tr_b16 a[228:229], v4 offset:17440
    ds_read_b64_tr_b16 a[230:231], v4 offset:17952
    v_mfma_f32_16x16x32_bf16 v[100:103], a[240:243], v[236:239], v[100:103]
    s_lshr_b32 s64, s2, 3
    s_lshl2_add_u32 s64, s64, s3
    s_lshl_b32 s64, s64, 7
    s_add_u32 s64, s64, 2048
    s_min_u32 s64, s64, L_code_end - L_ct_2 - 64
    s_getpc_b64 s[100:101]
L_ct_2:
    s_add_u32 s100, s100, s64
    s_addc_u32 s101, s101, 0
    global_load_ubyte v23, v1, s[100:101]
    v_exp_f32 v222, v222
    v_mfma_f32_16x16x32_bf16 v[116:119], a[244:247], v[236:239], v[116:119]
    ds_read_b64_tr_b16 a[232:233], v4 offset:17472
    ds_read_b64_tr_b16 a[234:235], v4 offset:17984
    v_mfma_f32_16x16x32_bf16 v[132:135], a[248:251], v[236:239], v[132:135]
    v_exp_f32 v223, v223
    v_mfma_f32_16x16x32_bf16 v[148:151], a[252:255], v[236:239], v[148:151]
    ds_read_b64_tr_b16 a[236:237], v4 offset:17504
    ds_read_b64_tr_b16 a[238:239], v4 offset:18016
    v_mfma_f32_16x16x32_bf16 a[172:175], a[176:179], v[236:239], a[172:175]
    v_cvt_pk_bf16_f32 v234, v220, v221
    v_cvt_pk_bf16_f32 v235, v222, v223
    v_mfma_f32_16x16x32_bf16 v[216:219], a[192:195], v[184:187], v[248:251]
    s_add_u32 m0, s52, 43712
    ds_read_b64_tr_b16 a[240:241], v4 offset:17536
    ds_read_b64_tr_b16 a[242:243], v4 offset:18048
    v_mfma_f32_16x16x32_bf16 v[216:219], a[196:199], v[188:191], v[216:219]
    buffer_load_dwordx4 v6, s[16:19], s47 offen offset:256 lds
    v_mfma_f32_16x16x32_bf16 v[216:219], a[200:203], v[192:195], v[216:219]
    s_add_u32 s60, s60, 8192
    v_exp_f32 v224, v224
    v_mfma_f32_16x16x32_bf16 v[216:219], a[204:207], v[196:199], v[216:219]
    s_and_b32 s60, s60, 0x1ffff
    ds_read_b64_tr_b16 a[244:245], v4 offset:17568
    ds_read_b64_tr_b16 a[246:247], v4 offset:18080
    v_mfma_f32_16x16x32_bf16 v[220:223], a[208:211], v[184:187], v[248:251]
    s_add_u32 s47, s44, s60
    v_exp_f32 v225, v225
    v_mfma_f32_16x16x32_bf16 v[220:223], a[212:215], v[188:191], v[220:223]
    s_add_u32 m0, s4, 72448
    ds_read_b64_tr_b16 a[248:249], v4 offset:17600
    ds_read_b64_tr_b16 a[250:251], v4 offset:18112
    v_mfma_f32_16x16x32_bf16 v[220:223], a[216:219], v[192:195], v[220:223]
    buffer_load_dwordx4 v9, s[20:23], s49 offen offset:0 lds
    v_exp_f32 v226, v226
    v_mfma_f32_16x16x32_bf16 v[220:223], a[220:223], v[196:199], v[220:223]
    s_waitcnt lgkmcnt(10)
    s_add_u32 m0, s51, 0
    ds_read_b64_tr_b16 a[252:253], v4 offset:17632
    ds_read_b64_tr_b16 a[254:255], v4 offset:18144
    v_mfma_f32_16x16x32_bf16 v[24:27], a[224:227], v[232:235], v[24:27]
    buffer_load_dwordx4 v5, s[12:15], s46 offen lds
    v_mfma_f32_16x16x32_bf16 v[40:43], a[228:231], v[232:235], v[40:43]
    s_waitcnt lgkmcnt(8)
    v_exp_f32 v227, v227
    v_mfma_f32_16x16x32_bf16 v[56:59], a[232:235], v[232:235], v[56:59]
    v_exp_f32 v228, v228
    v_mfma_f32_16x16x32_bf16 v[72:75], a[236:239], v[232:235], v[72:75]
    s_waitcnt lgkmcnt(4)
    v_cvt_pk_bf16_f32 v236, v224, v225
    v_cvt_pk_bf16_f32 v237, v226, v227
    v_mfma_f32_16x16x32_bf16 v[88:91], a[240:243], v[232:235], v[88:91]
    v_exp_f32 v229, v229
    v_mfma_f32_16x16x32_bf16 v[104:107], a[244:247], v[232:235], v[104:107]
    s_waitcnt lgkmcnt(0)
    v_exp_f32 v230, v230
    v_mfma_f32_16x16x32_bf16 v[120:123], a[248:251], v[232:235], v[120:123]
    v_exp_f32 v231, v231
    v_mfma_f32_16x16x32_bf16 v[136:139], a[252:255], v[232:235], v[136:139]
    v_cvt_pk_bf16_f32 v238, v228, v229
    v_cvt_pk_bf16_f32 v239, v230, v231
    v_mfma_f32_16x16x32_bf16 a[160:163], a[176:179], v[232:235], a[160:163]
    s_add_u32 m0, s51, 832
    v_mfma_f32_16x16x32_bf16 v[224:227], a[192:195], v[200:203], v[252:255]
    buffer_load_dwordx4 v5, s[12:15], s46 offen offset:256 lds
    v_mfma_f32_16x16x32_bf16 v[224:227], a[196:199], v[204:207], v[224:227]
    s_add_u32 s59, s59, 8192
    v_exp_f32 v216, v216
    v_mfma_f32_16x16x32_bf16 v[224:227], a[200:203], v[208:211], v[224:227]
    s_and_b32 s59, s59, 0x1ffff
    v_exp_f32 v217, v217
    v_mfma_f32_16x16x32_bf16 v[224:227], a[204:207], v[212:215], v[224:227]
    s_add_u32 s46, s44, s59
    ds_read_b128 a[192:195], v3 offset:8704
    ds_read_b128 a[196:199], v3 offset:8768
    v_mfma_f32_16x16x32_bf16 v[228:231], a[208:211], v[200:203], v[252:255]
    v_exp_f32 v218, v218
    v_mfma_f32_16x16x32_bf16 v[228:231], a[212:215], v[204:207], v[228:231]
    v_exp_f32 v219, v219
    v_mfma_f32_16x16x32_bf16 v[228:231], a[216:219], v[208:211], v[228:231]
    s_add_u32 m0, s4, 72480
    ds_read_b128 a[200:203], v3 offset:8832
    ds_read_b128 a[204:207], v3 offset:8896
    v_mfma_f32_16x16x32_bf16 v[228:231], a[220:223], v[212:215], v[228:231]
    buffer_load_dwordx4 v9, s[20:23], s49 offen offset:1024 lds
    v_mfma_f32_16x16x32_bf16 v[28:31], a[224:227], v[236:239], v[28:31]
    v_cvt_pk_bf16_f32 v232, v216, v217
    v_cvt_pk_bf16_f32 v233, v218, v219
    v_mfma_f32_16x16x32_bf16 v[44:47], a[228:231], v[236:239], v[44:47]
    v_exp_f32 v220, v220
    v_mfma_f32_16x16x32_bf16 v[60:63], a[232:235], v[236:239], v[60:63]
    ds_read_b128 a[208:211], v3 offset:13056
    ds_read_b128 a[212:215], v3 offset:13120
    v_mfma_f32_16x16x32_bf16 v[76:79], a[236:239], v[236:239], v[76:79]
    buffer_load_dwordx2 v[16:17], v12, s[24:27], 0 offen sc1
    v_exp_f32 v221, v221
    v_mfma_f32_16x16x32_bf16 v[92:95], a[240:243], v[236:239], v[92:95]
    v_exp_f32 v222, v222
    v_mfma_f32_16x16x32_bf16 v[108:111], a[244:247], v[236:239], v[108:111]
    v_exp_f32 v223, v223
    v_mfma_f32_16x16x32_bf16 v[124:127], a[248:251], v[236:239], v[124:127]
    s_add_u32 m0, s4, 72512
    ds_read_b128 a[216:219], v3 offset:13184
    ds_read_b128 a[220:223], v3 offset:13248
    v_mfma_f32_16x16x32_bf16 v[140:143], a[252:255], v[236:239], v[140:143]
    buffer_load_dwordx4 v9, s[20:23], s49 offen offset:2048 lds
    v_mfma_f32_16x16x32_bf16 a[164:167], a[176:179], v[236:239], a[164:167]
    s_waitcnt lgkmcnt(6)
    v_cvt_pk_bf16_f32 v234, v220, v221
    v_cvt_pk_bf16_f32 v235, v222, v223
    v_mfma_f32_16x16x32_bf16 v[216:219], a[192:195], v[152:155], v[240:243]
    v_exp_f32 v224, v224
    v_mfma_f32_16x16x32_bf16 v[216:219], a[196:199], v[156:159], v[216:219]
    s_waitcnt lgkmcnt(4)
    v_exp_f32 v225, v225
    v_mfma_f32_16x16x32_bf16 v[216:219], a[200:203], v[160:163], v[216:219]
    v_exp_f32 v226, v226
    v_mfma_f32_16x16x32_bf16 v[216:219], a[204:207], v[164:167], v[216:219]
    s_waitcnt lgkmcnt(2)
    v_exp_f32 v227, v227
    v_mfma_f32_16x16x32_bf16 v[220:223], a[208:211], v[152:155], v[240:243]
    v_cvt_pk_bf16_f32 v236, v224, v225
    v_cvt_pk_bf16_f32 v237, v226, v227
    v_mfma_f32_16x16x32_bf16 v[220:223], a[212:215], v[156:159], v[220:223]
    s_waitcnt lgkmcnt(0)
    v_mfma_f32_16x16x32_bf16 v[220:223], a[216:219], v[160:163], v[220:223]
    s_cmp_lt_u32 s3, 2
    s_cselect_b32 s53, 0, 1792
    s_cselect_b32 s54, 0, s62
    s_min_u32 s55, s3, 2
    s_lshl_b32 s55, s55, 10
    s_lshl_b32 s54, s54, 8
    s_add_u32 s54, s54, s55
    s_add_u32 s54, s54, 0x52000
    s_mov_b32 s68, 0
    v_lshrrev_b32 v8, 4, v1
    v_mad_u32_u24 v8, v8, s53, v2
    v_mfma_f32_16x16x32_bf16 v[220:223], a[220:223], v[164:167], v[220:223]
    v_exp_f32 v228, v228
    v_mfma_f32_16x16x32_bf16 v[32:35], a[224:227], v[232:235], v[32:35]
    v_exp_f32 v229, v229
    v_mfma_f32_16x16x32_bf16 v[48:51], a[228:231], v[232:235], v[48:51]
    v_exp_f32 v230, v230
    v_mfma_f32_16x16x32_bf16 v[64:67], a[232:235], v[232:235], v[64:67]
    v_exp_f32 v231, v231
    v_mfma_f32_16x16x32_bf16 v[80:83], a[236:239], v[232:235], v[80:83]
    v_cvt_pk_bf16_f32 v238, v228, v229
    v_cvt_pk_bf16_f32 v239, v230, v231
    v_mfma_f32_16x16x32_bf16 v[96:99], a[240:243], v[232:235], v[96:99]
    s_add_u32 m0, s4, 72544
    v_mfma_f32_16x16x32_bf16 v[112:115], a[244:247], v[232:235], v[112:115]
    buffer_load_dwordx4 v9, s[20:23], s49 offen offset:3072 lds
    v_mfma_f32_16x16x32_bf16 v[128:131], a[248:251], v[232:235], v[128:131]
    v_mfma_f32_16x16x32_bf16 v[144:147], a[252:255], v[232:235], v[144:147]
    v_mfma_f32_16x16x32_bf16 a[168:171], a[176:179], v[232:235], a[168:171]
    v_mfma_f32_16x16x32_bf16 v[224:227], a[192:195], v[168:171], v[244:247]
    s_waitcnt vmcnt(14)
    s_barrier
    v_mfma_f32_16x16x32_bf16 v[224:227], a[196:199], v[172:175], v[224:227]
    v_exp_f32 v216, v216
    v_mfma_f32_16x16x32_bf16 v[224:227], a[200:203], v[176:179], v[224:227]
    v_exp_f32 v217, v217
    v_mfma_f32_16x16x32_bf16 v[224:227], a[204:207], v[180:183], v[224:227]
    v_exp_f32 v218, v218
    v_mfma_f32_16x16x32_bf16 v[228:231], a[208:211], v[168:171], v[244:247]
    v_exp_f32 v219, v219
    v_mfma_f32_16x16x32_bf16 v[228:231], a[212:215], v[172:175], v[228:231]
    v_cvt_pk_bf16_f32 v232, v216, v217
    v_cvt_pk_bf16_f32 v233, v218, v219
    v_mfma_f32_16x16x32_bf16 v[228:231], a[216:219], v[176:179], v[228:231]
    s_add_u32 m0, s52, 17408
    v_mfma_f32_16x16x32_bf16 v[228:231], a[220:223], v[180:183], v[228:231]
    buffer_load_dwordx4 v6, s[16:19], s47 offen lds
    v_mfma_f32_16x16x32_bf16 v[36:39], a[224:227], v[236:239], v[36:39]
    v_exp_f32 v220, v220
    v_mfma_f32_16x16x32_bf16 v[52:55], a[228:231], v[236:239], v[52:55]
    ds_read_b64_tr_b16 a[224:225], v4 offset:34496
    ds_read_b64_tr_b16 a[226:227], v4 offset:35008
    v_mfma_f32_16x16x32_bf16 v[68:71], a[232:235], v[236:239], v[68:71]
    v_exp_f32 v221, v221
    v_mfma_f32_16x16x32_bf16 v[84:87], a[236:239], v[236:239], v[84:87]
    ds_read_b64_tr_b16 a[228:229], v4 offset:34528
    ds_read_b64_tr_b16 a[230:231], v4 offset:35040
    v_mfma_f32_16x16x32_bf16 v[100:103], a[240:243], v[236:239], v[100:103]
    v_exp_f32 v222, v222
    v_mfma_f32_16x16x32_bf16 v[116:119], a[244:247], v[236:239], v[116:119]
    ds_read_b64_tr_b16 a[232:233], v4 offset:34560
    ds_read_b64_tr_b16 a[234:235], v4 offset:35072
    v_mfma_f32_16x16x32_bf16 v[132:135], a[248:251], v[236:239], v[132:135]
    v_exp_f32 v223, v223
    v_mfma_f32_16x16x32_bf16 v[148:151], a[252:255], v[236:239], v[148:151]
    ds_read_b64_tr_b16 a[236:237], v4 offset:34592
    ds_read_b64_tr_b16 a[238:239], v4 offset:35104
    v_mfma_f32_16x16x32_bf16 a[172:175], a[176:179], v[236:239], a[172:175]
    v_cvt_pk_bf16_f32 v234, v220, v221
    v_cvt_pk_bf16_f32 v235, v222, v223
    v_mfma_f32_16x16x32_bf16 v[216:219], a[192:195], v[184:187], v[248:251]
    s_add_u32 m0, s52, 18208
    ds_read_b64_tr_b16 a[240:241], v4 offset:34624
    ds_read_b64_tr_b16 a[242:243], v4 offset:35136
    v_mfma_f32_16x16x32_bf16 v[216:219], a[196:199], v[188:191], v[216:219]
    buffer_load_dwordx4 v6, s[16:19], s47 offen offset:256 lds
    v_mfma_f32_16x16x32_bf16 v[216:219], a[200:203], v[192:195], v[216:219]
    s_add_u32 s60, s60, 8192
    v_exp_f32 v224, v224
    v_mfma_f32_16x16x32_bf16 v[216:219], a[204:207], v[196:199], v[216:219]
    s_and_b32 s60, s60, 0x1ffff
    ds_read_b64_tr_b16 a[244:245], v4 offset:34656
    ds_read_b64_tr_b16 a[246:247], v4 offset:35168
    v_mfma_f32_16x16x32_bf16 v[220:223], a[208:211], v[184:187], v[248:251]
    s_add_u32 s47, s44, s60
    v_exp_f32 v225, v225
    v_mfma_f32_16x16x32_bf16 v[220:223], a[212:215], v[188:191], v[220:223]
    ds_read_b64_tr_b16 a[248:249], v4 offset:34688
    ds_read_b64_tr_b16 a[250:251], v4 offset:35200
    v_mfma_f32_16x16x32_bf16 v[220:223], a[216:219], v[192:195], v[220:223]
    s_add_u32 m0, s51, 8704
    v_exp_f32 v226, v226
    v_mfma_f32_16x16x32_bf16 v[220:223], a[220:223], v[196:199], v[220:223]
    s_waitcnt lgkmcnt(10)
    ds_read_b64_tr_b16 a[252:253], v4 offset:34720
    ds_read_b64_tr_b16 a[254:255], v4 offset:35232
    v_mfma_f32_16x16x32_bf16 v[24:27], a[224:227], v[232:235], v[24:27]
    buffer_load_dwordx4 v5, s[12:15], s46 offen lds
    v_mfma_f32_16x16x32_bf16 v[40:43], a[228:231], v[232:235], v[40:43]
    s_waitcnt lgkmcnt(8)
    v_exp_f32 v227, v227
    v_mfma_f32_16x16x32_bf16 v[56:59], a[232:235], v[232:235], v[56:59]
    v_exp_f32 v228, v228
    v_mfma_f32_16x16x32_bf16 v[72:75], a[236:239], v[232:235], v[72:75]
    s_waitcnt lgkmcnt(4)
    v_cvt_pk_bf16_f32 v236, v224, v225
    v_cvt_pk_bf16_f32 v237, v226, v227
    v_mfma_f32_16x16x32_bf16 v[88:91], a[240:243], v[232:235], v[88:91]
    v_exp_f32 v229, v229
    v_mfma_f32_16x16x32_bf16 v[104:107], a[244:247], v[232:235], v[104:107]
    s_waitcnt lgkmcnt(0)
    v_exp_f32 v230, v230
    v_mfma_f32_16x16x32_bf16 v[120:123], a[248:251], v[232:235], v[120:123]
    v_exp_f32 v231, v231
    v_mfma_f32_16x16x32_bf16 v[136:139], a[252:255], v[232:235], v[136:139]
    v_cvt_pk_bf16_f32 v238, v228, v229
    v_cvt_pk_bf16_f32 v239, v230, v231
    v_mfma_f32_16x16x32_bf16 a[160:163], a[176:179], v[232:235], a[160:163]
    s_add_u32 m0, s51, 9536
    v_mfma_f32_16x16x32_bf16 v[224:227], a[192:195], v[200:203], v[252:255]
    buffer_load_dwordx4 v5, s[12:15], s46 offen offset:256 lds
    v_mfma_f32_16x16x32_bf16 v[224:227], a[196:199], v[204:207], v[224:227]
    s_add_u32 s59, s59, 8192
    v_exp_f32 v216, v216
    v_mfma_f32_16x16x32_bf16 v[224:227], a[200:203], v[208:211], v[224:227]
    s_and_b32 s59, s59, 0x1ffff
    v_exp_f32 v217, v217
    v_mfma_f32_16x16x32_bf16 v[224:227], a[204:207], v[212:215], v[224:227]
    s_add_u32 s46, s44, s59
    ds_read_b128 a[192:195], v3 offset:25856
    ds_read_b128 a[196:199], v3 offset:25920
    v_mfma_f32_16x16x32_bf16 v[228:231], a[208:211], v[200:203], v[252:255]
    v_exp_f32 v218, v218
    v_mfma_f32_16x16x32_bf16 v[228:231], a[212:215], v[204:207], v[228:231]
    v_exp_f32 v219, v219
    v_mfma_f32_16x16x32_bf16 v[228:231], a[216:219], v[208:211], v[228:231]
    ds_read_b128 a[200:203], v3 offset:25984
    ds_read_b128 a[204:207], v3 offset:26048
    v_mfma_f32_16x16x32_bf16 v[228:231], a[220:223], v[212:215], v[228:231]
    s_waitcnt vmcnt(6)
    v_subrev_u32 v16, s45, v16
    v_lshrrev_b32 v16, 3, v16
    v_bitop3_b32 v16, v17, s66, v16 bitop3:0xbe
    v_cmp_ne_u32 vcc, 0, v16
    s_cbranch_vccnz L_att_check
L_att_checked:
    v_mfma_f32_16x16x32_bf16 v[28:31], a[224:227], v[236:239], v[28:31]
    v_cvt_pk_bf16_f32 v232, v216, v217
    v_cvt_pk_bf16_f32 v233, v218, v219
    v_mfma_f32_16x16x32_bf16 v[44:47], a[228:231], v[236:239], v[44:47]
    v_exp_f32 v220, v220
    v_mfma_f32_16x16x32_bf16 v[60:63], a[232:235], v[236:239], v[60:63]
    ds_read_b128 a[208:211], v3 offset:30208
    ds_read_b128 a[212:215], v3 offset:30272
    v_mfma_f32_16x16x32_bf16 v[76:79], a[236:239], v[236:239], v[76:79]
    s_cmp_lt_u32 s3, 2
    s_cselect_b32 exec_hi, -1, 0xffff
    s_add_u32 m0, s55, 161024
    s_nop 0
    buffer_load_dwordx4 v8, s[24:27], s54 offen sc1 lds
    s_mov_b64 exec, -1
    v_exp_f32 v221, v221
    v_mfma_f32_16x16x32_bf16 v[92:95], a[240:243], v[236:239], v[92:95]
    v_exp_f32 v222, v222
    v_mfma_f32_16x16x32_bf16 v[108:111], a[244:247], v[236:239], v[108:111]
    v_exp_f32 v223, v223
    v_mfma_f32_16x16x32_bf16 v[124:127], a[248:251], v[236:239], v[124:127]
    ds_read_b128 a[216:219], v3 offset:30336
    ds_read_b128 a[220:223], v3 offset:30400
    v_mfma_f32_16x16x32_bf16 v[140:143], a[252:255], v[236:239], v[140:143]
    buffer_load_dwordx4 a[32:35], v2, s[24:27], s84 offen offset:0 sc1
    v_mfma_f32_16x16x32_bf16 a[164:167], a[176:179], v[236:239], a[164:167]
    s_waitcnt lgkmcnt(6)
    v_cvt_pk_bf16_f32 v234, v220, v221
    v_cvt_pk_bf16_f32 v235, v222, v223
    v_mfma_f32_16x16x32_bf16 v[216:219], a[192:195], v[152:155], v[240:243]
    v_exp_f32 v224, v224
    v_mfma_f32_16x16x32_bf16 v[216:219], a[196:199], v[156:159], v[216:219]
    s_waitcnt lgkmcnt(4)
    v_exp_f32 v225, v225
    v_mfma_f32_16x16x32_bf16 v[216:219], a[200:203], v[160:163], v[216:219]
    v_exp_f32 v226, v226
    v_mfma_f32_16x16x32_bf16 v[216:219], a[204:207], v[164:167], v[216:219]
    s_waitcnt lgkmcnt(2)
    v_exp_f32 v227, v227
    v_mfma_f32_16x16x32_bf16 v[220:223], a[208:211], v[152:155], v[240:243]
    v_cvt_pk_bf16_f32 v236, v224, v225
    v_cvt_pk_bf16_f32 v237, v226, v227
    v_mfma_f32_16x16x32_bf16 v[220:223], a[212:215], v[156:159], v[220:223]
    s_waitcnt lgkmcnt(0)
    v_mfma_f32_16x16x32_bf16 v[220:223], a[216:219], v[160:163], v[220:223]
    buffer_load_dwordx4 a[36:39], v2, s[24:27], s84 offen offset:1024 sc1
    v_mfma_f32_16x16x32_bf16 v[220:223], a[220:223], v[164:167], v[220:223]
    v_exp_f32 v228, v228
    v_mfma_f32_16x16x32_bf16 v[32:35], a[224:227], v[232:235], v[32:35]
    v_exp_f32 v229, v229
    v_mfma_f32_16x16x32_bf16 v[48:51], a[228:231], v[232:235], v[48:51]
    v_exp_f32 v230, v230
    v_mfma_f32_16x16x32_bf16 v[64:67], a[232:235], v[232:235], v[64:67]
    v_exp_f32 v231, v231
    v_mfma_f32_16x16x32_bf16 v[80:83], a[236:239], v[232:235], v[80:83]
    v_cvt_pk_bf16_f32 v238, v228, v229
    v_cvt_pk_bf16_f32 v239, v230, v231
    v_mfma_f32_16x16x32_bf16 v[96:99], a[240:243], v[232:235], v[96:99]
    v_mfma_f32_16x16x32_bf16 v[112:115], a[244:247], v[232:235], v[112:115]
    buffer_load_dwordx4 a[40:43], v2, s[24:27], s84 offen offset:2048 sc1
    v_mfma_f32_16x16x32_bf16 v[128:131], a[248:251], v[232:235], v[128:131]
    v_mfma_f32_16x16x32_bf16 v[144:147], a[252:255], v[232:235], v[144:147]
    v_mfma_f32_16x16x32_bf16 a[168:171], a[176:179], v[232:235], a[168:171]
    buffer_load_dwordx4 a[44:47], v2, s[24:27], s84 offen offset:3072 sc1
    v_mfma_f32_16x16x32_bf16 v[224:227], a[192:195], v[168:171], v[244:247]
    s_barrier
    v_mfma_f32_16x16x32_bf16 v[224:227], a[196:199], v[172:175], v[224:227]
    buffer_load_dwordx4 a[48:51], v2, s[24:27], s85 offen offset:0 sc1
    v_exp_f32 v216, v216
    v_mfma_f32_16x16x32_bf16 v[224:227], a[200:203], v[176:179], v[224:227]
    v_exp_f32 v217, v217
    v_mfma_f32_16x16x32_bf16 v[224:227], a[204:207], v[180:183], v[224:227]
    v_exp_f32 v218, v218
    v_mfma_f32_16x16x32_bf16 v[228:231], a[208:211], v[168:171], v[244:247]
    v_exp_f32 v219, v219
    v_mfma_f32_16x16x32_bf16 v[228:231], a[212:215], v[172:175], v[228:231]
    v_cvt_pk_bf16_f32 v232, v216, v217
    v_cvt_pk_bf16_f32 v233, v218, v219
    v_mfma_f32_16x16x32_bf16 v[228:231], a[216:219], v[176:179], v[228:231]
    s_add_u32 m0, s52, 34496
    v_mfma_f32_16x16x32_bf16 v[228:231], a[220:223], v[180:183], v[228:231]
    buffer_load_dwordx4 v6, s[16:19], s47 offen lds
    v_mfma_f32_16x16x32_bf16 v[36:39], a[224:227], v[236:239], v[36:39]
    v_exp_f32 v220, v220
    v_mfma_f32_16x16x32_bf16 v[52:55], a[228:231], v[236:239], v[52:55]
    ds_read_b64_tr_b16 a[224:225], v4 offset:42912
    ds_read_b64_tr_b16 a[226:227], v4 offset:43424
    v_mfma_f32_16x16x32_bf16 v[68:71], a[232:235], v[236:239], v[68:71]
    v_exp_f32 v221, v221
    v_mfma_f32_16x16x32_bf16 v[84:87], a[236:239], v[236:239], v[84:87]
    ds_read_b64_tr_b16 a[228:229], v4 offset:42944
    ds_read_b64_tr_b16 a[230:231], v4 offset:43456
    v_mfma_f32_16x16x32_bf16 v[100:103], a[240:243], v[236:239], v[100:103]
    buffer_load_dwordx4 a[52:55], v2, s[24:27], s85 offen offset:1024 sc1
    v_exp_f32 v222, v222
    v_mfma_f32_16x16x32_bf16 v[116:119], a[244:247], v[236:239], v[116:119]
    ds_read_b64_tr_b16 a[232:233], v4 offset:42976
    ds_read_b64_tr_b16 a[234:235], v4 offset:43488
    v_mfma_f32_16x16x32_bf16 v[132:135], a[248:251], v[236:239], v[132:135]
    v_exp_f32 v223, v223
    v_mfma_f32_16x16x32_bf16 v[148:151], a[252:255], v[236:239], v[148:151]
    ds_read_b64_tr_b16 a[236:237], v4 offset:43008
    ds_read_b64_tr_b16 a[238:239], v4 offset:43520
    v_mfma_f32_16x16x32_bf16 a[172:175], a[176:179], v[236:239], a[172:175]
    v_cvt_pk_bf16_f32 v234, v220, v221
    v_cvt_pk_bf16_f32 v235, v222, v223
    v_mfma_f32_16x16x32_bf16 v[216:219], a[192:195], v[184:187], v[248:251]
    s_add_u32 m0, s52, 35296
    ds_read_b64_tr_b16 a[240:241], v4 offset:43040
    ds_read_b64_tr_b16 a[242:243], v4 offset:43552
    v_mfma_f32_16x16x32_bf16 v[216:219], a[196:199], v[188:191], v[216:219]
    buffer_load_dwordx4 v6, s[16:19], s47 offen offset:256 lds
    v_mfma_f32_16x16x32_bf16 v[216:219], a[200:203], v[192:195], v[216:219]
    s_add_u32 s60, s60, 8192
    v_exp_f32 v224, v224
    v_mfma_f32_16x16x32_bf16 v[216:219], a[204:207], v[196:199], v[216:219]
    s_and_b32 s60, s60, 0x1ffff
    ds_read_b64_tr_b16 a[244:245], v4 offset:43072
    ds_read_b64_tr_b16 a[246:247], v4 offset:43584
    v_mfma_f32_16x16x32_bf16 v[220:223], a[208:211], v[184:187], v[248:251]
    s_add_u32 s47, s44, s60
    v_exp_f32 v225, v225
    v_mfma_f32_16x16x32_bf16 v[220:223], a[212:215], v[188:191], v[220:223]
    ds_read_b64_tr_b16 a[248:249], v4 offset:43104
    ds_read_b64_tr_b16 a[250:251], v4 offset:43616
    v_mfma_f32_16x16x32_bf16 v[220:223], a[216:219], v[192:195], v[220:223]
    s_add_u32 m0, s51, 25856
    buffer_load_dwordx4 a[56:59], v2, s[24:27], s85 offen offset:2048 sc1
    v_exp_f32 v226, v226
    v_mfma_f32_16x16x32_bf16 v[220:223], a[220:223], v[196:199], v[220:223]
    s_waitcnt lgkmcnt(10)
    ds_read_b64_tr_b16 a[252:253], v4 offset:43136
    ds_read_b64_tr_b16 a[254:255], v4 offset:43648
    v_mfma_f32_16x16x32_bf16 v[24:27], a[224:227], v[232:235], v[24:27]
    buffer_load_dwordx4 v5, s[12:15], s46 offen lds
    v_mfma_f32_16x16x32_bf16 v[40:43], a[228:231], v[232:235], v[40:43]
    s_waitcnt lgkmcnt(8)
    v_exp_f32 v227, v227
    v_mfma_f32_16x16x32_bf16 v[56:59], a[232:235], v[232:235], v[56:59]
    v_exp_f32 v228, v228
    v_mfma_f32_16x16x32_bf16 v[72:75], a[236:239], v[232:235], v[72:75]
    s_waitcnt lgkmcnt(4)
    v_cvt_pk_bf16_f32 v236, v224, v225
    v_cvt_pk_bf16_f32 v237, v226, v227
    v_mfma_f32_16x16x32_bf16 v[88:91], a[240:243], v[232:235], v[88:91]
    v_exp_f32 v229, v229
    v_mfma_f32_16x16x32_bf16 v[104:107], a[244:247], v[232:235], v[104:107]
    s_waitcnt lgkmcnt(0)
    v_exp_f32 v230, v230
    v_mfma_f32_16x16x32_bf16 v[120:123], a[248:251], v[232:235], v[120:123]
    v_exp_f32 v231, v231
    v_mfma_f32_16x16x32_bf16 v[136:139], a[252:255], v[232:235], v[136:139]
    v_cvt_pk_bf16_f32 v238, v228, v229
    v_cvt_pk_bf16_f32 v239, v230, v231
    v_mfma_f32_16x16x32_bf16 a[160:163], a[176:179], v[232:235], a[160:163]
    s_add_u32 m0, s51, 26688
    v_mfma_f32_16x16x32_bf16 v[224:227], a[192:195], v[200:203], v[252:255]
    buffer_load_dwordx4 v5, s[12:15], s46 offen offset:256 lds
    v_mfma_f32_16x16x32_bf16 v[224:227], a[196:199], v[204:207], v[224:227]
    s_add_u32 s59, s59, 8192
    v_exp_f32 v216, v216
    v_mfma_f32_16x16x32_bf16 v[224:227], a[200:203], v[208:211], v[224:227]
    s_and_b32 s59, s59, 0x1ffff
    v_exp_f32 v217, v217
    v_mfma_f32_16x16x32_bf16 v[224:227], a[204:207], v[212:215], v[224:227]
    s_add_u32 s46, s44, s59
    ds_read_b128 a[192:195], v3 offset:0
    ds_read_b128 a[196:199], v3 offset:64
    v_mfma_f32_16x16x32_bf16 v[228:231], a[208:211], v[200:203], v[252:255]
    v_exp_f32 v218, v218
    v_mfma_f32_16x16x32_bf16 v[228:231], a[212:215], v[204:207], v[228:231]
    v_exp_f32 v219, v219
    v_mfma_f32_16x16x32_bf16 v[228:231], a[216:219], v[208:211], v[228:231]
    ds_read_b128 a[200:203], v3 offset:128
    ds_read_b128 a[204:207], v3 offset:192
    v_mfma_f32_16x16x32_bf16 v[228:231], a[220:223], v[212:215], v[228:231]
    buffer_load_dwordx4 a[60:63], v2, s[24:27], s85 offen offset:3072 sc1
    v_mfma_f32_16x16x32_bf16 v[28:31], a[224:227], v[236:239], v[28:31]
    v_cvt_pk_bf16_f32 v232, v216, v217
    v_cvt_pk_bf16_f32 v233, v218, v219
    v_mfma_f32_16x16x32_bf16 v[44:47], a[228:231], v[236:239], v[44:47]
    v_exp_f32 v220, v220
    v_mfma_f32_16x16x32_bf16 v[60:63], a[232:235], v[236:239], v[60:63]
    ds_read_b128 a[208:211], v3 offset:4352
    ds_read_b128 a[212:215], v3 offset:4416
    v_mfma_f32_16x16x32_bf16 v[76:79], a[236:239], v[236:239], v[76:79]
    buffer_load_dwordx4 a[64:67], v2, s[24:27], s86 offen offset:0 sc1
    v_exp_f32 v221, v221
    v_mfma_f32_16x16x32_bf16 v[92:95], a[240:243], v[236:239], v[92:95]
    v_exp_f32 v222, v222
    v_mfma_f32_16x16x32_bf16 v[108:111], a[244:247], v[236:239], v[108:111]
    v_exp_f32 v223, v223
    v_mfma_f32_16x16x32_bf16 v[124:127], a[248:251], v[236:239], v[124:127]
    ds_read_b128 a[216:219], v3 offset:4480
    ds_read_b128 a[220:223], v3 offset:4544
    v_mfma_f32_16x16x32_bf16 v[140:143], a[252:255], v[236:239], v[140:143]
    buffer_load_dwordx4 a[68:71], v2, s[24:27], s86 offen offset:1024 sc1
    v_mfma_f32_16x16x32_bf16 a[164:167], a[176:179], v[236:239], a[164:167]
    s_waitcnt lgkmcnt(6)
    v_cvt_pk_bf16_f32 v234, v220, v221
    v_cvt_pk_bf16_f32 v235, v222, v223
    v_mfma_f32_16x16x32_bf16 v[216:219], a[192:195], v[152:155], v[240:243]
    v_exp_f32 v224, v224
    v_mfma_f32_16x16x32_bf16 v[216:219], a[196:199], v[156:159], v[216:219]
    s_waitcnt lgkmcnt(4)
    v_exp_f32 v225, v225
    v_mfma_f32_16x16x32_bf16 v[216:219], a[200:203], v[160:163], v[216:219]
    v_exp_f32 v226, v226
    v_mfma_f32_16x16x32_bf16 v[216:219], a[204:207], v[164:167], v[216:219]
    s_waitcnt lgkmcnt(2)
    v_exp_f32 v227, v227
    v_mfma_f32_16x16x32_bf16 v[220:223], a[208:211], v[152:155], v[240:243]
    v_cvt_pk_bf16_f32 v236, v224, v225
    v_cvt_pk_bf16_f32 v237, v226, v227
    v_mfma_f32_16x16x32_bf16 v[220:223], a[212:215], v[156:159], v[220:223]
    s_waitcnt lgkmcnt(0)
    v_mfma_f32_16x16x32_bf16 v[220:223], a[216:219], v[160:163], v[220:223]
    buffer_load_dwordx4 a[72:75], v2, s[24:27], s86 offen offset:2048 sc1
    v_mfma_f32_16x16x32_bf16 v[220:223], a[220:223], v[164:167], v[220:223]
    v_exp_f32 v228, v228
    v_mfma_f32_16x16x32_bf16 v[32:35], a[224:227], v[232:235], v[32:35]
    v_exp_f32 v229, v229
    v_mfma_f32_16x16x32_bf16 v[48:51], a[228:231], v[232:235], v[48:51]
    v_exp_f32 v230, v230
    v_mfma_f32_16x16x32_bf16 v[64:67], a[232:235], v[232:235], v[64:67]
    v_exp_f32 v231, v231
    v_mfma_f32_16x16x32_bf16 v[80:83], a[236:239], v[232:235], v[80:83]
    v_cvt_pk_bf16_f32 v238, v228, v229
    v_cvt_pk_bf16_f32 v239, v230, v231
    v_mfma_f32_16x16x32_bf16 v[96:99], a[240:243], v[232:235], v[96:99]
    v_mfma_f32_16x16x32_bf16 v[112:115], a[244:247], v[232:235], v[112:115]
    buffer_load_dwordx4 a[76:79], v2, s[24:27], s86 offen offset:3072 sc1
    v_mfma_f32_16x16x32_bf16 v[128:131], a[248:251], v[232:235], v[128:131]
    v_mfma_f32_16x16x32_bf16 v[144:147], a[252:255], v[232:235], v[144:147]
    v_mfma_f32_16x16x32_bf16 a[168:171], a[176:179], v[232:235], a[168:171]
    buffer_load_dwordx4 a[80:83], v2, s[24:27], s87 offen offset:0 sc1
    v_mfma_f32_16x16x32_bf16 v[224:227], a[192:195], v[168:171], v[244:247]
    s_waitcnt vmcnt(18)
    s_barrier
    v_mfma_f32_16x16x32_bf16 v[224:227], a[196:199], v[172:175], v[224:227]
    buffer_load_dwordx4 a[84:87], v2, s[24:27], s87 offen offset:1024 sc1
    v_exp_f32 v216, v216
    v_mfma_f32_16x16x32_bf16 v[224:227], a[200:203], v[176:179], v[224:227]
    v_exp_f32 v217, v217
    v_mfma_f32_16x16x32_bf16 v[224:227], a[204:207], v[180:183], v[224:227]
    v_exp_f32 v218, v218
    v_mfma_f32_16x16x32_bf16 v[228:231], a[208:211], v[168:171], v[244:247]
    v_exp_f32 v219, v219
    v_mfma_f32_16x16x32_bf16 v[228:231], a[212:215], v[172:175], v[228:231]
    v_cvt_pk_bf16_f32 v232, v216, v217
    v_cvt_pk_bf16_f32 v233, v218, v219
    v_mfma_f32_16x16x32_bf16 v[228:231], a[216:219], v[176:179], v[228:231]
    s_add_u32 m0, s52, 42912
    v_mfma_f32_16x16x32_bf16 v[228:231], a[220:223], v[180:183], v[228:231]
    buffer_load_dwordx4 v6, s[16:19], s47 offen lds
    v_mfma_f32_16x16x32_bf16 v[36:39], a[224:227], v[236:239], v[36:39]
    v_exp_f32 v220, v220
    v_mfma_f32_16x16x32_bf16 v[52:55], a[228:231], v[236:239], v[52:55]
    ds_read_b64_tr_b16 a[224:225], v4 offset:17408
    ds_read_b64_tr_b16 a[226:227], v4 offset:17920
    v_mfma_f32_16x16x32_bf16 v[68:71], a[232:235], v[236:239], v[68:71]
    v_exp_f32 v221, v221
    v_mfma_f32_16x16x32_bf16 v[84:87], a[236:239], v[236:239], v[84:87]
    ds_read_b64_tr_b16 a[228:229], v4 offset:17440
    ds_read_b64_tr_b16 a[230:231], v4 offset:17952
    v_mfma_f32_16x16x32_bf16 v[100:103], a[240:243], v[236:239], v[100:103]
    buffer_load_dwordx4 a[88:91], v2, s[24:27], s87 offen offset:2048 sc1
    v_exp_f32 v222, v222
    v_mfma_f32_16x16x32_bf16 v[116:119], a[244:247], v[236:239], v[116:119]
    ds_read_b64_tr_b16 a[232:233], v4 offset:17472
    ds_read_b64_tr_b16 a[234:235], v4 offset:17984
    v_mfma_f32_16x16x32_bf16 v[132:135], a[248:251], v[236:239], v[132:135]
    v_exp_f32 v223, v223
    v_mfma_f32_16x16x32_bf16 v[148:151], a[252:255], v[236:239], v[148:151]
    ds_read_b64_tr_b16 a[236:237], v4 offset:17504
    ds_read_b64_tr_b16 a[238:239], v4 offset:18016
    v_mfma_f32_16x16x32_bf16 a[172:175], a[176:179], v[236:239], a[172:175]
    v_cvt_pk_bf16_f32 v234, v220, v221
    v_cvt_pk_bf16_f32 v235, v222, v223
    v_mfma_f32_16x16x32_bf16 v[216:219], a[192:195], v[184:187], v[248:251]
    s_add_u32 m0, s52, 43712
    ds_read_b64_tr_b16 a[240:241], v4 offset:17536
    ds_read_b64_tr_b16 a[242:243], v4 offset:18048
    v_mfma_f32_16x16x32_bf16 v[216:219], a[196:199], v[188:191], v[216:219]
    buffer_load_dwordx4 v6, s[16:19], s47 offen offset:256 lds
    v_mfma_f32_16x16x32_bf16 v[216:219], a[200:203], v[192:195], v[216:219]
    s_add_u32 s60, s60, 8192
    v_exp_f32 v224, v224
    v_mfma_f32_16x16x32_bf16 v[216:219], a[204:207], v[196:199], v[216:219]
    s_and_b32 s60, s60, 0x1ffff
    ds_read_b64_tr_b16 a[244:245], v4 offset:17568
    ds_read_b64_tr_b16 a[246:247], v4 offset:18080
    v_mfma_f32_16x16x32_bf16 v[220:223], a[208:211], v[184:187], v[248:251]
    s_add_u32 s47, s44, s60
    v_exp_f32 v225, v225
    v_mfma_f32_16x16x32_bf16 v[220:223], a[212:215], v[188:191], v[220:223]
    ds_read_b64_tr_b16 a[248:249], v4 offset:17600
    ds_read_b64_tr_b16 a[250:251], v4 offset:18112
    v_mfma_f32_16x16x32_bf16 v[220:223], a[216:219], v[192:195], v[220:223]
    s_add_u32 m0, s51, 0
    buffer_load_dwordx4 a[92:95], v2, s[24:27], s87 offen offset:3072 sc1
    v_exp_f32 v226, v226
    v_mfma_f32_16x16x32_bf16 v[220:223], a[220:223], v[196:199], v[220:223]
    s_waitcnt lgkmcnt(10)
    ds_read_b64_tr_b16 a[252:253], v4 offset:17632
    ds_read_b64_tr_b16 a[254:255], v4 offset:18144
    v_mfma_f32_16x16x32_bf16 v[24:27], a[224:227], v[232:235], v[24:27]
    buffer_load_dwordx4 v5, s[12:15], s46 offen lds
    v_mfma_f32_16x16x32_bf16 v[40:43], a[228:231], v[232:235], v[40:43]
    s_waitcnt lgkmcnt(8)
    v_exp_f32 v227, v227
    v_mfma_f32_16x16x32_bf16 v[56:59], a[232:235], v[232:235], v[56:59]
    v_exp_f32 v228, v228
    v_mfma_f32_16x16x32_bf16 v[72:75], a[236:239], v[232:235], v[72:75]
    s_waitcnt lgkmcnt(4)
    v_cvt_pk_bf16_f32 v236, v224, v225
    v_cvt_pk_bf16_f32 v237, v226, v227
    v_mfma_f32_16x16x32_bf16 v[88:91], a[240:243], v[232:235], v[88:91]
    v_exp_f32 v229, v229
    v_mfma_f32_16x16x32_bf16 v[104:107], a[244:247], v[232:235], v[104:107]
    s_waitcnt lgkmcnt(0)
    v_exp_f32 v230, v230
    v_mfma_f32_16x16x32_bf16 v[120:123], a[248:251], v[232:235], v[120:123]
    v_exp_f32 v231, v231
    v_mfma_f32_16x16x32_bf16 v[136:139], a[252:255], v[232:235], v[136:139]
    v_cvt_pk_bf16_f32 v238, v228, v229
    v_cvt_pk_bf16_f32 v239, v230, v231
    v_mfma_f32_16x16x32_bf16 a[160:163], a[176:179], v[232:235], a[160:163]
    s_add_u32 m0, s51, 832
    v_mfma_f32_16x16x32_bf16 v[224:227], a[192:195], v[200:203], v[252:255]
    buffer_load_dwordx4 v5, s[12:15], s46 offen offset:256 lds
    v_mfma_f32_16x16x32_bf16 v[224:227], a[196:199], v[204:207], v[224:227]
    s_add_u32 s59, s59, 8192
    v_exp_f32 v216, v216
    v_mfma_f32_16x16x32_bf16 v[224:227], a[200:203], v[208:211], v[224:227]
    s_and_b32 s59, s59, 0x1ffff
    v_exp_f32 v217, v217
    v_mfma_f32_16x16x32_bf16 v[224:227], a[204:207], v[212:215], v[224:227]
    s_add_u32 s46, s44, s59
    ds_read_b128 a[192:195], v3 offset:8704
    ds_read_b128 a[196:199], v3 offset:8768
    v_mfma_f32_16x16x32_bf16 v[228:231], a[208:211], v[200:203], v[252:255]
    v_exp_f32 v218, v218
    v_mfma_f32_16x16x32_bf16 v[228:231], a[212:215], v[204:207], v[228:231]
    v_exp_f32 v219, v219
    v_mfma_f32_16x16x32_bf16 v[228:231], a[216:219], v[208:211], v[228:231]
    ds_read_b128 a[200:203], v3 offset:8832
    ds_read_b128 a[204:207], v3 offset:8896
    v_mfma_f32_16x16x32_bf16 v[228:231], a[220:223], v[212:215], v[228:231]
    buffer_load_dwordx4 a[96:99], v2, s[24:27], s88 offen offset:0 sc1
    v_mfma_f32_16x16x32_bf16 v[28:31], a[224:227], v[236:239], v[28:31]
    v_cvt_pk_bf16_f32 v232, v216, v217
    v_cvt_pk_bf16_f32 v233, v218, v219
    v_mfma_f32_16x16x32_bf16 v[44:47], a[228:231], v[236:239], v[44:47]
    v_exp_f32 v220, v220
    v_mfma_f32_16x16x32_bf16 v[60:63], a[232:235], v[236:239], v[60:63]
    ds_read_b128 a[208:211], v3 offset:13056
    ds_read_b128 a[212:215], v3 offset:13120
    v_mfma_f32_16x16x32_bf16 v[76:79], a[236:239], v[236:239], v[76:79]
    buffer_load_dwordx4 a[100:103], v2, s[24:27], s88 offen offset:1024 sc1
    v_exp_f32 v221, v221
    v_mfma_f32_16x16x32_bf16 v[92:95], a[240:243], v[236:239], v[92:95]
    v_exp_f32 v222, v222
    v_mfma_f32_16x16x32_bf16 v[108:111], a[244:247], v[236:239], v[108:111]
    v_exp_f32 v223, v223
    v_mfma_f32_16x16x32_bf16 v[124:127], a[248:251], v[236:239], v[124:127]
    ds_read_b128 a[216:219], v3 offset:13184
    ds_read_b128 a[220:223], v3 offset:13248
    v_mfma_f32_16x16x32_bf16 v[140:143], a[252:255], v[236:239], v[140:143]
    buffer_load_dwordx4 a[104:107], v2, s[24:27], s88 offen offset:2048 sc1
    v_mfma_f32_16x16x32_bf16 a[164:167], a[176:179], v[236:239], a[164:167]
    s_waitcnt lgkmcnt(6)
    v_cvt_pk_bf16_f32 v234, v220, v221
    v_cvt_pk_bf16_f32 v235, v222, v223
    v_mfma_f32_16x16x32_bf16 v[216:219], a[192:195], v[152:155], v[240:243]
    v_exp_f32 v224, v224
    v_mfma_f32_16x16x32_bf16 v[216:219], a[196:199], v[156:159], v[216:219]
    s_waitcnt lgkmcnt(4)
    v_exp_f32 v225, v225
    v_mfma_f32_16x16x32_bf16 v[216:219], a[200:203], v[160:163], v[216:219]
    v_exp_f32 v226, v226
    v_mfma_f32_16x16x32_bf16 v[216:219], a[204:207], v[164:167], v[216:219]
    s_waitcnt lgkmcnt(2)
    v_exp_f32 v227, v227
    v_mfma_f32_16x16x32_bf16 v[220:223], a[208:211], v[152:155], v[240:243]
    v_cvt_pk_bf16_f32 v236, v224, v225
    v_cvt_pk_bf16_f32 v237, v226, v227
    v_mfma_f32_16x16x32_bf16 v[220:223], a[212:215], v[156:159], v[220:223]
    s_waitcnt lgkmcnt(0)
    v_mfma_f32_16x16x32_bf16 v[220:223], a[216:219], v[160:163], v[220:223]
    buffer_load_dwordx4 a[108:111], v2, s[24:27], s88 offen offset:3072 sc1
    v_mfma_f32_16x16x32_bf16 v[220:223], a[220:223], v[164:167], v[220:223]
    v_exp_f32 v228, v228
    v_mfma_f32_16x16x32_bf16 v[32:35], a[224:227], v[232:235], v[32:35]
    v_exp_f32 v229, v229
    v_mfma_f32_16x16x32_bf16 v[48:51], a[228:231], v[232:235], v[48:51]
    v_exp_f32 v230, v230
    v_mfma_f32_16x16x32_bf16 v[64:67], a[232:235], v[232:235], v[64:67]
    v_exp_f32 v231, v231
    v_mfma_f32_16x16x32_bf16 v[80:83], a[236:239], v[232:235], v[80:83]
    v_cvt_pk_bf16_f32 v238, v228, v229
    v_cvt_pk_bf16_f32 v239, v230, v231
    v_mfma_f32_16x16x32_bf16 v[96:99], a[240:243], v[232:235], v[96:99]
    v_mfma_f32_16x16x32_bf16 v[112:115], a[244:247], v[232:235], v[112:115]
    buffer_load_dwordx4 a[112:115], v2, s[24:27], s89 offen offset:0 sc1
    v_mfma_f32_16x16x32_bf16 v[128:131], a[248:251], v[232:235], v[128:131]
    v_mfma_f32_16x16x32_bf16 v[144:147], a[252:255], v[232:235], v[144:147]
    v_mfma_f32_16x16x32_bf16 a[168:171], a[176:179], v[232:235], a[168:171]
    buffer_load_dwordx4 a[116:119], v2, s[24:27], s89 offen offset:1024 sc1
    v_mfma_f32_16x16x32_bf16 v[224:227], a[192:195], v[168:171], v[244:247]
    s_waitcnt vmcnt(19)
    s_barrier
    v_mfma_f32_16x16x32_bf16 v[224:227], a[196:199], v[172:175], v[224:227]
    buffer_load_dwordx4 a[120:123], v2, s[24:27], s89 offen offset:2048 sc1
    v_exp_f32 v216, v216
    v_mfma_f32_16x16x32_bf16 v[224:227], a[200:203], v[176:179], v[224:227]
    v_exp_f32 v217, v217
    v_mfma_f32_16x16x32_bf16 v[224:227], a[204:207], v[180:183], v[224:227]
    v_exp_f32 v218, v218
    v_mfma_f32_16x16x32_bf16 v[228:231], a[208:211], v[168:171], v[244:247]
    v_exp_f32 v219, v219
    v_mfma_f32_16x16x32_bf16 v[228:231], a[212:215], v[172:175], v[228:231]
    v_cvt_pk_bf16_f32 v232, v216, v217
    v_cvt_pk_bf16_f32 v233, v218, v219
    v_mfma_f32_16x16x32_bf16 v[228:231], a[216:219], v[176:179], v[228:231]
    s_add_u32 m0, s52, 17408
    v_mfma_f32_16x16x32_bf16 v[228:231], a[220:223], v[180:183], v[228:231]
    buffer_load_dwordx4 v6, s[16:19], s47 offen lds
    v_mfma_f32_16x16x32_bf16 v[36:39], a[224:227], v[236:239], v[36:39]
    v_exp_f32 v220, v220
    v_mfma_f32_16x16x32_bf16 v[52:55], a[228:231], v[236:239], v[52:55]
    ds_read_b64_tr_b16 a[224:225], v4 offset:34496
    ds_read_b64_tr_b16 a[226:227], v4 offset:35008
    v_mfma_f32_16x16x32_bf16 v[68:71], a[232:235], v[236:239], v[68:71]
    v_exp_f32 v221, v221
    v_mfma_f32_16x16x32_bf16 v[84:87], a[236:239], v[236:239], v[84:87]
    ds_read_b64_tr_b16 a[228:229], v4 offset:34528
    ds_read_b64_tr_b16 a[230:231], v4 offset:35040
    v_mfma_f32_16x16x32_bf16 v[100:103], a[240:243], v[236:239], v[100:103]
    buffer_load_dwordx4 a[124:127], v2, s[24:27], s89 offen offset:3072 sc1
    v_exp_f32 v222, v222
    v_mfma_f32_16x16x32_bf16 v[116:119], a[244:247], v[236:239], v[116:119]
    ds_read_b64_tr_b16 a[232:233], v4 offset:34560
    ds_read_b64_tr_b16 a[234:235], v4 offset:35072
    v_mfma_f32_16x16x32_bf16 v[132:135], a[248:251], v[236:239], v[132:135]
    v_exp_f32 v223, v223
    v_mfma_f32_16x16x32_bf16 v[148:151], a[252:255], v[236:239], v[148:151]
    ds_read_b64_tr_b16 a[236:237], v4 offset:34592
    ds_read_b64_tr_b16 a[238:239], v4 offset:35104
    v_mfma_f32_16x16x32_bf16 a[172:175], a[176:179], v[236:239], a[172:175]
    v_cvt_pk_bf16_f32 v234, v220, v221
    v_cvt_pk_bf16_f32 v235, v222, v223
    v_mfma_f32_16x16x32_bf16 v[216:219], a[192:195], v[184:187], v[248:251]
    s_add_u32 m0, s52, 18208
    ds_read_b64_tr_b16 a[240:241], v4 offset:34624
    ds_read_b64_tr_b16 a[242:243], v4 offset:35136
    v_mfma_f32_16x16x32_bf16 v[216:219], a[196:199], v[188:191], v[216:219]
    buffer_load_dwordx4 v6, s[16:19], s47 offen offset:256 lds
    v_mfma_f32_16x16x32_bf16 v[216:219], a[200:203], v[192:195], v[216:219]
    s_add_u32 s60, s60, 8192
    v_exp_f32 v224, v224
    v_mfma_f32_16x16x32_bf16 v[216:219], a[204:207], v[196:199], v[216:219]
    s_and_b32 s60, s60, 0x1ffff
    ds_read_b64_tr_b16 a[244:245], v4 offset:34656
    ds_read_b64_tr_b16 a[246:247], v4 offset:35168
    v_mfma_f32_16x16x32_bf16 v[220:223], a[208:211], v[184:187], v[248:251]
    s_add_u32 s47, s44, s60
    v_exp_f32 v225, v225
    v_mfma_f32_16x16x32_bf16 v[220:223], a[212:215], v[188:191], v[220:223]
    ds_read_b64_tr_b16 a[248:249], v4 offset:34688
    ds_read_b64_tr_b16 a[250:251], v4 offset:35200
    v_mfma_f32_16x16x32_bf16 v[220:223], a[216:219], v[192:195], v[220:223]
    s_add_u32 m0, s51, 8704
    buffer_load_dwordx4 a[128:131], v2, s[24:27], s90 offen offset:0 sc1
    v_exp_f32 v226, v226
    v_mfma_f32_16x16x32_bf16 v[220:223], a[220:223], v[196:199], v[220:223]
    s_waitcnt lgkmcnt(10)
    ds_read_b64_tr_b16 a[252:253], v4 offset:34720
    ds_read_b64_tr_b16 a[254:255], v4 offset:35232
    v_mfma_f32_16x16x32_bf16 v[24:27], a[224:227], v[232:235], v[24:27]
    buffer_load_dwordx4 v5, s[12:15], s46 offen lds
    v_mfma_f32_16x16x32_bf16 v[40:43], a[228:231], v[232:235], v[40:43]
    s_waitcnt lgkmcnt(8)
    v_exp_f32 v227, v227
    v_mfma_f32_16x16x32_bf16 v[56:59], a[232:235], v[232:235], v[56:59]
    v_exp_f32 v228, v228
    v_mfma_f32_16x16x32_bf16 v[72:75], a[236:239], v[232:235], v[72:75]
    s_waitcnt lgkmcnt(4)
    v_cvt_pk_bf16_f32 v236, v224, v225
    v_cvt_pk_bf16_f32 v237, v226, v227
    v_mfma_f32_16x16x32_bf16 v[88:91], a[240:243], v[232:235], v[88:91]
    v_exp_f32 v229, v229
    v_mfma_f32_16x16x32_bf16 v[104:107], a[244:247], v[232:235], v[104:107]
    s_waitcnt lgkmcnt(0)
    v_exp_f32 v230, v230
    v_mfma_f32_16x16x32_bf16 v[120:123], a[248:251], v[232:235], v[120:123]
    v_exp_f32 v231, v231
    v_mfma_f32_16x16x32_bf16 v[136:139], a[252:255], v[232:235], v[136:139]
    v_cvt_pk_bf16_f32 v238, v228, v229
    v_cvt_pk_bf16_f32 v239, v230, v231
    v_mfma_f32_16x16x32_bf16 a[160:163], a[176:179], v[232:235], a[160:163]
    s_add_u32 m0, s51, 9536
    v_mfma_f32_16x16x32_bf16 v[224:227], a[192:195], v[200:203], v[252:255]
    buffer_load_dwordx4 v5, s[12:15], s46 offen offset:256 lds
    v_mfma_f32_16x16x32_bf16 v[224:227], a[196:199], v[204:207], v[224:227]
    s_add_u32 s59, s59, 8192
    v_exp_f32 v216, v216
    v_mfma_f32_16x16x32_bf16 v[224:227], a[200:203], v[208:211], v[224:227]
    s_and_b32 s59, s59, 0x1ffff
    v_exp_f32 v217, v217
    v_mfma_f32_16x16x32_bf16 v[224:227], a[204:207], v[212:215], v[224:227]
    s_add_u32 s46, s44, s59
    ds_read_b128 a[192:195], v3 offset:25856
    ds_read_b128 a[196:199], v3 offset:25920
    v_mfma_f32_16x16x32_bf16 v[228:231], a[208:211], v[200:203], v[252:255]
    v_exp_f32 v218, v218
    v_mfma_f32_16x16x32_bf16 v[228:231], a[212:215], v[204:207], v[228:231]
    v_exp_f32 v219, v219
    v_mfma_f32_16x16x32_bf16 v[228:231], a[216:219], v[208:211], v[228:231]
    ds_read_b128 a[200:203], v3 offset:25984
    ds_read_b128 a[204:207], v3 offset:26048
    v_mfma_f32_16x16x32_bf16 v[228:231], a[220:223], v[212:215], v[228:231]
    buffer_load_dwordx4 a[132:135], v2, s[24:27], s90 offen offset:1024 sc1
    v_mfma_f32_16x16x32_bf16 v[28:31], a[224:227], v[236:239], v[28:31]
    v_cvt_pk_bf16_f32 v232, v216, v217
    v_cvt_pk_bf16_f32 v233, v218, v219
    v_mfma_f32_16x16x32_bf16 v[44:47], a[228:231], v[236:239], v[44:47]
    v_exp_f32 v220, v220
    v_mfma_f32_16x16x32_bf16 v[60:63], a[232:235], v[236:239], v[60:63]
    ds_read_b128 a[208:211], v3 offset:30208
    ds_read_b128 a[212:215], v3 offset:30272
    v_mfma_f32_16x16x32_bf16 v[76:79], a[236:239], v[236:239], v[76:79]
    buffer_load_dwordx4 a[136:139], v2, s[24:27], s90 offen offset:2048 sc1
    v_exp_f32 v221, v221
    v_mfma_f32_16x16x32_bf16 v[92:95], a[240:243], v[236:239], v[92:95]
    v_exp_f32 v222, v222
    v_mfma_f32_16x16x32_bf16 v[108:111], a[244:247], v[236:239], v[108:111]
    v_exp_f32 v223, v223
    v_mfma_f32_16x16x32_bf16 v[124:127], a[248:251], v[236:239], v[124:127]
    ds_read_b128 a[216:219], v3 offset:30336
    ds_read_b128 a[220:223], v3 offset:30400
    v_mfma_f32_16x16x32_bf16 v[140:143], a[252:255], v[236:239], v[140:143]
    buffer_load_dwordx4 a[140:143], v2, s[24:27], s90 offen offset:3072 sc1
    v_mfma_f32_16x16x32_bf16 a[164:167], a[176:179], v[236:239], a[164:167]
    s_waitcnt lgkmcnt(6)
    v_cvt_pk_bf16_f32 v234, v220, v221
    v_cvt_pk_bf16_f32 v235, v222, v223
    v_mfma_f32_16x16x32_bf16 v[216:219], a[192:195], v[152:155], v[240:243]
    v_exp_f32 v224, v224
    v_mfma_f32_16x16x32_bf16 v[216:219], a[196:199], v[156:159], v[216:219]
    s_waitcnt lgkmcnt(4)
    v_exp_f32 v225, v225
    v_mfma_f32_16x16x32_bf16 v[216:219], a[200:203], v[160:163], v[216:219]
    v_exp_f32 v226, v226
    v_mfma_f32_16x16x32_bf16 v[216:219], a[204:207], v[164:167], v[216:219]
    s_waitcnt lgkmcnt(2)
    v_exp_f32 v227, v227
    v_mfma_f32_16x16x32_bf16 v[220:223], a[208:211], v[152:155], v[240:243]
    v_cvt_pk_bf16_f32 v236, v224, v225
    v_cvt_pk_bf16_f32 v237, v226, v227
    v_mfma_f32_16x16x32_bf16 v[220:223], a[212:215], v[156:159], v[220:223]
    s_waitcnt lgkmcnt(0)
    v_mfma_f32_16x16x32_bf16 v[220:223], a[216:219], v[160:163], v[220:223]
    buffer_load_dwordx4 a[144:147], v2, s[24:27], s91 offen offset:0 sc1
    v_mfma_f32_16x16x32_bf16 v[220:223], a[220:223], v[164:167], v[220:223]
    v_exp_f32 v228, v228
    v_mfma_f32_16x16x32_bf16 v[32:35], a[224:227], v[232:235], v[32:35]
    v_exp_f32 v229, v229
    v_mfma_f32_16x16x32_bf16 v[48:51], a[228:231], v[232:235], v[48:51]
    v_exp_f32 v230, v230
    v_mfma_f32_16x16x32_bf16 v[64:67], a[232:235], v[232:235], v[64:67]
    v_exp_f32 v231, v231
    v_mfma_f32_16x16x32_bf16 v[80:83], a[236:239], v[232:235], v[80:83]
    v_cvt_pk_bf16_f32 v238, v228, v229
    v_cvt_pk_bf16_f32 v239, v230, v231
    v_mfma_f32_16x16x32_bf16 v[96:99], a[240:243], v[232:235], v[96:99]
    v_mfma_f32_16x16x32_bf16 v[112:115], a[244:247], v[232:235], v[112:115]
    buffer_load_dwordx4 a[148:151], v2, s[24:27], s91 offen offset:1024 sc1
    v_mfma_f32_16x16x32_bf16 v[128:131], a[248:251], v[232:235], v[128:131]
    v_mfma_f32_16x16x32_bf16 v[144:147], a[252:255], v[232:235], v[144:147]
    v_mfma_f32_16x16x32_bf16 a[168:171], a[176:179], v[232:235], a[168:171]
    buffer_load_dwordx4 a[152:155], v2, s[24:27], s91 offen offset:2048 sc1
    v_mfma_f32_16x16x32_bf16 v[224:227], a[192:195], v[168:171], v[244:247]
    s_waitcnt vmcnt(19)
    s_barrier
    v_mfma_f32_16x16x32_bf16 v[224:227], a[196:199], v[172:175], v[224:227]
    buffer_load_dwordx4 a[156:159], v2, s[24:27], s91 offen offset:3072 sc1
    v_exp_f32 v216, v216
    v_mfma_f32_16x16x32_bf16 v[224:227], a[200:203], v[176:179], v[224:227]
    v_exp_f32 v217, v217
    v_mfma_f32_16x16x32_bf16 v[224:227], a[204:207], v[180:183], v[224:227]
    v_exp_f32 v218, v218
    v_mfma_f32_16x16x32_bf16 v[228:231], a[208:211], v[168:171], v[244:247]
    v_exp_f32 v219, v219
    v_mfma_f32_16x16x32_bf16 v[228:231], a[212:215], v[172:175], v[228:231]
    v_cvt_pk_bf16_f32 v232, v216, v217
    v_cvt_pk_bf16_f32 v233, v218, v219
    v_mfma_f32_16x16x32_bf16 v[228:231], a[216:219], v[176:179], v[228:231]
    s_add_u32 m0, s52, 34496
    v_mfma_f32_16x16x32_bf16 v[228:231], a[220:223], v[180:183], v[228:231]
    buffer_load_dwordx4 v6, s[16:19], s47 offen lds
    v_mfma_f32_16x16x32_bf16 v[36:39], a[224:227], v[236:239], v[36:39]
    v_exp_f32 v220, v220
    v_mfma_f32_16x16x32_bf16 v[52:55], a[228:231], v[236:239], v[52:55]
    ds_read_b64_tr_b16 a[224:225], v4 offset:42912
    ds_read_b64_tr_b16 a[226:227], v4 offset:43424
    v_mfma_f32_16x16x32_bf16 v[68:71], a[232:235], v[236:239], v[68:71]
    v_exp_f32 v221, v221
    v_mfma_f32_16x16x32_bf16 v[84:87], a[236:239], v[236:239], v[84:87]
    ds_read_b64_tr_b16 a[228:229], v4 offset:42944
    ds_read_b64_tr_b16 a[230:231], v4 offset:43456
    v_mfma_f32_16x16x32_bf16 v[100:103], a[240:243], v[236:239], v[100:103]
    buffer_load_dwordx4 a[0:3], v2, s[24:27], s92 offen offset:0 sc1
    v_exp_f32 v222, v222
    v_mfma_f32_16x16x32_bf16 v[116:119], a[244:247], v[236:239], v[116:119]
    ds_read_b64_tr_b16 a[232:233], v4 offset:42976
    ds_read_b64_tr_b16 a[234:235], v4 offset:43488
    v_mfma_f32_16x16x32_bf16 v[132:135], a[248:251], v[236:239], v[132:135]
    v_exp_f32 v223, v223
    v_mfma_f32_16x16x32_bf16 v[148:151], a[252:255], v[236:239], v[148:151]
    ds_read_b64_tr_b16 a[236:237], v4 offset:43008
    ds_read_b64_tr_b16 a[238:239], v4 offset:43520
    v_mfma_f32_16x16x32_bf16 a[172:175], a[176:179], v[236:239], a[172:175]
    v_cvt_pk_bf16_f32 v234, v220, v221
    v_cvt_pk_bf16_f32 v235, v222, v223
    v_mfma_f32_16x16x32_bf16 v[216:219], a[192:195], v[184:187], v[248:251]
    s_add_u32 m0, s52, 35296
    ds_read_b64_tr_b16 a[240:241], v4 offset:43040
    ds_read_b64_tr_b16 a[242:243], v4 offset:43552
    v_mfma_f32_16x16x32_bf16 v[216:219], a[196:199], v[188:191], v[216:219]
    buffer_load_dwordx4 v6, s[16:19], s47 offen offset:256 lds
    v_mfma_f32_16x16x32_bf16 v[216:219], a[200:203], v[192:195], v[216:219]
    s_add_u32 s60, s60, 8192
    v_exp_f32 v224, v224
    v_mfma_f32_16x16x32_bf16 v[216:219], a[204:207], v[196:199], v[216:219]
    s_and_b32 s60, s60, 0x1ffff
    ds_read_b64_tr_b16 a[244:245], v4 offset:43072
    ds_read_b64_tr_b16 a[246:247], v4 offset:43584
    v_mfma_f32_16x16x32_bf16 v[220:223], a[208:211], v[184:187], v[248:251]
    s_add_u32 s47, s44, s60
    v_exp_f32 v225, v225
    v_mfma_f32_16x16x32_bf16 v[220:223], a[212:215], v[188:191], v[220:223]
    ds_read_b64_tr_b16 a[248:249], v4 offset:43104
    ds_read_b64_tr_b16 a[250:251], v4 offset:43616
    v_mfma_f32_16x16x32_bf16 v[220:223], a[216:219], v[192:195], v[220:223]
    s_add_u32 m0, s51, 25856
    buffer_load_dwordx4 a[4:7], v2, s[24:27], s92 offen offset:1024 sc1
    v_exp_f32 v226, v226
    v_mfma_f32_16x16x32_bf16 v[220:223], a[220:223], v[196:199], v[220:223]
    s_waitcnt lgkmcnt(10)
    ds_read_b64_tr_b16 a[252:253], v4 offset:43136
    ds_read_b64_tr_b16 a[254:255], v4 offset:43648
    v_mfma_f32_16x16x32_bf16 v[24:27], a[224:227], v[232:235], v[24:27]
    buffer_load_dwordx4 v5, s[12:15], s46 offen lds
    v_mfma_f32_16x16x32_bf16 v[40:43], a[228:231], v[232:235], v[40:43]
    s_waitcnt lgkmcnt(8)
    v_exp_f32 v227, v227
    v_mfma_f32_16x16x32_bf16 v[56:59], a[232:235], v[232:235], v[56:59]
    v_exp_f32 v228, v228
    v_mfma_f32_16x16x32_bf16 v[72:75], a[236:239], v[232:235], v[72:75]
    s_waitcnt lgkmcnt(4)
    v_cvt_pk_bf16_f32 v236, v224, v225
    v_cvt_pk_bf16_f32 v237, v226, v227
    v_mfma_f32_16x16x32_bf16 v[88:91], a[240:243], v[232:235], v[88:91]
    v_exp_f32 v229, v229
    v_mfma_f32_16x16x32_bf16 v[104:107], a[244:247], v[232:235], v[104:107]
    s_waitcnt lgkmcnt(0)
    v_exp_f32 v230, v230
    v_mfma_f32_16x16x32_bf16 v[120:123], a[248:251], v[232:235], v[120:123]
    v_exp_f32 v231, v231
    v_mfma_f32_16x16x32_bf16 v[136:139], a[252:255], v[232:235], v[136:139]
    v_cvt_pk_bf16_f32 v238, v228, v229
    v_cvt_pk_bf16_f32 v239, v230, v231
    v_mfma_f32_16x16x32_bf16 a[160:163], a[176:179], v[232:235], a[160:163]
    s_add_u32 m0, s51, 26688
    v_mfma_f32_16x16x32_bf16 v[224:227], a[192:195], v[200:203], v[252:255]
    buffer_load_dwordx4 v5, s[12:15], s46 offen offset:256 lds
    v_mfma_f32_16x16x32_bf16 v[224:227], a[196:199], v[204:207], v[224:227]
    s_add_u32 s59, s59, 8192
    v_exp_f32 v216, v216
    v_mfma_f32_16x16x32_bf16 v[224:227], a[200:203], v[208:211], v[224:227]
    s_and_b32 s59, s59, 0x1ffff
    v_exp_f32 v217, v217
    v_mfma_f32_16x16x32_bf16 v[224:227], a[204:207], v[212:215], v[224:227]
    s_add_u32 s46, s44, s59
    ds_read_b128 a[192:195], v3 offset:0
    ds_read_b128 a[196:199], v3 offset:64
    v_mfma_f32_16x16x32_bf16 v[228:231], a[208:211], v[200:203], v[252:255]
    v_exp_f32 v218, v218
    v_mfma_f32_16x16x32_bf16 v[228:231], a[212:215], v[204:207], v[228:231]
    v_exp_f32 v219, v219
    v_mfma_f32_16x16x32_bf16 v[228:231], a[216:219], v[208:211], v[228:231]
    ds_read_b128 a[200:203], v3 offset:128
    ds_read_b128 a[204:207], v3 offset:192
    v_mfma_f32_16x16x32_bf16 v[228:231], a[220:223], v[212:215], v[228:231]
    buffer_load_dwordx4 a[8:11], v2, s[24:27], s92 offen offset:2048 sc1
    v_mfma_f32_16x16x32_bf16 v[28:31], a[224:227], v[236:239], v[28:31]
    v_cvt_pk_bf16_f32 v232, v216, v217
    v_cvt_pk_bf16_f32 v233, v218, v219
    v_mfma_f32_16x16x32_bf16 v[44:47], a[228:231], v[236:239], v[44:47]
    v_exp_f32 v220, v220
    v_mfma_f32_16x16x32_bf16 v[60:63], a[232:235], v[236:239], v[60:63]
    ds_read_b128 a[208:211], v3 offset:4352
    ds_read_b128 a[212:215], v3 offset:4416
    v_mfma_f32_16x16x32_bf16 v[76:79], a[236:239], v[236:239], v[76:79]
    buffer_load_dwordx4 a[12:15], v2, s[24:27], s92 offen offset:3072 sc1
    v_exp_f32 v221, v221
    v_mfma_f32_16x16x32_bf16 v[92:95], a[240:243], v[236:239], v[92:95]
    v_exp_f32 v222, v222
    v_mfma_f32_16x16x32_bf16 v[108:111], a[244:247], v[236:239], v[108:111]
    v_exp_f32 v223, v223
    v_mfma_f32_16x16x32_bf16 v[124:127], a[248:251], v[236:239], v[124:127]
    ds_read_b128 a[216:219], v3 offset:4480
    ds_read_b128 a[220:223], v3 offset:4544
    v_mfma_f32_16x16x32_bf16 v[140:143], a[252:255], v[236:239], v[140:143]
    buffer_load_dwordx4 a[16:19], v2, s[24:27], s93 offen offset:0 sc1
    v_mfma_f32_16x16x32_bf16 a[164:167], a[176:179], v[236:239], a[164:167]
    s_waitcnt lgkmcnt(6)
    v_cvt_pk_bf16_f32 v234, v220, v221
    v_cvt_pk_bf16_f32 v235, v222, v223
    v_mfma_f32_16x16x32_bf16 v[216:219], a[192:195], v[152:155], v[240:243]
    v_exp_f32 v224, v224
    v_mfma_f32_16x16x32_bf16 v[216:219], a[196:199], v[156:159], v[216:219]
    s_waitcnt lgkmcnt(4)
    v_exp_f32 v225, v225
    v_mfma_f32_16x16x32_bf16 v[216:219], a[200:203], v[160:163], v[216:219]
    v_exp_f32 v226, v226
    v_mfma_f32_16x16x32_bf16 v[216:219], a[204:207], v[164:167], v[216:219]
    s_waitcnt lgkmcnt(2)
    v_exp_f32 v227, v227
    v_mfma_f32_16x16x32_bf16 v[220:223], a[208:211], v[152:155], v[240:243]
    v_cvt_pk_bf16_f32 v236, v224, v225
    v_cvt_pk_bf16_f32 v237, v226, v227
    v_mfma_f32_16x16x32_bf16 v[220:223], a[212:215], v[156:159], v[220:223]
    s_waitcnt lgkmcnt(0)
    v_mfma_f32_16x16x32_bf16 v[220:223], a[216:219], v[160:163], v[220:223]
    buffer_load_dwordx4 a[20:23], v2, s[24:27], s93 offen offset:1024 sc1
    v_mfma_f32_16x16x32_bf16 v[220:223], a[220:223], v[164:167], v[220:223]
    v_exp_f32 v228, v228
    v_mfma_f32_16x16x32_bf16 v[32:35], a[224:227], v[232:235], v[32:35]
    v_exp_f32 v229, v229
    v_mfma_f32_16x16x32_bf16 v[48:51], a[228:231], v[232:235], v[48:51]
    v_exp_f32 v230, v230
    v_mfma_f32_16x16x32_bf16 v[64:67], a[232:235], v[232:235], v[64:67]
    v_exp_f32 v231, v231
    v_mfma_f32_16x16x32_bf16 v[80:83], a[236:239], v[232:235], v[80:83]
    v_cvt_pk_bf16_f32 v238, v228, v229
    v_cvt_pk_bf16_f32 v239, v230, v231
    v_mfma_f32_16x16x32_bf16 v[96:99], a[240:243], v[232:235], v[96:99]
    v_mfma_f32_16x16x32_bf16 v[112:115], a[244:247], v[232:235], v[112:115]
    s_lshr_b32 s64, s2, 3
    s_lshl2_add_u32 s64, s64, s3
    s_lshl_b32 s64, s64, 7
    s_add_u32 s64, s64, 2048
    s_min_u32 s64, s64, L_code_end - L_ct_3 - 64
    s_getpc_b64 s[100:101]
L_ct_3:
    s_add_u32 s100, s100, s64
    s_addc_u32 s101, s101, 0
    global_load_ubyte v23, v1, s[100:101]
    v_mfma_f32_16x16x32_bf16 v[128:131], a[248:251], v[232:235], v[128:131]
    v_mfma_f32_16x16x32_bf16 v[144:147], a[252:255], v[232:235], v[144:147]
    v_mfma_f32_16x16x32_bf16 a[168:171], a[176:179], v[232:235], a[168:171]
    buffer_load_dwordx4 a[24:27], v2, s[24:27], s93 offen offset:2048 sc1
    v_mfma_f32_16x16x32_bf16 v[224:227], a[192:195], v[168:171], v[244:247]
    s_waitcnt vmcnt(19)
    s_barrier
    v_mfma_f32_16x16x32_bf16 v[224:227], a[196:199], v[172:175], v[224:227]
    buffer_load_dwordx4 a[28:31], v2, s[24:27], s93 offen offset:3072 sc1
    v_exp_f32 v216, v216
    v_mfma_f32_16x16x32_bf16 v[224:227], a[200:203], v[176:179], v[224:227]
    v_exp_f32 v217, v217
    v_mfma_f32_16x16x32_bf16 v[224:227], a[204:207], v[180:183], v[224:227]
    v_exp_f32 v218, v218
    v_mfma_f32_16x16x32_bf16 v[228:231], a[208:211], v[168:171], v[244:247]
    v_exp_f32 v219, v219
    v_mfma_f32_16x16x32_bf16 v[228:231], a[212:215], v[172:175], v[228:231]
    v_cvt_pk_bf16_f32 v232, v216, v217
    v_cvt_pk_bf16_f32 v233, v218, v219
    v_mfma_f32_16x16x32_bf16 v[228:231], a[216:219], v[176:179], v[228:231]
    s_add_u32 m0, s52, 42912
    v_mfma_f32_16x16x32_bf16 v[228:231], a[220:223], v[180:183], v[228:231]
    buffer_load_dwordx4 v6, s[16:19], s47 offen lds
    v_mfma_f32_16x16x32_bf16 v[36:39], a[224:227], v[236:239], v[36:39]
    v_exp_f32 v220, v220
    v_mfma_f32_16x16x32_bf16 v[52:55], a[228:231], v[236:239], v[52:55]
    ds_read_b64_tr_b16 a[224:225], v4 offset:17408
    ds_read_b64_tr_b16 a[226:227], v4 offset:17920
    v_mfma_f32_16x16x32_bf16 v[68:71], a[232:235], v[236:239], v[68:71]
    v_exp_f32 v221, v221
    v_mfma_f32_16x16x32_bf16 v[84:87], a[236:239], v[236:239], v[84:87]
    ds_read_b64_tr_b16 a[228:229], v4 offset:17440
    ds_read_b64_tr_b16 a[230:231], v4 offset:17952
    v_mfma_f32_16x16x32_bf16 v[100:103], a[240:243], v[236:239], v[100:103]
    buffer_load_dword v23, v13, s[24:27], s68 offen sc1
    v_exp_f32 v222, v222
    v_mfma_f32_16x16x32_bf16 v[116:119], a[244:247], v[236:239], v[116:119]
    s_mov_b32 s68, 16384
    ds_read_b64_tr_b16 a[232:233], v4 offset:17472
    ds_read_b64_tr_b16 a[234:235], v4 offset:17984
    v_mfma_f32_16x16x32_bf16 v[132:135], a[248:251], v[236:239], v[132:135]
    v_exp_f32 v223, v223
    v_mfma_f32_16x16x32_bf16 v[148:151], a[252:255], v[236:239], v[148:151]
    ds_read_b64_tr_b16 a[236:237], v4 offset:17504
    ds_read_b64_tr_b16 a[238:239], v4 offset:18016
    v_mfma_f32_16x16x32_bf16 a[172:175], a[176:179], v[236:239], a[172:175]
    v_cvt_pk_bf16_f32 v234, v220, v221
    v_cvt_pk_bf16_f32 v235, v222, v223
    v_mfma_f32_16x16x32_bf16 v[216:219], a[192:195], v[184:187], v[248:251]
    s_add_u32 m0, s52, 43712
    ds_read_b64_tr_b16 a[240:241], v4 offset:17536
    ds_read_b64_tr_b16 a[242:243], v4 offset:18048
    v_mfma_f32_16x16x32_bf16 v[216:219], a[196:199], v[188:191], v[216:219]
    buffer_load_dwordx4 v6, s[16:19], s47 offen offset:256 lds
    v_mfma_f32_16x16x32_bf16 v[216:219], a[200:203], v[192:195], v[216:219]
    s_add_u32 s60, s60, 8192
    v_exp_f32 v224, v224
    v_mfma_f32_16x16x32_bf16 v[216:219], a[204:207], v[196:199], v[216:219]
    s_and_b32 s60, s60, 0x1ffff
    ds_read_b64_tr_b16 a[244:245], v4 offset:17568
    ds_read_b64_tr_b16 a[246:247], v4 offset:18080
    v_mfma_f32_16x16x32_bf16 v[220:223], a[208:211], v[184:187], v[248:251]
    s_add_u32 s47, s44, s60
    v_exp_f32 v225, v225
    v_mfma_f32_16x16x32_bf16 v[220:223], a[212:215], v[188:191], v[220:223]
    ds_read_b64_tr_b16 a[248:249], v4 offset:17600
    ds_read_b64_tr_b16 a[250:251], v4 offset:18112
    v_mfma_f32_16x16x32_bf16 v[220:223], a[216:219], v[192:195], v[220:223]
    s_add_u32 m0, s51, 0
    buffer_load_dword v23, v13, s[24:27], s68 offen sc1
    v_exp_f32 v226, v226
    v_mfma_f32_16x16x32_bf16 v[220:223], a[220:223], v[196:199], v[220:223]
    s_waitcnt lgkmcnt(10)
    ds_read_b64_tr_b16 a[252:253], v4 offset:17632
    ds_read_b64_tr_b16 a[254:255], v4 offset:18144
    v_mfma_f32_16x16x32_bf16 v[24:27], a[224:227], v[232:235], v[24:27]
    s_mov_b32 s68, 32768
    buffer_load_dwordx4 v5, s[12:15], s46 offen lds
    v_mfma_f32_16x16x32_bf16 v[40:43], a[228:231], v[232:235], v[40:43]
    s_waitcnt lgkmcnt(8)
    v_exp_f32 v227, v227
    v_mfma_f32_16x16x32_bf16 v[56:59], a[232:235], v[232:235], v[56:59]
    v_exp_f32 v228, v228
    v_mfma_f32_16x16x32_bf16 v[72:75], a[236:239], v[232:235], v[72:75]
    s_waitcnt lgkmcnt(4)
    v_cvt_pk_bf16_f32 v236, v224, v225
    v_cvt_pk_bf16_f32 v237, v226, v227
    v_mfma_f32_16x16x32_bf16 v[88:91], a[240:243], v[232:235], v[88:91]
    v_exp_f32 v229, v229
    v_mfma_f32_16x16x32_bf16 v[104:107], a[244:247], v[232:235], v[104:107]
    s_waitcnt lgkmcnt(0)
    v_exp_f32 v230, v230
    v_mfma_f32_16x16x32_bf16 v[120:123], a[248:251], v[232:235], v[120:123]
    v_exp_f32 v231, v231
    v_mfma_f32_16x16x32_bf16 v[136:139], a[252:255], v[232:235], v[136:139]
    v_cvt_pk_bf16_f32 v238, v228, v229
    v_cvt_pk_bf16_f32 v239, v230, v231
    v_mfma_f32_16x16x32_bf16 a[160:163], a[176:179], v[232:235], a[160:163]
    s_add_u32 m0, s51, 832
    v_mfma_f32_16x16x32_bf16 v[224:227], a[192:195], v[200:203], v[252:255]
    buffer_load_dwordx4 v5, s[12:15], s46 offen offset:256 lds
    v_mfma_f32_16x16x32_bf16 v[224:227], a[196:199], v[204:207], v[224:227]
    s_add_u32 s59, s59, 8192
    v_exp_f32 v216, v216
    v_mfma_f32_16x16x32_bf16 v[224:227], a[200:203], v[208:211], v[224:227]
    s_and_b32 s59, s59, 0x1ffff
    v_exp_f32 v217, v217
    v_mfma_f32_16x16x32_bf16 v[224:227], a[204:207], v[212:215], v[224:227]
    s_add_u32 s46, s44, s59
    ds_read_b128 a[192:195], v3 offset:8704
    ds_read_b128 a[196:199], v3 offset:8768
    v_mfma_f32_16x16x32_bf16 v[228:231], a[208:211], v[200:203], v[252:255]
    v_exp_f32 v218, v218
    v_mfma_f32_16x16x32_bf16 v[228:231], a[212:215], v[204:207], v[228:231]
    v_exp_f32 v219, v219
    v_mfma_f32_16x16x32_bf16 v[228:231], a[216:219], v[208:211], v[228:231]
    s_add_u32 m0, s52, 152576
    ds_read_b128 a[200:203], v3 offset:8832
    ds_read_b128 a[204:207], v3 offset:8896
    v_mfma_f32_16x16x32_bf16 v[228:231], a[220:223], v[212:215], v[228:231]
    buffer_load_dwordx4 v6, s[16:19], s47 offen lds
    v_mfma_f32_16x16x32_bf16 v[28:31], a[224:227], v[236:239], v[28:31]
    v_cvt_pk_bf16_f32 v232, v216, v217
    v_cvt_pk_bf16_f32 v233, v218, v219
    v_mfma_f32_16x16x32_bf16 v[44:47], a[228:231], v[236:239], v[44:47]
    v_exp_f32 v220, v220
    v_mfma_f32_16x16x32_bf16 v[60:63], a[232:235], v[236:239], v[60:63]
    ds_read_b128 a[208:211], v3 offset:13056
    ds_read_b128 a[212:215], v3 offset:13120
    v_mfma_f32_16x16x32_bf16 v[76:79], a[236:239], v[236:239], v[76:79]
    buffer_load_dword v23, v13, s[24:27], s68 offen sc1
    v_exp_f32 v221, v221
    v_mfma_f32_16x16x32_bf16 v[92:95], a[240:243], v[236:239], v[92:95]
    s_mov_b32 s68, 4096
    v_exp_f32 v222, v222
    v_mfma_f32_16x16x32_bf16 v[108:111], a[244:247], v[236:239], v[108:111]
    v_exp_f32 v223, v223
    v_mfma_f32_16x16x32_bf16 v[124:127], a[248:251], v[236:239], v[124:127]
    s_add_u32 m0, s52, 153376
    ds_read_b128 a[216:219], v3 offset:13184
    ds_read_b128 a[220:223], v3 offset:13248
    v_mfma_f32_16x16x32_bf16 v[140:143], a[252:255], v[236:239], v[140:143]
    buffer_load_dwordx4 v6, s[16:19], s47 offen offset:256 lds
    v_mfma_f32_16x16x32_bf16 a[164:167], a[176:179], v[236:239], a[164:167]
    s_waitcnt lgkmcnt(6)
    v_cvt_pk_bf16_f32 v234, v220, v221
    v_cvt_pk_bf16_f32 v235, v222, v223
    v_mfma_f32_16x16x32_bf16 v[216:219], a[192:195], v[152:155], v[240:243]
    s_add_u32 s60, s60, 8192
    v_exp_f32 v224, v224
    v_mfma_f32_16x16x32_bf16 v[216:219], a[196:199], v[156:159], v[216:219]
    s_waitcnt lgkmcnt(4)
    v_exp_f32 v225, v225
    v_mfma_f32_16x16x32_bf16 v[216:219], a[200:203], v[160:163], v[216:219]
    s_and_b32 s60, s60, 0x1ffff
    v_exp_f32 v226, v226
    v_mfma_f32_16x16x32_bf16 v[216:219], a[204:207], v[164:167], v[216:219]
    s_waitcnt lgkmcnt(2)
    v_exp_f32 v227, v227
    v_mfma_f32_16x16x32_bf16 v[220:223], a[208:211], v[152:155], v[240:243]
    s_add_u32 s47, s44, s60
    v_cvt_pk_bf16_f32 v236, v224, v225
    v_cvt_pk_bf16_f32 v237, v226, v227
    v_mfma_f32_16x16x32_bf16 v[220:223], a[212:215], v[156:159], v[220:223]
    s_waitcnt lgkmcnt(0)
    v_mfma_f32_16x16x32_bf16 v[220:223], a[216:219], v[160:163], v[220:223]
    buffer_load_dword v23, v13, s[24:27], s68 offen sc1
    v_mfma_f32_16x16x32_bf16 v[220:223], a[220:223], v[164:167], v[220:223]
    s_mov_b32 s68, 20480
    v_exp_f32 v228, v228
    v_mfma_f32_16x16x32_bf16 v[32:35], a[224:227], v[232:235], v[32:35]
    v_exp_f32 v229, v229
    v_mfma_f32_16x16x32_bf16 v[48:51], a[228:231], v[232:235], v[48:51]
    v_exp_f32 v230, v230
    v_mfma_f32_16x16x32_bf16 v[64:67], a[232:235], v[232:235], v[64:67]
    v_exp_f32 v231, v231
    v_mfma_f32_16x16x32_bf16 v[80:83], a[236:239], v[232:235], v[80:83]
    v_cvt_pk_bf16_f32 v238, v228, v229
    v_cvt_pk_bf16_f32 v239, v230, v231
    v_mfma_f32_16x16x32_bf16 v[96:99], a[240:243], v[232:235], v[96:99]
    v_mfma_f32_16x16x32_bf16 v[112:115], a[244:247], v[232:235], v[112:115]
    buffer_load_dword v23, v13, s[24:27], s68 offen sc1
    v_mfma_f32_16x16x32_bf16 v[128:131], a[248:251], v[232:235], v[128:131]
    s_mov_b32 s68, 36864
    v_mfma_f32_16x16x32_bf16 v[144:147], a[252:255], v[232:235], v[144:147]
    v_mfma_f32_16x16x32_bf16 a[168:171], a[176:179], v[232:235], a[168:171]
    buffer_load_dword v23, v13, s[24:27], s68 offen sc1
    v_mfma_f32_16x16x32_bf16 v[224:227], a[192:195], v[168:171], v[244:247]
    s_waitcnt vmcnt(19)
    s_barrier
    v_exp_f32 v216, v216
    v_mfma_f32_16x16x32_bf16 v[224:227], a[196:199], v[172:175], v[224:227]
    s_mov_b32 s68, 8192
    v_exp_f32 v217, v217
    v_mfma_f32_16x16x32_bf16 v[224:227], a[200:203], v[176:179], v[224:227]
    ds_read_b128 a[192:195], v3 offset:25856
    ds_read_b128 a[196:199], v3 offset:25920
    v_mfma_f32_16x16x32_bf16 v[224:227], a[204:207], v[180:183], v[224:227]
    buffer_load_dword v23, v13, s[24:27], s68 offen sc1
    v_exp_f32 v218, v218
    v_mfma_f32_16x16x32_bf16 v[228:231], a[208:211], v[168:171], v[244:247]
    s_mov_b32 s68, 24576
    ds_read_b128 a[200:203], v3 offset:25984
    ds_read_b128 a[204:207], v3 offset:26048
    v_mfma_f32_16x16x32_bf16 v[228:231], a[212:215], v[172:175], v[228:231]
    v_exp_f32 v219, v219
    v_mfma_f32_16x16x32_bf16 v[228:231], a[216:219], v[176:179], v[228:231]
    ds_read_b128 a[208:211], v3 offset:30208
    ds_read_b128 a[212:215], v3 offset:30272
    v_mfma_f32_16x16x32_bf16 v[228:231], a[220:223], v[180:183], v[228:231]
    buffer_load_dword v23, v13, s[24:27], s68 offen sc1
    v_exp_f32 v220, v220
    v_mfma_f32_16x16x32_bf16 v[36:39], a[224:227], v[236:239], v[36:39]
    s_mov_b32 s68, 40960
    ds_read_b128 a[216:219], v3 offset:30336
    ds_read_b128 a[220:223], v3 offset:30400
    v_mfma_f32_16x16x32_bf16 v[52:55], a[228:231], v[236:239], v[52:55]
    ds_read_b64_tr_b16 a[224:225], v4 offset:34496
    ds_read_b64_tr_b16 a[226:227], v4 offset:35008
    v_mfma_f32_16x16x32_bf16 v[68:71], a[232:235], v[236:239], v[68:71]
    v_exp_f32 v221, v221
    v_mfma_f32_16x16x32_bf16 v[84:87], a[236:239], v[236:239], v[84:87]
    ds_read_b64_tr_b16 a[228:229], v4 offset:34528
    ds_read_b64_tr_b16 a[230:231], v4 offset:35040
    v_mfma_f32_16x16x32_bf16 v[100:103], a[240:243], v[236:239], v[100:103]
    v_exp_f32 v222, v222
    v_mfma_f32_16x16x32_bf16 v[116:119], a[244:247], v[236:239], v[116:119]
    ds_read_b64_tr_b16 a[232:233], v4 offset:34560
    ds_read_b64_tr_b16 a[234:235], v4 offset:35072
    v_mfma_f32_16x16x32_bf16 v[132:135], a[248:251], v[236:239], v[132:135]
    v_exp_f32 v223, v223
    v_mfma_f32_16x16x32_bf16 v[148:151], a[252:255], v[236:239], v[148:151]
    v_cvt_pk_bf16_f32 v232, v216, v217
    v_cvt_pk_bf16_f32 v233, v218, v219
    v_mfma_f32_16x16x32_bf16 a[172:175], a[176:179], v[236:239], a[172:175]
    s_waitcnt lgkmcnt(12)
    v_cvt_pk_bf16_f32 v234, v220, v221
    v_cvt_pk_bf16_f32 v235, v222, v223
    v_mfma_f32_16x16x32_bf16 v[216:219], a[192:195], v[152:155], v[240:243]
    ds_read_b64_tr_b16 a[236:237], v4 offset:34592
    ds_read_b64_tr_b16 a[238:239], v4 offset:35104
    v_mfma_f32_16x16x32_bf16 v[216:219], a[196:199], v[156:159], v[216:219]
    s_waitcnt lgkmcnt(12)
    buffer_load_dword v23, v13, s[24:27], s68 offen sc1
    v_exp_f32 v224, v224
    v_mfma_f32_16x16x32_bf16 v[216:219], a[200:203], v[160:163], v[216:219]
    s_mov_b32 s68, 12288
    ds_read_b64_tr_b16 a[240:241], v4 offset:34624
    ds_read_b64_tr_b16 a[242:243], v4 offset:35136
    v_mfma_f32_16x16x32_bf16 v[216:219], a[204:207], v[164:167], v[216:219]
    s_waitcnt lgkmcnt(12)
    v_exp_f32 v225, v225
    v_mfma_f32_16x16x32_bf16 v[220:223], a[208:211], v[152:155], v[240:243]
    ds_read_b64_tr_b16 a[244:245], v4 offset:34656
    ds_read_b64_tr_b16 a[246:247], v4 offset:35168
    v_mfma_f32_16x16x32_bf16 v[220:223], a[212:215], v[156:159], v[220:223]
    s_waitcnt lgkmcnt(12)
    v_exp_f32 v226, v226
    v_mfma_f32_16x16x32_bf16 v[220:223], a[216:219], v[160:163], v[220:223]
    ds_read_b64_tr_b16 a[248:249], v4 offset:34688
    ds_read_b64_tr_b16 a[250:251], v4 offset:35200
    v_mfma_f32_16x16x32_bf16 v[220:223], a[220:223], v[164:167], v[220:223]
    s_waitcnt lgkmcnt(10)
    v_exp_f32 v227, v227
    v_mfma_f32_16x16x32_bf16 v[24:27], a[224:227], v[232:235], v[24:27]
    ds_read_b64_tr_b16 a[252:253], v4 offset:34720
    ds_read_b64_tr_b16 a[254:255], v4 offset:35232
    v_mfma_f32_16x16x32_bf16 v[40:43], a[228:231], v[232:235], v[40:43]
    s_waitcnt lgkmcnt(8)
    v_cvt_pk_bf16_f32 v236, v224, v225
    v_cvt_pk_bf16_f32 v237, v226, v227
    v_mfma_f32_16x16x32_bf16 v[56:59], a[232:235], v[232:235], v[56:59]
    v_exp_f32 v228, v228
    v_mfma_f32_16x16x32_bf16 v[72:75], a[236:239], v[232:235], v[72:75]
    s_waitcnt lgkmcnt(4)
    v_exp_f32 v229, v229
    v_mfma_f32_16x16x32_bf16 v[88:91], a[240:243], v[232:235], v[88:91]
    v_mfma_f32_16x16x32_bf16 v[104:107], a[244:247], v[232:235], v[104:107]
    s_waitcnt lgkmcnt(0)
    v_mfma_f32_16x16x32_bf16 v[120:123], a[248:251], v[232:235], v[120:123]
    v_exp_f32 v230, v230
    v_mfma_f32_16x16x32_bf16 v[136:139], a[252:255], v[232:235], v[136:139]
    v_exp_f32 v231, v231
    v_mfma_f32_16x16x32_bf16 a[160:163], a[176:179], v[232:235], a[160:163]
    v_cvt_pk_bf16_f32 v238, v228, v229
    v_cvt_pk_bf16_f32 v239, v230, v231
    v_mfma_f32_16x16x32_bf16 v[224:227], a[192:195], v[168:171], v[244:247]
    s_waitcnt vmcnt(9)
    s_barrier
    v_exp_f32 v216, v216
    v_mfma_f32_16x16x32_bf16 v[224:227], a[196:199], v[172:175], v[224:227]
    s_lshl_b32 s53, s42, 5
    v_exp_f32 v217, v217
    v_mfma_f32_16x16x32_bf16 v[224:227], a[200:203], v[176:179], v[224:227]
    s_add_u32 s53, s53, s40
    ds_read_b128 a[192:195], v3 offset:0
    ds_read_b128 a[196:199], v3 offset:64
    v_mfma_f32_16x16x32_bf16 v[224:227], a[204:207], v[180:183], v[224:227]
    s_lshl_b32 s53, s53, 14
    v_exp_f32 v218, v218
    v_mfma_f32_16x16x32_bf16 v[228:231], a[208:211], v[168:171], v[244:247]
    s_add_u32 s53, s53, 0x1200000
    ds_read_b128 a[200:203], v3 offset:128
    ds_read_b128 a[204:207], v3 offset:192
    v_mfma_f32_16x16x32_bf16 v[228:231], a[212:215], v[172:175], v[228:231]
    s_add_u32 s54, s53, 4096
    v_exp_f32 v219, v219
    v_mfma_f32_16x16x32_bf16 v[228:231], a[216:219], v[176:179], v[228:231]
    s_add_u32 s55, s53, 8192
    ds_read_b128 a[208:211], v3 offset:4352
    ds_read_b128 a[212:215], v3 offset:4416
    v_mfma_f32_16x16x32_bf16 v[228:231], a[220:223], v[180:183], v[228:231]
    s_add_u32 s56, s53, 12288
    v_exp_f32 v220, v220
    v_mfma_f32_16x16x32_bf16 v[28:31], a[224:227], v[236:239], v[28:31]
    ds_read_b128 a[216:219], v3 offset:4480
    ds_read_b128 a[220:223], v3 offset:4544
    v_mfma_f32_16x16x32_bf16 v[44:47], a[228:231], v[236:239], v[44:47]
    ds_read_b64_tr_b16 a[224:225], v4 offset:42912
    ds_read_b64_tr_b16 a[226:227], v4 offset:43424
    v_mfma_f32_16x16x32_bf16 v[60:63], a[232:235], v[236:239], v[60:63]
    v_exp_f32 v221, v221
    v_mfma_f32_16x16x32_bf16 v[76:79], a[236:239], v[236:239], v[76:79]
    ds_read_b64_tr_b16 a[228:229], v4 offset:42944
    ds_read_b64_tr_b16 a[230:231], v4 offset:43456
    v_mfma_f32_16x16x32_bf16 v[92:95], a[240:243], v[236:239], v[92:95]
    v_exp_f32 v222, v222
    v_mfma_f32_16x16x32_bf16 v[108:111], a[244:247], v[236:239], v[108:111]
    ds_read_b64_tr_b16 a[232:233], v4 offset:42976
    ds_read_b64_tr_b16 a[234:235], v4 offset:43488
    v_mfma_f32_16x16x32_bf16 v[124:127], a[248:251], v[236:239], v[124:127]
    v_exp_f32 v223, v223
    v_mfma_f32_16x16x32_bf16 v[140:143], a[252:255], v[236:239], v[140:143]
    v_cvt_pk_bf16_f32 v232, v216, v217
    v_cvt_pk_bf16_f32 v233, v218, v219
    v_mfma_f32_16x16x32_bf16 a[164:167], a[176:179], v[236:239], a[164:167]
    s_waitcnt lgkmcnt(12)
    v_cvt_pk_bf16_f32 v234, v220, v221
    v_cvt_pk_bf16_f32 v235, v222, v223
    v_mfma_f32_16x16x32_bf16 v[216:219], a[192:195], v[152:155], v[240:243]
    ds_read_b64_tr_b16 a[236:237], v4 offset:43008
    ds_read_b64_tr_b16 a[238:239], v4 offset:43520
    v_mfma_f32_16x16x32_bf16 v[216:219], a[196:199], v[156:159], v[216:219]
    s_waitcnt lgkmcnt(12)
    v_exp_f32 v224, v224
    v_mfma_f32_16x16x32_bf16 v[216:219], a[200:203], v[160:163], v[216:219]
    ds_read_b64_tr_b16 a[240:241], v4 offset:43040
    ds_read_b64_tr_b16 a[242:243], v4 offset:43552
    v_mfma_f32_16x16x32_bf16 v[216:219], a[204:207], v[164:167], v[216:219]
    s_waitcnt lgkmcnt(12)
    v_exp_f32 v225, v225
    v_mfma_f32_16x16x32_bf16 v[220:223], a[208:211], v[152:155], v[240:243]
    ds_read_b64_tr_b16 a[244:245], v4 offset:43072
    ds_read_b64_tr_b16 a[246:247], v4 offset:43584
    v_mfma_f32_16x16x32_bf16 v[220:223], a[212:215], v[156:159], v[220:223]
    s_waitcnt lgkmcnt(12)
    v_exp_f32 v226, v226
    v_mfma_f32_16x16x32_bf16 v[220:223], a[216:219], v[160:163], v[220:223]
    ds_read_b64_tr_b16 a[248:249], v4 offset:43104
    ds_read_b64_tr_b16 a[250:251], v4 offset:43616
    v_mfma_f32_16x16x32_bf16 v[220:223], a[220:223], v[164:167], v[220:223]
    s_waitcnt lgkmcnt(10)
    v_exp_f32 v227, v227
    v_mfma_f32_16x16x32_bf16 v[24:27], a[224:227], v[232:235], v[24:27]
    ds_read_b64_tr_b16 a[252:253], v4 offset:43136
    ds_read_b64_tr_b16 a[254:255], v4 offset:43648
    v_mfma_f32_16x16x32_bf16 v[40:43], a[228:231], v[232:235], v[40:43]
    s_waitcnt lgkmcnt(8)
    v_cvt_pk_bf16_f32 v236, v224, v225
    v_cvt_pk_bf16_f32 v237, v226, v227
    v_mfma_f32_16x16x32_bf16 v[56:59], a[232:235], v[232:235], v[56:59]
    v_exp_f32 v228, v228
    v_mfma_f32_16x16x32_bf16 v[72:75], a[236:239], v[232:235], v[72:75]
    s_waitcnt lgkmcnt(4)
    v_exp_f32 v229, v229
    v_mfma_f32_16x16x32_bf16 v[88:91], a[240:243], v[232:235], v[88:91]
    v_mfma_f32_16x16x32_bf16 v[104:107], a[244:247], v[232:235], v[104:107]
    s_waitcnt lgkmcnt(0)
    v_mfma_f32_16x16x32_bf16 v[120:123], a[248:251], v[232:235], v[120:123]
    v_exp_f32 v230, v230
    v_mfma_f32_16x16x32_bf16 v[136:139], a[252:255], v[232:235], v[136:139]
    v_exp_f32 v231, v231
    v_mfma_f32_16x16x32_bf16 a[160:163], a[176:179], v[232:235], a[160:163]
    v_cvt_pk_bf16_f32 v238, v228, v229
    v_cvt_pk_bf16_f32 v239, v230, v231
    v_mfma_f32_16x16x32_bf16 v[224:227], a[192:195], v[168:171], v[244:247]
    s_waitcnt vmcnt(6)
    s_barrier
    v_mfma_f32_16x16x32_bf16 v[224:227], a[196:199], v[172:175], v[224:227]
    v_exp_f32 v216, v216
    v_mfma_f32_16x16x32_bf16 v[224:227], a[200:203], v[176:179], v[224:227]
    v_exp_f32 v217, v217
    v_mfma_f32_16x16x32_bf16 v[224:227], a[204:207], v[180:183], v[224:227]
    v_exp_f32 v218, v218
    v_mfma_f32_16x16x32_bf16 v[228:231], a[208:211], v[168:171], v[244:247]
    v_exp_f32 v219, v219
    v_mfma_f32_16x16x32_bf16 v[228:231], a[212:215], v[172:175], v[228:231]
    v_cvt_pk_bf16_f32 v232, v216, v217
    v_cvt_pk_bf16_f32 v233, v218, v219
    v_mfma_f32_16x16x32_bf16 v[228:231], a[216:219], v[176:179], v[228:231]
    v_mfma_f32_16x16x32_bf16 v[228:231], a[220:223], v[180:183], v[228:231]
    v_mfma_f32_16x16x32_bf16 v[28:31], a[224:227], v[236:239], v[28:31]
    v_exp_f32 v220, v220
    v_mfma_f32_16x16x32_bf16 v[44:47], a[228:231], v[236:239], v[44:47]
    ds_read_b64_tr_b16 a[224:225], v7 offset:0
    ds_read_b64_tr_b16 a[226:227], v7 offset:512
    v_mfma_f32_16x16x32_bf16 v[60:63], a[232:235], v[236:239], v[60:63]
    v_exp_f32 v221, v221
    v_mfma_f32_16x16x32_bf16 v[76:79], a[236:239], v[236:239], v[76:79]
    ds_read_b64_tr_b16 a[228:229], v7 offset:32
    ds_read_b64_tr_b16 a[230:231], v7 offset:544
    v_mfma_f32_16x16x32_bf16 v[92:95], a[240:243], v[236:239], v[92:95]
    v_exp_f32 v222, v222
    v_mfma_f32_16x16x32_bf16 v[108:111], a[244:247], v[236:239], v[108:111]
    ds_read_b64_tr_b16 a[232:233], v7 offset:64
    ds_read_b64_tr_b16 a[234:235], v7 offset:576
    v_mfma_f32_16x16x32_bf16 v[124:127], a[248:251], v[236:239], v[124:127]
    v_exp_f32 v223, v223
    v_mfma_f32_16x16x32_bf16 v[140:143], a[252:255], v[236:239], v[140:143]
    ds_read_b64_tr_b16 a[236:237], v7 offset:96
    ds_read_b64_tr_b16 a[238:239], v7 offset:608
    v_mfma_f32_16x16x32_bf16 a[164:167], a[176:179], v[236:239], a[164:167]
    v_cvt_pk_bf16_f32 v234, v220, v221
    v_cvt_pk_bf16_f32 v235, v222, v223
    v_mfma_f32_16x16x32_bf16 v[216:219], a[192:195], v[184:187], v[248:251]
    ds_read_b64_tr_b16 a[240:241], v7 offset:128
    ds_read_b64_tr_b16 a[242:243], v7 offset:640
    v_mfma_f32_16x16x32_bf16 v[216:219], a[196:199], v[188:191], v[216:219]
    buffer_load_dwordx4 v[240:243], v10, s[8:11], 0 offen offset:0
    v_mfma_f32_16x16x32_bf16 v[216:219], a[200:203], v[192:195], v[216:219]
    v_exp_f32 v224, v224
    v_mfma_f32_16x16x32_bf16 v[216:219], a[204:207], v[196:199], v[216:219]
    ds_read_b64_tr_b16 a[244:245], v7 offset:160
    ds_read_b64_tr_b16 a[246:247], v7 offset:672
    v_mfma_f32_16x16x32_bf16 v[220:223], a[208:211], v[184:187], v[248:251]
    v_exp_f32 v225, v225
    v_mfma_f32_16x16x32_bf16 v[220:223], a[212:215], v[188:191], v[220:223]
    ds_read_b64_tr_b16 a[248:249], v7 offset:192
    ds_read_b64_tr_b16 a[250:251], v7 offset:704
    v_mfma_f32_16x16x32_bf16 v[220:223], a[216:219], v[192:195], v[220:223]
    v_exp_f32 v226, v226
    v_mfma_f32_16x16x32_bf16 v[220:223], a[220:223], v[196:199], v[220:223]
    s_waitcnt lgkmcnt(10)
    ds_read_b64_tr_b16 a[252:253], v7 offset:224
    ds_read_b64_tr_b16 a[254:255], v7 offset:736
    v_mfma_f32_16x16x32_bf16 v[24:27], a[224:227], v[232:235], v[24:27]
    buffer_load_dwordx4 v[244:247], v10, s[8:11], 0 offen offset:64
    v_mfma_f32_16x16x32_bf16 v[40:43], a[228:231], v[232:235], v[40:43]
    s_waitcnt lgkmcnt(8)
    v_exp_f32 v227, v227
    v_mfma_f32_16x16x32_bf16 v[56:59], a[232:235], v[232:235], v[56:59]
    v_exp_f32 v228, v228
    v_mfma_f32_16x16x32_bf16 v[72:75], a[236:239], v[232:235], v[72:75]
    s_waitcnt lgkmcnt(4)
    v_cvt_pk_bf16_f32 v236, v224, v225
    v_cvt_pk_bf16_f32 v237, v226, v227
    v_mfma_f32_16x16x32_bf16 v[88:91], a[240:243], v[232:235], v[88:91]
    v_exp_f32 v229, v229
    v_mfma_f32_16x16x32_bf16 v[104:107], a[244:247], v[232:235], v[104:107]
    s_waitcnt lgkmcnt(0)
    v_exp_f32 v230, v230
    v_mfma_f32_16x16x32_bf16 v[120:123], a[248:251], v[232:235], v[120:123]
    v_exp_f32 v231, v231
    v_mfma_f32_16x16x32_bf16 v[136:139], a[252:255], v[232:235], v[136:139]
    v_cvt_pk_bf16_f32 v238, v228, v229
    v_cvt_pk_bf16_f32 v239, v230, v231
    v_mfma_f32_16x16x32_bf16 a[160:163], a[176:179], v[232:235], a[160:163]
    v_mfma_f32_16x16x32_bf16 v[224:227], a[192:195], v[200:203], v[252:255]
    v_mfma_f32_16x16x32_bf16 v[224:227], a[196:199], v[204:207], v[224:227]
    v_exp_f32 v216, v216
    v_mfma_f32_16x16x32_bf16 v[224:227], a[200:203], v[208:211], v[224:227]
    v_exp_f32 v217, v217
    v_mfma_f32_16x16x32_bf16 v[224:227], a[204:207], v[212:215], v[224:227]
    ds_read_b128 a[192:195], v3 offset:8704
    ds_read_b128 a[196:199], v3 offset:8768
    v_mfma_f32_16x16x32_bf16 v[228:231], a[208:211], v[200:203], v[252:255]
    v_exp_f32 v218, v218
    v_accvgpr_read_b32 v16, a160
    v_lshl_add_u32 v22, s3, 10, v2
    v_mov_b32 v20, v16
    v_rcp_f32 v16, v16
    v_mfma_f32_16x16x32_bf16 v[228:231], a[212:215], v[204:207], v[228:231]
    v_exp_f32 v219, v219
    v_nop
    v_mul_f32 v24, v24, v16
    v_mul_f32 v25, v25, v16
    v_mul_f32 v26, v26, v16
    v_mfma_f32_16x16x32_bf16 v[228:231], a[216:219], v[208:211], v[228:231]
    ds_read_b128 a[200:203], v3 offset:8832
    ds_read_b128 a[204:207], v3 offset:8896
    v_mul_f32 v27, v27, v16
    v_mul_f32 v40, v40, v16
    v_mul_f32 v41, v41, v16
    v_mul_f32 v42, v42, v16
    v_mfma_f32_16x16x32_bf16 v[228:231], a[220:223], v[212:215], v[228:231]
    v_mul_f32 v43, v43, v16
    v_cvt_pk_bf16_f32 v24, v24, v25
    v_cvt_pk_bf16_f32 v25, v26, v27
    v_cvt_pk_bf16_f32 v26, v40, v41
    v_cvt_pk_bf16_f32 v27, v42, v43
    v_mfma_f32_16x16x32_bf16 v[28:31], a[224:227], v[236:239], v[28:31]
    buffer_store_dwordx4 v[24:27], v22, s[24:27], s53 offen sc1
    v_cvt_pk_bf16_f32 v232, v216, v217
    v_cvt_pk_bf16_f32 v233, v218, v219
    v_mfma_f32_16x16x32_bf16 v[44:47], a[228:231], v[236:239], v[44:47]
    v_exp_f32 v220, v220
    v_mul_f32 v56, v56, v16
    v_mul_f32 v57, v57, v16
    v_mul_f32 v58, v58, v16
    v_mul_f32 v59, v59, v16
    v_mfma_f32_16x16x32_bf16 v[60:63], a[232:235], v[236:239], v[60:63]
    ds_read_b128 a[208:211], v3 offset:13056
    ds_read_b128 a[212:215], v3 offset:13120
    v_mul_f32 v72, v72, v16
    v_mul_f32 v73, v73, v16
    v_mul_f32 v74, v74, v16
    v_mul_f32 v75, v75, v16
    v_mfma_f32_16x16x32_bf16 v[76:79], a[236:239], v[236:239], v[76:79]
    v_exp_f32 v221, v221
    v_cvt_pk_bf16_f32 v56, v56, v57
    v_cvt_pk_bf16_f32 v57, v58, v59
    v_cvt_pk_bf16_f32 v58, v72, v73
    v_cvt_pk_bf16_f32 v59, v74, v75
    v_mfma_f32_16x16x32_bf16 v[92:95], a[240:243], v[236:239], v[92:95]
    buffer_store_dwordx4 v[56:59], v22, s[24:27], s54 offen sc1
    v_exp_f32 v222, v222
    v_mfma_f32_16x16x32_bf16 v[108:111], a[244:247], v[236:239], v[108:111]
    v_exp_f32 v223, v223
    v_mul_f32 v88, v88, v16
    v_mul_f32 v89, v89, v16
    v_mul_f32 v90, v90, v16
    v_mul_f32 v91, v91, v16
    v_mfma_f32_16x16x32_bf16 v[124:127], a[248:251], v[236:239], v[124:127]
    ds_read_b128 a[216:219], v3 offset:13184
    ds_read_b128 a[220:223], v3 offset:13248
    v_mul_f32 v104, v104, v16
    v_mul_f32 v105, v105, v16
    v_mul_f32 v106, v106, v16
    v_mul_f32 v107, v107, v16
    v_mfma_f32_16x16x32_bf16 v[140:143], a[252:255], v[236:239], v[140:143]
    v_cvt_pk_bf16_f32 v88, v88, v89
    v_cvt_pk_bf16_f32 v89, v90, v91
    v_cvt_pk_bf16_f32 v90, v104, v105
    v_cvt_pk_bf16_f32 v91, v106, v107
    v_mfma_f32_16x16x32_bf16 a[164:167], a[176:179], v[236:239], a[164:167]
    s_waitcnt lgkmcnt(6)
    buffer_store_dwordx4 v[88:91], v22, s[24:27], s55 offen sc1
    v_cvt_pk_bf16_f32 v234, v220, v221
    v_cvt_pk_bf16_f32 v235, v222, v223
    v_mfma_f32_16x16x32_bf16 v[216:219], a[192:195], v[184:187], v[248:251]
    v_exp_f32 v224, v224
    v_mul_f32 v120, v120, v16
    v_mul_f32 v121, v121, v16
    v_mul_f32 v122, v122, v16
    v_mul_f32 v123, v123, v16
    v_mfma_f32_16x16x32_bf16 v[216:219], a[196:199], v[188:191], v[216:219]
    s_waitcnt lgkmcnt(4)
    v_exp_f32 v225, v225
    v_mul_f32 v136, v136, v16
    v_mul_f32 v137, v137, v16
    v_mul_f32 v138, v138, v16
    v_mul_f32 v139, v139, v16
    v_mfma_f32_16x16x32_bf16 v[216:219], a[200:203], v[192:195], v[216:219]
    v_exp_f32 v226, v226
    v_cvt_pk_bf16_f32 v120, v120, v121
    v_cvt_pk_bf16_f32 v121, v122, v123
    v_cvt_pk_bf16_f32 v122, v136, v137
    v_cvt_pk_bf16_f32 v123, v138, v139
    v_mfma_f32_16x16x32_bf16 v[216:219], a[204:207], v[196:199], v[216:219]
    s_waitcnt lgkmcnt(2)
    buffer_store_dwordx4 v[120:123], v22, s[24:27], s56 offen sc1
    v_exp_f32 v227, v227
    v_mfma_f32_16x16x32_bf16 v[220:223], a[208:211], v[184:187], v[248:251]
    v_cvt_pk_bf16_f32 v236, v224, v225
    v_cvt_pk_bf16_f32 v237, v226, v227
    v_accvgpr_read_b32 v17, a164
    v_xor_b32 v22, 1024, v22
    v_add_f32 v20, v20, v17
    v_rcp_f32 v17, v17
    v_mfma_f32_16x16x32_bf16 v[220:223], a[212:215], v[188:191], v[220:223]
    s_waitcnt lgkmcnt(0)
    v_nop
    v_mul_f32 v28, v28, v17
    v_mul_f32 v29, v29, v17
    v_mul_f32 v30, v30, v17
    v_mul_f32 v31, v31, v17
    v_mul_f32 v44, v44, v17
    v_mfma_f32_16x16x32_bf16 v[220:223], a[216:219], v[192:195], v[220:223]
    v_mul_f32 v45, v45, v17
    v_mul_f32 v46, v46, v17
    v_mul_f32 v47, v47, v17
    v_cvt_pk_bf16_f32 v28, v28, v29
    v_cvt_pk_bf16_f32 v29, v30, v31
    v_cvt_pk_bf16_f32 v30, v44, v45
    v_mfma_f32_16x16x32_bf16 v[220:223], a[220:223], v[196:199], v[220:223]
    v_exp_f32 v228, v228
    v_cvt_pk_bf16_f32 v31, v46, v47
    v_mfma_f32_16x16x32_bf16 v[32:35], a[224:227], v[232:235], v[32:35]
    buffer_store_dwordx4 v[28:31], v22, s[24:27], s53 offen sc1
    v_exp_f32 v229, v229
    v_mfma_f32_16x16x32_bf16 v[48:51], a[228:231], v[232:235], v[48:51]
    v_exp_f32 v230, v230
    v_mul_f32 v60, v60, v17
    v_mul_f32 v61, v61, v17
    v_mul_f32 v62, v62, v17
    v_mul_f32 v63, v63, v17
    v_mfma_f32_16x16x32_bf16 v[64:67], a[232:235], v[232:235], v[64:67]
    v_exp_f32 v231, v231
    v_mul_f32 v76, v76, v17
    v_mul_f32 v77, v77, v17
    v_mul_f32 v78, v78, v17
    v_mul_f32 v79, v79, v17
    v_mfma_f32_16x16x32_bf16 v[80:83], a[236:239], v[232:235], v[80:83]
    v_cvt_pk_bf16_f32 v238, v228, v229
    v_cvt_pk_bf16_f32 v239, v230, v231
    v_cvt_pk_bf16_f32 v60, v60, v61
    v_cvt_pk_bf16_f32 v61, v62, v63
    v_cvt_pk_bf16_f32 v62, v76, v77
    v_cvt_pk_bf16_f32 v63, v78, v79
    v_mfma_f32_16x16x32_bf16 v[96:99], a[240:243], v[232:235], v[96:99]
    buffer_store_dwordx4 v[60:63], v22, s[24:27], s54 offen sc1
    v_mul_f32 v92, v92, v17
    v_mul_f32 v93, v93, v17
    v_mfma_f32_16x16x32_bf16 v[112:115], a[244:247], v[232:235], v[112:115]
    v_mul_f32 v94, v94, v17
    v_mul_f32 v95, v95, v17
    v_mul_f32 v108, v108, v17
    v_mul_f32 v109, v109, v17
    v_mul_f32 v110, v110, v17
    v_mul_f32 v111, v111, v17
    v_mfma_f32_16x16x32_bf16 v[128:131], a[248:251], v[232:235], v[128:131]
    v_cvt_pk_bf16_f32 v92, v92, v93
    v_cvt_pk_bf16_f32 v93, v94, v95
    v_cvt_pk_bf16_f32 v94, v108, v109
    v_cvt_pk_bf16_f32 v95, v110, v111
    v_mfma_f32_16x16x32_bf16 v[144:147], a[252:255], v[232:235], v[144:147]
    buffer_store_dwordx4 v[92:95], v22, s[24:27], s55 offen sc1
    v_mul_f32 v124, v124, v17
    v_mul_f32 v125, v125, v17
    v_mfma_f32_16x16x32_bf16 a[168:171], a[176:179], v[232:235], a[168:171]
    v_mul_f32 v126, v126, v17
    v_mul_f32 v127, v127, v17
    v_mul_f32 v140, v140, v17
    v_mul_f32 v141, v141, v17
    v_mul_f32 v142, v142, v17
    v_mul_f32 v143, v143, v17
    v_mfma_f32_16x16x32_bf16 v[224:227], a[192:195], v[200:203], v[252:255]
    v_exp_f32 v216, v216
    v_cvt_pk_bf16_f32 v124, v124, v125
    v_cvt_pk_bf16_f32 v125, v126, v127
    v_cvt_pk_bf16_f32 v126, v140, v141
    v_cvt_pk_bf16_f32 v127, v142, v143
    v_mfma_f32_16x16x32_bf16 v[224:227], a[196:199], v[204:207], v[224:227]
    buffer_store_dwordx4 v[124:127], v22, s[24:27], s56 offen sc1
    v_exp_f32 v217, v217
    v_mfma_f32_16x16x32_bf16 v[224:227], a[200:203], v[208:211], v[224:227]
    ds_read_b128 a[192:195], v3 offset:25856
    ds_read_b128 a[196:199], v3 offset:25920
    v_mfma_f32_16x16x32_bf16 v[224:227], a[204:207], v[212:215], v[224:227]
    v_exp_f32 v218, v218
    v_mfma_f32_16x16x32_bf16 v[228:231], a[208:211], v[200:203], v[252:255]
    ds_read_b128 a[200:203], v3 offset:25984
    ds_read_b128 a[204:207], v3 offset:26048
    v_mfma_f32_16x16x32_bf16 v[228:231], a[212:215], v[204:207], v[228:231]
    v_exp_f32 v219, v219
    v_mfma_f32_16x16x32_bf16 v[228:231], a[216:219], v[208:211], v[228:231]
    ds_read_b128 a[208:211], v3 offset:30208
    ds_read_b128 a[212:215], v3 offset:30272
    v_mfma_f32_16x16x32_bf16 v[228:231], a[220:223], v[212:215], v[228:231]
    v_exp_f32 v220, v220
    v_mfma_f32_16x16x32_bf16 v[36:39], a[224:227], v[236:239], v[36:39]
    ds_read_b128 a[216:219], v3 offset:30336
    ds_read_b128 a[220:223], v3 offset:30400
    v_mfma_f32_16x16x32_bf16 v[52:55], a[228:231], v[236:239], v[52:55]
    ds_read_b64_tr_b16 a[224:225], v4 offset:34496
    ds_read_b64_tr_b16 a[226:227], v4 offset:35008
    v_mfma_f32_16x16x32_bf16 v[68:71], a[232:235], v[236:239], v[68:71]
    v_exp_f32 v221, v221
    v_mfma_f32_16x16x32_bf16 v[84:87], a[236:239], v[236:239], v[84:87]
    ds_read_b64_tr_b16 a[228:229], v4 offset:34528
    ds_read_b64_tr_b16 a[230:231], v4 offset:35040
    v_mfma_f32_16x16x32_bf16 v[100:103], a[240:243], v[236:239], v[100:103]
    v_exp_f32 v222, v222
    v_mfma_f32_16x16x32_bf16 v[116:119], a[244:247], v[236:239], v[116:119]
    ds_read_b64_tr_b16 a[232:233], v4 offset:34560
    ds_read_b64_tr_b16 a[234:235], v4 offset:35072
    v_mfma_f32_16x16x32_bf16 v[132:135], a[248:251], v[236:239], v[132:135]
    v_exp_f32 v223, v223
    v_mfma_f32_16x16x32_bf16 v[148:151], a[252:255], v[236:239], v[148:151]
    v_cvt_pk_bf16_f32 v232, v216, v217
    v_cvt_pk_bf16_f32 v233, v218, v219
    v_mfma_f32_16x16x32_bf16 a[172:175], a[176:179], v[236:239], a[172:175]
    s_waitcnt lgkmcnt(12)
    v_cvt_pk_bf16_f32 v234, v220, v221
    v_cvt_pk_bf16_f32 v235, v222, v223
    v_mfma_f32_16x16x32_bf16 v[216:219], a[192:195], v[184:187], v[248:251]
    ds_read_b64_tr_b16 a[236:237], v4 offset:34592
    ds_read_b64_tr_b16 a[238:239], v4 offset:35104
    v_mfma_f32_16x16x32_bf16 v[216:219], a[196:199], v[188:191], v[216:219]
    s_waitcnt lgkmcnt(12)
    v_exp_f32 v224, v224
    v_mfma_f32_16x16x32_bf16 v[216:219], a[200:203], v[192:195], v[216:219]
    ds_read_b64_tr_b16 a[240:241], v4 offset:34624
    ds_read_b64_tr_b16 a[242:243], v4 offset:35136
    v_mfma_f32_16x16x32_bf16 v[216:219], a[204:207], v[196:199], v[216:219]
    s_waitcnt lgkmcnt(12)
    v_exp_f32 v225, v225
    v_mfma_f32_16x16x32_bf16 v[220:223], a[208:211], v[184:187], v[248:251]
    ds_read_b64_tr_b16 a[244:245], v4 offset:34656
    ds_read_b64_tr_b16 a[246:247], v4 offset:35168
    v_mfma_f32_16x16x32_bf16 v[220:223], a[212:215], v[188:191], v[220:223]
    s_waitcnt lgkmcnt(12)
    v_exp_f32 v226, v226
    v_mfma_f32_16x16x32_bf16 v[220:223], a[216:219], v[192:195], v[220:223]
    ds_read_b64_tr_b16 a[248:249], v4 offset:34688
    ds_read_b64_tr_b16 a[250:251], v4 offset:35200
    v_mfma_f32_16x16x32_bf16 v[220:223], a[220:223], v[196:199], v[220:223]
    s_waitcnt lgkmcnt(10)
    v_exp_f32 v227, v227
    v_mfma_f32_16x16x32_bf16 v[32:35], a[224:227], v[232:235], v[32:35]
    ds_read_b64_tr_b16 a[252:253], v4 offset:34720
    ds_read_b64_tr_b16 a[254:255], v4 offset:35232
    v_mfma_f32_16x16x32_bf16 v[48:51], a[228:231], v[232:235], v[48:51]
    s_waitcnt lgkmcnt(8)
    v_cvt_pk_bf16_f32 v236, v224, v225
    v_cvt_pk_bf16_f32 v237, v226, v227
    v_mfma_f32_16x16x32_bf16 v[64:67], a[232:235], v[232:235], v[64:67]
    v_exp_f32 v228, v228
    v_mfma_f32_16x16x32_bf16 v[80:83], a[236:239], v[232:235], v[80:83]
    s_waitcnt lgkmcnt(4)
    v_exp_f32 v229, v229
    v_mfma_f32_16x16x32_bf16 v[96:99], a[240:243], v[232:235], v[96:99]
    v_exp_f32 v230, v230
    v_mfma_f32_16x16x32_bf16 v[112:115], a[244:247], v[232:235], v[112:115]
    s_waitcnt lgkmcnt(0)
    v_exp_f32 v231, v231
    v_mfma_f32_16x16x32_bf16 v[128:131], a[248:251], v[232:235], v[128:131]
    v_cvt_pk_bf16_f32 v238, v228, v229
    v_cvt_pk_bf16_f32 v239, v230, v231
    v_mfma_f32_16x16x32_bf16 v[144:147], a[252:255], v[232:235], v[144:147]
    v_mfma_f32_16x16x32_bf16 a[168:171], a[176:179], v[232:235], a[168:171]
    v_mfma_f32_16x16x32_bf16 v[36:39], a[224:227], v[236:239], v[36:39]
    v_exp_f32 v216, v216
    v_mfma_f32_16x16x32_bf16 v[52:55], a[228:231], v[236:239], v[52:55]
    ds_read_b64_tr_b16 a[224:225], v4 offset:42912
    ds_read_b64_tr_b16 a[226:227], v4 offset:43424
    v_mfma_f32_16x16x32_bf16 v[68:71], a[232:235], v[236:239], v[68:71]
    v_exp_f32 v217, v217
    v_mfma_f32_16x16x32_bf16 v[84:87], a[236:239], v[236:239], v[84:87]
    ds_read_b64_tr_b16 a[228:229], v4 offset:42944
    ds_read_b64_tr_b16 a[230:231], v4 offset:43456
    v_mfma_f32_16x16x32_bf16 v[100:103], a[240:243], v[236:239], v[100:103]
    v_exp_f32 v218, v218
    v_mfma_f32_16x16x32_bf16 v[116:119], a[244:247], v[236:239], v[116:119]
    ds_read_b64_tr_b16 a[232:233], v4 offset:42976
    ds_read_b64_tr_b16 a[234:235], v4 offset:43488
    v_mfma_f32_16x16x32_bf16 v[132:135], a[248:251], v[236:239], v[132:135]
    v_exp_f32 v219, v219
    v_mfma_f32_16x16x32_bf16 v[148:151], a[252:255], v[236:239], v[148:151]
    ds_read_b64_tr_b16 a[236:237], v4 offset:43008
    ds_read_b64_tr_b16 a[238:239], v4 offset:43520
    v_mfma_f32_16x16x32_bf16 a[172:175], a[176:179], v[236:239], a[172:175]
    v_cvt_pk_bf16_f32 v232, v216, v217
    v_cvt_pk_bf16_f32 v233, v218, v219
    v_mfma_f32_16x16x32_bf16 v[224:227], a[192:195], v[200:203], v[252:255]
    ds_read_b64_tr_b16 a[240:241], v4 offset:43040
    ds_read_b64_tr_b16 a[242:243], v4 offset:43552
    v_mfma_f32_16x16x32_bf16 v[224:227], a[196:199], v[204:207], v[224:227]
    v_exp_f32 v220, v220
    v_mfma_f32_16x16x32_bf16 v[224:227], a[200:203], v[208:211], v[224:227]
    ds_read_b64_tr_b16 a[244:245], v4 offset:43072
    ds_read_b64_tr_b16 a[246:247], v4 offset:43584
    v_mfma_f32_16x16x32_bf16 v[224:227], a[204:207], v[212:215], v[224:227]
    v_exp_f32 v221, v221
    v_mfma_f32_16x16x32_bf16 v[228:231], a[208:211], v[200:203], v[252:255]
    ds_read_b64_tr_b16 a[248:249], v4 offset:43104
    ds_read_b64_tr_b16 a[250:251], v4 offset:43616
    v_mfma_f32_16x16x32_bf16 v[228:231], a[212:215], v[204:207], v[228:231]
    v_exp_f32 v222, v222
    v_mfma_f32_16x16x32_bf16 v[228:231], a[216:219], v[208:211], v[228:231]
    ds_read_b64_tr_b16 a[252:253], v4 offset:43136
    ds_read_b64_tr_b16 a[254:255], v4 offset:43648
    v_mfma_f32_16x16x32_bf16 v[228:231], a[220:223], v[212:215], v[228:231]
    v_exp_f32 v223, v223
    v_nop
    v_cvt_pk_bf16_f32 v234, v220, v221
    v_cvt_pk_bf16_f32 v235, v222, v223
    s_nop 1
    v_mfma_f32_16x16x32_bf16 a[168:171], a[176:179], v[232:235], a[168:171]
    s_waitcnt lgkmcnt(12)
    v_exp_f32 v224, v224
    v_mfma_f32_16x16x32_bf16 v[32:35], a[224:227], v[232:235], v[32:35]
    v_exp_f32 v225, v225
    v_mfma_f32_16x16x32_bf16 v[48:51], a[228:231], v[232:235], v[48:51]
    s_waitcnt lgkmcnt(8)
    v_exp_f32 v226, v226
    v_cvt_pk_bf16_f32 v236, v224, v225
    v_mfma_f32_16x16x32_bf16 v[64:67], a[232:235], v[232:235], v[64:67]
    v_exp_f32 v227, v227
    v_mfma_f32_16x16x32_bf16 v[80:83], a[236:239], v[232:235], v[80:83]
    s_waitcnt lgkmcnt(4)
    v_exp_f32 v228, v228
    v_cvt_pk_bf16_f32 v237, v226, v227
    v_mfma_f32_16x16x32_bf16 v[96:99], a[240:243], v[232:235], v[96:99]
    v_exp_f32 v229, v229
    v_mfma_f32_16x16x32_bf16 v[112:115], a[244:247], v[232:235], v[112:115]
    s_waitcnt lgkmcnt(0)
    v_exp_f32 v230, v230
    v_cvt_pk_bf16_f32 v238, v228, v229
    v_mfma_f32_16x16x32_bf16 v[128:131], a[248:251], v[232:235], v[128:131]
    v_exp_f32 v231, v231
    v_mfma_f32_16x16x32_bf16 v[144:147], a[252:255], v[232:235], v[144:147]
    v_cvt_pk_bf16_f32 v239, v230, v231
    s_nop 1
    v_mfma_f32_16x16x32_bf16 a[172:175], a[176:179], v[236:239], a[172:175]
    v_accvgpr_read_b32 v18, a168
    v_xor_b32 v22, 3072, v22
    v_mfma_f32_16x16x32_bf16 v[36:39], a[224:227], v[236:239], v[36:39]
    v_add_f32 v20, v20, v18
    v_rcp_f32 v18, v18
    v_mfma_f32_16x16x32_bf16 v[52:55], a[228:231], v[236:239], v[52:55]
    v_nop
    v_mul_f32 v32, v32, v18
    v_mfma_f32_16x16x32_bf16 v[68:71], a[232:235], v[236:239], v[68:71]
    v_mul_f32 v33, v33, v18
    v_mul_f32 v34, v34, v18
    v_mfma_f32_16x16x32_bf16 v[84:87], a[236:239], v[236:239], v[84:87]
    v_mul_f32 v35, v35, v18
    v_mul_f32 v48, v48, v18
    v_mfma_f32_16x16x32_bf16 v[100:103], a[240:243], v[236:239], v[100:103]
    v_mul_f32 v49, v49, v18
    v_mul_f32 v50, v50, v18
    v_mfma_f32_16x16x32_bf16 v[116:119], a[244:247], v[236:239], v[116:119]
    v_mul_f32 v51, v51, v18
    v_cvt_pk_bf16_f32 v32, v32, v33
    v_mfma_f32_16x16x32_bf16 v[132:135], a[248:251], v[236:239], v[132:135]
    v_cvt_pk_bf16_f32 v33, v34, v35
    v_cvt_pk_bf16_f32 v34, v48, v49
    v_mfma_f32_16x16x32_bf16 v[148:151], a[252:255], v[236:239], v[148:151]
    v_cvt_pk_bf16_f32 v35, v50, v51
L_region_A_begin:
    buffer_store_dwordx4 v[32:35], v22, s[24:27], s53 offen sc1
    v_pk_mul_f32 v[64:65], v[64:65], v[18:19] op_sel_hi:[1,0]
    v_pk_mul_f32 v[66:67], v[66:67], v[18:19] op_sel_hi:[1,0]
    v_pk_mul_f32 v[80:81], v[80:81], v[18:19] op_sel_hi:[1,0]
    v_pk_mul_f32 v[82:83], v[82:83], v[18:19] op_sel_hi:[1,0]
    v_cvt_pk_bf16_f32 v64, v64, v65
    v_cvt_pk_bf16_f32 v65, v66, v67
    v_cvt_pk_bf16_f32 v66, v80, v81
    v_cvt_pk_bf16_f32 v67, v82, v83
    buffer_store_dwordx4 v[64:67], v22, s[24:27], s54 offen sc1
    v_pk_mul_f32 v[96:97], v[96:97], v[18:19] op_sel_hi:[1,0]
    v_pk_mul_f32 v[98:99], v[98:99], v[18:19] op_sel_hi:[1,0]
    v_pk_mul_f32 v[112:113], v[112:113], v[18:19] op_sel_hi:[1,0]
    v_pk_mul_f32 v[114:115], v[114:115], v[18:19] op_sel_hi:[1,0]
    v_cvt_pk_bf16_f32 v96, v96, v97
    v_cvt_pk_bf16_f32 v97, v98, v99
    v_cvt_pk_bf16_f32 v98, v112, v113
    v_cvt_pk_bf16_f32 v99, v114, v115
    buffer_store_dwordx4 v[96:99], v22, s[24:27], s55 offen sc1
    v_pk_mul_f32 v[128:129], v[128:129], v[18:19] op_sel_hi:[1,0]
    v_pk_mul_f32 v[130:131], v[130:131], v[18:19] op_sel_hi:[1,0]
    v_pk_mul_f32 v[144:145], v[144:145], v[18:19] op_sel_hi:[1,0]
    v_pk_mul_f32 v[146:147], v[146:147], v[18:19] op_sel_hi:[1,0]
    v_cvt_pk_bf16_f32 v128, v128, v129
    v_cvt_pk_bf16_f32 v129, v130, v131
    v_cvt_pk_bf16_f32 v130, v144, v145
    v_cvt_pk_bf16_f32 v131, v146, v147
    buffer_store_dwordx4 v[128:131], v22, s[24:27], s56 offen sc1
    v_accvgpr_read_b32 v19, a172
    v_xor_b32 v22, 1024, v22
    v_add_f32 v20, v20, v19
    v_rcp_f32 v19, v19
    v_cmp_nge_f32 vcc, 0x4e800000, v20
    v_mov_b32 v216, 1024
    v_lshl_add_u32 v217, s3, 2, v216
    s_cmp_lg_u64 vcc, 0
    s_cselect_b32 s57, 1, 0
    v_mov_b32 v218, s57
    ds_write_b32 v217, v218
    v_pk_mul_f32 v[36:37], v[36:37], v[18:19] op_sel:[0,1]
    v_pk_mul_f32 v[38:39], v[38:39], v[18:19] op_sel:[0,1]
    v_pk_mul_f32 v[52:53], v[52:53], v[18:19] op_sel:[0,1]
    v_pk_mul_f32 v[54:55], v[54:55], v[18:19] op_sel:[0,1]
    v_cvt_pk_bf16_f32 v36, v36, v37
    v_cvt_pk_bf16_f32 v37, v38, v39
    v_cvt_pk_bf16_f32 v38, v52, v53
    v_cvt_pk_bf16_f32 v39, v54, v55
    buffer_store_dwordx4 v[36:39], v22, s[24:27], s53 offen sc1
    s_waitcnt lgkmcnt(0)
    s_barrier
    ds_read_b128 v[220:223], v216
    v_pk_mul_f32 v[68:69], v[68:69], v[18:19] op_sel:[0,1]
    v_pk_mul_f32 v[70:71], v[70:71], v[18:19] op_sel:[0,1]
    v_pk_mul_f32 v[84:85], v[84:85], v[18:19] op_sel:[0,1]
    v_pk_mul_f32 v[86:87], v[86:87], v[18:19] op_sel:[0,1]
    v_cvt_pk_bf16_f32 v68, v68, v69
    v_cvt_pk_bf16_f32 v69, v70, v71
    v_cvt_pk_bf16_f32 v70, v84, v85
    v_cvt_pk_bf16_f32 v71, v86, v87
    buffer_store_dwordx4 v[68:71], v22, s[24:27], s54 offen sc1
    v_pk_mul_f32 v[100:101], v[100:101], v[18:19] op_sel:[0,1]
    v_pk_mul_f32 v[102:103], v[102:103], v[18:19] op_sel:[0,1]
    v_pk_mul_f32 v[116:117], v[116:117], v[18:19] op_sel:[0,1]
    v_pk_mul_f32 v[118:119], v[118:119], v[18:19] op_sel:[0,1]
    v_cvt_pk_bf16_f32 v100, v100, v101
    v_cvt_pk_bf16_f32 v101, v102, v103
    v_cvt_pk_bf16_f32 v102, v116, v117
    v_cvt_pk_bf16_f32 v103, v118, v119
    buffer_store_dwordx4 v[100:103], v22, s[24:27], s55 offen sc1
    v_pk_mul_f32 v[132:133], v[132:133], v[18:19] op_sel:[0,1]
    v_pk_mul_f32 v[134:135], v[134:135], v[18:19] op_sel:[0,1]
    v_pk_mul_f32 v[148:149], v[148:149], v[18:19] op_sel:[0,1]
    v_pk_mul_f32 v[150:151], v[150:151], v[18:19] op_sel:[0,1]
    v_cvt_pk_bf16_f32 v132, v132, v133
    v_cvt_pk_bf16_f32 v133, v134, v135
    v_cvt_pk_bf16_f32 v134, v148, v149
    v_cvt_pk_bf16_f32 v135, v150, v151
    buffer_store_dwordx4 v[132:135], v22, s[24:27], s56 offen sc1
    s_waitcnt lgkmcnt(0)
    v_or_b32 v220, v220, v221
    v_or3_b32 v220, v220, v222, v223
    s_nop 0
    v_readfirstlane_b32 s57, v220
    s_andn2_b32 s57, s57, s48
    s_cbranch_scc1 L_att_retry
    s_sub_u32 s79, s61, s62
    s_lshl_b32 s79, s79, 19
    s_add_u32 s79, s79, 0x700000
    s_and_b32 s80, s61, 3
    s_lshl_b32 s80, s80, 10
    s_xor_b32 s54, s61, 1
    s_sub_u32 s54, s54, s62
    s_lshl_b32 s54, s54, 19
    s_add_u32 s54, s54, 0x700000
    s_xor_b32 s55, s80, 1024
    s_lshl2_add_u32 s82, s2, s3
    s_lshl_b32 s82, s82, 12
    s_add_u32 s82, s82, 0x2200000
    s_xor_b32 s81, s82, 1048576
    s_add_u32 s53, s3, 1
    s_and_b32 s53, s53, 3
    s_lshl_b32 s53, s53, 10
    v_add_u32 v12, s53, v2
    v_xor_b32 v3, s55, v12
    v_add_u32 v3, s54, v3
    s_add_u32 s53, s3, 2
    s_and_b32 s53, s53, 3
    s_lshl_b32 s53, s53, 10
    v_add_u32 v13, s53, v2
    v_xor_b32 v4, s55, v13
    v_add_u32 v4, s54, v4
    s_add_u32 s53, s3, 3
    s_and_b32 s53, s53, 3
    s_lshl_b32 s53, s53, 10
    v_add_u32 v14, s53, v2
    v_xor_b32 v5, s55, v14
    v_add_u32 v5, s54, v5
    s_add_u32 s53, s3, 4
    s_and_b32 s53, s53, 3
    s_lshl_b32 s53, s53, 10
    v_add_u32 v15, s53, v2
    v_xor_b32 v6, s55, v15
    v_add_u32 v6, s54, v6
    v_and_b32 v92, 15, v1
    v_lshrrev_b32 v93, 4, v1
    v_bfe_u32 v88, v1, 4, 1
    v_lshrrev_b32 v89, 5, v1
    s_lshl2_add_u32 s55, s61, s3
    s_lshl_b32 s53, s55, 14
    s_lshl_b32 s54, s62, 7
    v_mov_b32 v8, v10
    v_lshlrev_b32 v18, 3, v93
    v_lshlrev_b32 v7, 4, v93
    v_and_b32 v90, 1, v1
    v_lshl_add_u32 v19, v90, 10, v7
    v_add_u32 v19, 161024, v19
    v_add_u32 v7, 163072, v7
    v_lshlrev_b32 v17, 2, v92
    v_lshl_add_u32 v17, v89, 6, v17
    v_lshlrev_b32 v0, 4, v92
    v_lshl_add_u32 v0, v88, 10, v0
    v_lshl_add_u32 v0, v89, 8, v0
    s_lshl_b32 s56, s62, 11
    s_add_u32 s19, s53, s56
    s_add_u32 s19, s19, 0x300000
    s_lshl_b32 s20, s55, 10
    s_add_u32 s20, s20, 0x60000
    s_add_u32 s21, s20, s54
    s_lshl_b32 s23, s3, 12
    s_lshl_b32 s18, s61, 16
    s_add_u32 s18, s18, s23
    s_add_u32 s18, s18, 0x300000
    s_add_u32 s23, s23, 49152
    s_mul_i32 s83, s3, 25312
    s_add_u32 s83, s83, 51328
    v_bfe_u32 v90, v1, 2, 2
    v_mul_u32_u24 v9, 1056, v90
    v_lshl_add_u32 v9, v93, 7, v9
    v_and_b32 v90, 3, v1
    v_lshl_add_u32 v9, v90, 3, v9
    v_add_u32 v9, s83, v9
    ds_read_b64_tr_b16 v[152:153], v9 offset:0
    ds_read_b64_tr_b16 v[154:155], v9 offset:512
    ds_read_b64_tr_b16 v[156:157], v9 offset:32
    ds_read_b64_tr_b16 v[158:159], v9 offset:544
    ds_read_b64_tr_b16 v[160:161], v9 offset:64
    ds_read_b64_tr_b16 v[162:163], v9 offset:576
    ds_read_b64_tr_b16 v[164:165], v9 offset:96
    ds_read_b64_tr_b16 v[166:167], v9 offset:608
    ds_read_b64_tr_b16 v[168:169], v9 offset:4224
    ds_read_b64_tr_b16 v[170:171], v9 offset:4736
    ds_read_b64_tr_b16 v[172:173], v9 offset:4256
    ds_read_b64_tr_b16 v[174:175], v9 offset:4768
    ds_read_b64_tr_b16 v[176:177], v9 offset:4288
    ds_read_b64_tr_b16 v[178:179], v9 offset:4800
    ds_read_b64_tr_b16 v[180:181], v9 offset:4320
    ds_read_b64_tr_b16 v[182:183], v9 offset:4832
    ds_read_b64_tr_b16 v[184:185], v9 offset:8448
    ds_read_b64_tr_b16 v[186:187], v9 offset:8960
    ds_read_b64_tr_b16 v[188:189], v9 offset:8480
    ds_read_b64_tr_b16 v[190:191], v9 offset:8992
    ds_read_b64_tr_b16 v[192:193], v9 offset:8512
    ds_read_b64_tr_b16 v[194:195], v9 offset:9024
    ds_read_b64_tr_b16 v[196:197], v9 offset:8544
    ds_read_b64_tr_b16 v[198:199], v9 offset:9056
    ds_read_b64_tr_b16 v[200:201], v9 offset:12672
    ds_read_b64_tr_b16 v[202:203], v9 offset:13184
    ds_read_b64_tr_b16 v[204:205], v9 offset:12704
    ds_read_b64_tr_b16 v[206:207], v9 offset:13216
    ds_read_b64_tr_b16 v[208:209], v9 offset:12736
    ds_read_b64_tr_b16 v[210:211], v9 offset:13248
    ds_read_b64_tr_b16 v[212:213], v9 offset:12768
    ds_read_b64_tr_b16 v[214:215], v9 offset:13280
    ds_read_b64_tr_b16 v[216:217], v9 offset:16896
    ds_read_b64_tr_b16 v[218:219], v9 offset:17408
    ds_read_b64_tr_b16 v[220:221], v9 offset:16928
    ds_read_b64_tr_b16 v[222:223], v9 offset:17440
    ds_read_b64_tr_b16 v[224:225], v9 offset:16960
    ds_read_b64_tr_b16 v[226:227], v9 offset:17472
    ds_read_b64_tr_b16 v[228:229], v9 offset:16992
    ds_read_b64_tr_b16 v[230:231], v9 offset:17504
    ds_read_b64_tr_b16 v[232:233], v9 offset:21120
    ds_read_b64_tr_b16 v[234:235], v9 offset:21632
    ds_read_b64_tr_b16 v[236:237], v9 offset:21152
    ds_read_b64_tr_b16 v[238:239], v9 offset:21664
    ds_read_b64_tr_b16 v[248:249], v9 offset:21184
    ds_read_b64_tr_b16 v[250:251], v9 offset:21696
    ds_read_b64_tr_b16 v[252:253], v9 offset:21216
    ds_read_b64_tr_b16 v[254:255], v9 offset:21728
    s_lshr_b32 s53, s61, 2
    s_lshl_b32 s53, s53, 5
    s_and_b32 s54, s61, 1
    s_lshl2_add_u32 s54, s54, s3
    s_add_u32 s53, s53, s54
    v_and_b32 v90, 3, v1
    v_lshl_add_u32 v10, v90, 3, s53
    v_lshlrev_b32 v10, 7, v10
    s_lshl2_add_u32 s53, s62, s3
    s_mul_i32 s22, s53, 3
    s_cmp_ge_u32 s53, 27
    s_subb_u32 s22, s22, s62
    s_cmp_ge_u32 s53, 31
    s_subb_u32 s22, s22, 0
    s_mul_i32 s56, s61, 176128
    s_add_u32 s56, s56, 0x500000
    s_add_u32 s53, s22, 0
    s_lshl_b32 s54, s53, 14
    s_add_u32 s12, s54, 0x1080000
    s_lshr_b32 s54, s53, 1
    s_lshl_b32 s54, s54, 12
    s_and_b32 s55, s53, 1
    s_lshl_b32 s55, s55, 9
    s_add_u32 s54, s54, s55
    s_add_u32 s15, s54, s56
    s_add_u32 s53, s22, 1
    s_lshl_b32 s54, s53, 14
    s_add_u32 s13, s54, 0x1080000
    s_lshr_b32 s54, s53, 1
    s_lshl_b32 s54, s54, 12
    s_and_b32 s55, s53, 1
    s_lshl_b32 s55, s55, 9
    s_add_u32 s54, s54, s55
    s_add_u32 s16, s54, s56
    s_add_u32 s53, s22, 2
    s_lshl_b32 s54, s53, 14
    s_add_u32 s14, s54, 0x1080000
    s_lshr_b32 s54, s53, 1
    s_lshl_b32 s54, s54, 12
    s_and_b32 s55, s53, 1
    s_lshl_b32 s55, s55, 9
    s_add_u32 s54, s54, s55
    s_add_u32 s17, s54, s56
    s_cmp_ge_u32 s62, 6
    s_addc_u32 s53, s3, 0
    s_cmp_ge_u32 s53, 3
    s_cmov_b32 s17, 0x10000000
    s_cmov_b32 s14, 0x10000000
    s_and_b32 s53, s61, 3
    s_mul_i32 s53, s53, 2
    s_add_u32 s53, s53, s62
    v_add_u32 v88, s53, v92
    v_mul_u32_u24 v89, 373, v88
    v_lshrrev_b32 v89, 12, v89
    v_mul_u32_u24 v89, 11, v89
    v_sub_u32 v88, v88, v89
    s_mul_i32 s54, s3, 11
    v_add_u32 v88, s54, v88
    v_cmp_gt_u32 vcc, 43, v88
    v_lshlrev_b32 v88, 12, v88
    v_mov_b32 v89, 0x10000000
    v_cndmask_b32 v16, v89, v88, vcc
    v_and_b32 v88, 31, v1
    v_lshrrev_b32 v89, 2, v88
    v_lshlrev_b32 v89, 5, v89
    v_and_b32 v20, 3, v88
    v_add_u32 v20, v20, v89
    s_and_b32 s53, s61, 3
    s_lshl_b32 s53, s53, 8
    s_and_b32 s54, s61, 28
    s_add_u32 s53, s53, s54
    v_add_u32 v20, s53, v20
    v_lshlrev_b32 v20, 5, v20
    s_lshl_b32 s55, s3, 3
    v_and_b32 v88, 7, v1
    v_add_u32 v88, s55, v88
    v_lshrrev_b32 v89, 2, v88
    v_lshlrev_b32 v89, 5, v89
    v_and_b32 v21, 3, v88
    v_add_u32 v21, v21, v89
    s_and_b32 s53, s61, 3
    s_lshl_b32 s53, s53, 8
    s_and_b32 s54, s61, 28
    s_add_u32 s53, s53, s54
    v_add_u32 v21, s53, v21
    v_lshlrev_b32 v21, 5, v21
    v_and_b32 v20, 0xffffff80, v20
    v_and_b32 v21, 0xffffff80, v21
    v_readlane_b32 s68, v16, 0
    v_readlane_b32 s69, v16, 1
    v_readlane_b32 s70, v16, 2
    v_readlane_b32 s71, v16, 3
    v_readlane_b32 s72, v16, 4
    v_readlane_b32 s73, v16, 5
    v_readlane_b32 s74, v16, 6
    v_readlane_b32 s75, v16, 7
    v_readlane_b32 s76, v16, 8
    v_readlane_b32 s77, v16, 9
    v_readlane_b32 s78, v16, 10
    s_lshl_b32 s4, s3, 11
    s_add_u32 s4, s4, 152576
    v_add_u32 v18, s4, v18
    v_add_u32 v9, s83, v2
    v_add_u32 v88, s4, v2
    ds_write_b128 v88, a[180:183]
    ds_write_b128 v88, a[184:187] offset:1024
    s_waitcnt lgkmcnt(0)
    s_add_u32 s45, s66, 4
    v_mov_b32 v23, s66
    v_mov_b32 v22, s45
    s_mov_b64 exec, 1
    s_waitcnt vmcnt(0)
    s_barrier
    buffer_store_dwordx2 v[22:23], v2, s[24:27], s41 offen sc1
    s_mov_b64 exec, -1
    buffer_load_dwordx4 a[180:183], v2, s[24:27], s12 offen offset:0 sc1
    buffer_load_dwordx4 a[184:187], v2, s[24:27], s12 offen offset:1024 sc1
    buffer_load_dwordx4 a[188:191], v2, s[24:27], s12 offen offset:2048 sc1
    buffer_load_dwordx4 a[192:195], v2, s[24:27], s12 offen offset:3072 sc1
    buffer_load_dwordx4 a[196:199], v2, s[24:27], s13 offen offset:0 sc1
    buffer_load_dwordx4 a[200:203], v2, s[24:27], s13 offen offset:1024 sc1
    buffer_load_dwordx4 a[204:207], v2, s[24:27], s13 offen offset:2048 sc1
    buffer_load_dwordx4 a[208:211], v2, s[24:27], s13 offen offset:3072 sc1
    buffer_load_dwordx4 a[212:215], v2, s[24:27], s14 offen offset:0 sc1
    buffer_load_dwordx4 a[216:219], v2, s[24:27], s14 offen offset:1024 sc1
    s_mov_b32 s49, 0x80000
    s_add_u32 s45, s66, 4
    buffer_load_dwordx2 v[22:23], v10, s[24:27], 0 offen sc1
    buffer_load_dwordx4 a[220:223], v2, s[24:27], s14 offen offset:2048 sc1
    buffer_load_dwordx4 a[224:227], v2, s[24:27], s14 offen offset:3072 sc1
    s_add_u32 s12, s12, 4096
    buffer_load_dwordx4 a[228:231], v2, s[24:27], s12 offen offset:0 sc1
    buffer_load_dwordx4 a[232:235], v2, s[24:27], s12 offen offset:1024 sc1
    buffer_load_dwordx4 a[236:239], v2, s[24:27], s12 offen offset:2048 sc1
    buffer_load_dwordx4 a[240:243], v2, s[24:27], s12 offen offset:3072 sc1
    s_waitcnt vmcnt(6)
    s_branch L_ptest_9
L_poll_7:
    buffer_load_dwordx2 v[22:23], v10, s[24:27], 0 offen sc1
    s_sub_u32 s49, s49, 1
    s_waitcnt vmcnt(0)
    s_cbranch_scc1 L_polled_8
L_ptest_9:
    v_subrev_u32 v22, s45, v22
    v_lshrrev_b32 v22, 3, v22
    v_bitop3_b32 v22, v23, s66, v22 bitop3:0xbe
    v_cmp_ne_u32 vcc, 0, v22
    s_cbranch_vccnz L_poll_7
L_polled_8:
    s_xor_b32 s53, s2, 64
    s_lshl_b32 s53, s53, 7
    v_mov_b32 v10, s53
    buffer_load_dwordx4 v[104:107], v3, s[24:27], s84 offen sc1
    buffer_load_dwordx4 v[108:111], v3, s[24:27], s85 offen sc1
    buffer_load_dwordx4 v[112:115], v3, s[24:27], s86 offen sc1
    buffer_load_dwordx4 v[116:119], v3, s[24:27], s87 offen sc1
    buffer_load_dwordx4 v[120:123], v3, s[24:27], s88 offen sc1
    buffer_load_dwordx4 v[124:127], v3, s[24:27], s89 offen sc1
    buffer_load_dwordx4 v[128:131], v3, s[24:27], s90 offen sc1
    buffer_load_dwordx4 v[132:135], v3, s[24:27], s91 offen sc1
    buffer_load_dwordx4 v[136:139], v3, s[24:27], s92 offen sc1
    buffer_load_dwordx4 v[140:143], v3, s[24:27], s93 offen sc1
    buffer_load_dwordx4 v[144:147], v3, s[24:27], s94 offen sc1
    buffer_load_dwordx4 v[148:151], v3, s[24:27], s95 offen sc1
    buffer_load_dwordx4 a[160:163], v3, s[24:27], s96 offen sc1
    buffer_load_dwordx4 a[164:167], v3, s[24:27], s97 offen sc1
    s_waitcnt vmcnt(13)
    v_mfma_f32_16x16x32_bf16 v[24:27], a[32:35], v[104:107], 0
    buffer_load_dwordx4 a[168:171], v3, s[24:27], s98 offen sc1
    v_mfma_f32_16x16x32_bf16 v[40:43], a[36:39], v[104:107], 0
    v_mfma_f32_16x16x32_bf16 v[56:59], a[40:43], v[104:107], 0
    v_mfma_f32_16x16x32_bf16 v[72:75], a[44:47], v[104:107], 0
    s_waitcnt vmcnt(13)
    v_mfma_f32_16x16x32_bf16 v[24:27], a[48:51], v[108:111], v[24:27]
    v_mfma_f32_16x16x32_bf16 v[40:43], a[52:55], v[108:111], v[40:43]
    buffer_load_dwordx4 v[104:107], v3, s[24:27], s99 offen sc1
    v_mfma_f32_16x16x32_bf16 v[56:59], a[56:59], v[108:111], v[56:59]
    v_xor_b32 v3, s80, v12
    v_add_u32 v3, s79, v3
    v_mfma_f32_16x16x32_bf16 v[72:75], a[60:63], v[108:111], v[72:75]
    s_waitcnt vmcnt(13)
    v_mfma_f32_16x16x32_bf16 v[24:27], a[64:67], v[112:115], v[24:27]
    s_waitcnt vmcnt(12)
    v_mfma_f32_16x16x32_bf16 v[24:27], a[80:83], v[116:119], v[24:27]
    buffer_load_dwordx4 v[108:111], v4, s[24:27], s84 offen sc1
    v_mfma_f32_16x16x32_bf16 v[40:43], a[68:71], v[112:115], v[40:43]
    v_mfma_f32_16x16x32_bf16 v[40:43], a[84:87], v[116:119], v[40:43]
    v_mfma_f32_16x16x32_bf16 v[56:59], a[72:75], v[112:115], v[56:59]
    v_mfma_f32_16x16x32_bf16 v[56:59], a[88:91], v[116:119], v[56:59]
    buffer_load_dwordx4 a[172:175], v4, s[24:27], s85 offen sc1
    v_mfma_f32_16x16x32_bf16 v[72:75], a[76:79], v[112:115], v[72:75]
    v_mfma_f32_16x16x32_bf16 v[72:75], a[92:95], v[116:119], v[72:75]
    s_waitcnt vmcnt(13)
    v_mfma_f32_16x16x32_bf16 v[24:27], a[96:99], v[120:123], v[24:27]
    s_waitcnt vmcnt(12)
    v_mfma_f32_16x16x32_bf16 v[24:27], a[112:115], v[124:127], v[24:27]
    buffer_load_dwordx4 v[112:115], v4, s[24:27], s86 offen sc1
    v_mfma_f32_16x16x32_bf16 v[40:43], a[100:103], v[120:123], v[40:43]
    v_mfma_f32_16x16x32_bf16 v[40:43], a[116:119], v[124:127], v[40:43]
    v_mfma_f32_16x16x32_bf16 v[56:59], a[104:107], v[120:123], v[56:59]
    v_mfma_f32_16x16x32_bf16 v[56:59], a[120:123], v[124:127], v[56:59]
    buffer_load_dwordx4 v[116:119], v4, s[24:27], s87 offen sc1
    v_mfma_f32_16x16x32_bf16 v[72:75], a[108:111], v[120:123], v[72:75]
    v_mfma_f32_16x16x32_bf16 v[72:75], a[124:127], v[124:127], v[72:75]
    s_waitcnt vmcnt(13)
    v_mfma_f32_16x16x32_bf16 v[24:27], a[128:131], v[128:131], v[24:27]
    s_waitcnt vmcnt(12)
    v_mfma_f32_16x16x32_bf16 v[24:27], a[144:147], v[132:135], v[24:27]
    buffer_load_dwordx4 v[120:123], v4, s[24:27], s88 offen sc1
    v_mfma_f32_16x16x32_bf16 v[40:43], a[132:135], v[128:131], v[40:43]
    v_mfma_f32_16x16x32_bf16 v[40:43], a[148:151], v[132:135], v[40:43]
    v_mfma_f32_16x16x32_bf16 v[56:59], a[136:139], v[128:131], v[56:59]
    v_mfma_f32_16x16x32_bf16 v[56:59], a[152:155], v[132:135], v[56:59]
    buffer_load_dwordx4 v[124:127], v4, s[24:27], s89 offen sc1
    v_mfma_f32_16x16x32_bf16 v[72:75], a[140:143], v[128:131], v[72:75]
    v_mfma_f32_16x16x32_bf16 v[72:75], a[156:159], v[132:135], v[72:75]
    s_waitcnt vmcnt(13)
    v_mfma_f32_16x16x32_bf16 v[24:27], a[0:3], v[136:139], v[24:27]
    s_waitcnt vmcnt(12)
    v_mfma_f32_16x16x32_bf16 v[24:27], a[16:19], v[140:143], v[24:27]
    buffer_load_dwordx4 v[128:131], v4, s[24:27], s90 offen sc1
    v_mfma_f32_16x16x32_bf16 v[40:43], a[4:7], v[136:139], v[40:43]
    v_mfma_f32_16x16x32_bf16 v[40:43], a[20:23], v[140:143], v[40:43]
    v_mfma_f32_16x16x32_bf16 v[56:59], a[8:11], v[136:139], v[56:59]
    v_mfma_f32_16x16x32_bf16 v[56:59], a[24:27], v[140:143], v[56:59]
    buffer_load_dwordx4 v[132:135], v4, s[24:27], s91 offen sc1
    v_mfma_f32_16x16x32_bf16 v[72:75], a[12:15], v[136:139], v[72:75]
    v_mfma_f32_16x16x32_bf16 v[72:75], a[28:31], v[140:143], v[72:75]
    s_waitcnt vmcnt(13)
    v_mfma_f32_16x16x32_bf16 v[24:27], v[152:155], v[144:147], v[24:27]
    s_waitcnt vmcnt(12)
L_region_A_end:
    v_mfma_f32_16x16x32_bf16 v[24:27], v[168:171], v[148:151], v[24:27]
    buffer_load_dwordx4 v[136:139], v4, s[24:27], s92 offen sc1
    v_mfma_f32_16x16x32_bf16 v[40:43], v[156:159], v[144:147], v[40:43]
    v_mfma_f32_16x16x32_bf16 v[40:43], v[172:175], v[148:151], v[40:43]
    v_mfma_f32_16x16x32_bf16 v[56:59], v[160:163], v[144:147], v[56:59]
    v_mfma_f32_16x16x32_bf16 v[56:59], v[176:179], v[148:151], v[56:59]
    buffer_load_dwordx4 v[140:143], v4, s[24:27], s93 offen sc1
    v_mfma_f32_16x16x32_bf16 v[72:75], v[164:167], v[144:147], v[72:75]
    v_mfma_f32_16x16x32_bf16 v[72:75], v[180:183], v[148:151], v[72:75]
    s_waitcnt vmcnt(13)
    v_mfma_f32_16x16x32_bf16 v[24:27], v[184:187], a[160:163], v[24:27]
    s_waitcnt vmcnt(12)
    v_mfma_f32_16x16x32_bf16 v[24:27], v[200:203], a[164:167], v[24:27]
    buffer_load_dwordx4 v[144:147], v4, s[24:27], s94 offen sc1
    v_mfma_f32_16x16x32_bf16 v[40:43], v[188:191], a[160:163], v[40:43]
    v_mfma_f32_16x16x32_bf16 v[40:43], v[204:207], a[164:167], v[40:43]
    v_mfma_f32_16x16x32_bf16 v[56:59], v[192:195], a[160:163], v[56:59]
    v_mfma_f32_16x16x32_bf16 v[56:59], v[208:211], a[164:167], v[56:59]
    buffer_load_dwordx4 v[148:151], v4, s[24:27], s95 offen sc1
    v_mfma_f32_16x16x32_bf16 v[72:75], v[196:199], a[160:163], v[72:75]
    v_mfma_f32_16x16x32_bf16 v[72:75], v[212:215], a[164:167], v[72:75]
    s_waitcnt vmcnt(13)
    v_mfma_f32_16x16x32_bf16 v[24:27], v[216:219], a[168:171], v[24:27]
    s_waitcnt vmcnt(12)
    v_mfma_f32_16x16x32_bf16 v[24:27], v[232:235], v[104:107], v[24:27]
    buffer_load_dwordx4 a[176:179], v4, s[24:27], s96 offen sc1
    v_mfma_f32_16x16x32_bf16 v[40:43], v[220:223], a[168:171], v[40:43]
    v_mfma_f32_16x16x32_bf16 v[40:43], v[236:239], v[104:107], v[40:43]
    v_mfma_f32_16x16x32_bf16 v[56:59], v[224:227], a[168:171], v[56:59]
    v_mfma_f32_16x16x32_bf16 v[56:59], v[248:251], v[104:107], v[56:59]
    buffer_load_dwordx4 a[160:163], v4, s[24:27], s97 offen sc1
    v_mfma_f32_16x16x32_bf16 v[72:75], v[228:231], a[168:171], v[72:75]
    v_permlane16_swap_b32 v240, v242
    v_permlane16_swap_b32 v241, v243
    v_mfma_f32_16x16x32_bf16 v[72:75], v[252:255], v[104:107], v[72:75]
    s_waitcnt vmcnt(13)
    v_permlane16_swap_b32 v244, v246
    v_permlane16_swap_b32 v245, v247
    v_mfma_f32_16x16x32_bf16 v[28:31], a[32:35], v[108:111], 0
    s_waitcnt vmcnt(12)
    v_mfma_f32_16x16x32_bf16 v[28:31], a[48:51], a[172:175], v[28:31]
    buffer_load_dwordx4 v[104:107], v4, s[24:27], s98 offen sc1
    v_mfma_f32_16x16x32_bf16 v[44:47], a[36:39], v[108:111], 0
    v_lshlrev_b32 v88, 16, v240
    v_and_b32 v89, 0xffff0000, v240
    v_mfma_f32_16x16x32_bf16 v[44:47], a[52:55], a[172:175], v[44:47]
    v_lshlrev_b32 v90, 16, v241
    v_and_b32 v91, 0xffff0000, v241
    v_mfma_f32_16x16x32_bf16 v[60:63], a[40:43], v[108:111], 0
    ds_write_b128 v12, v[24:27] offset:0
    v_mfma_f32_16x16x32_bf16 v[60:63], a[56:59], a[172:175], v[60:63]
    buffer_load_dwordx4 a[164:167], v4, s[24:27], s99 offen sc1
    v_mfma_f32_16x16x32_bf16 v[76:79], a[44:47], v[108:111], 0
    v_xor_b32 v4, s80, v13
    v_add_u32 v4, s79, v4
    v_mfma_f32_16x16x32_bf16 v[76:79], a[60:63], a[172:175], v[76:79]
    s_waitcnt vmcnt(13)
    v_lshlrev_b32 v92, 16, v242
    v_and_b32 v93, 0xffff0000, v242
    v_mfma_f32_16x16x32_bf16 v[28:31], a[64:67], v[112:115], v[28:31]
    s_waitcnt vmcnt(12)
    ds_write_b128 v12, v[40:43] offset:4096
    v_mfma_f32_16x16x32_bf16 v[28:31], a[80:83], v[116:119], v[28:31]
    buffer_load_dwordx4 v[108:111], v5, s[24:27], s84 offen sc1
    v_mfma_f32_16x16x32_bf16 v[44:47], a[68:71], v[112:115], v[44:47]
    v_lshlrev_b32 v94, 16, v243
    v_and_b32 v95, 0xffff0000, v243
    v_mfma_f32_16x16x32_bf16 v[44:47], a[84:87], v[116:119], v[44:47]
    v_lshlrev_b32 v96, 16, v244
    v_and_b32 v97, 0xffff0000, v244
    v_mfma_f32_16x16x32_bf16 v[60:63], a[72:75], v[112:115], v[60:63]
    ds_write_b128 v12, v[56:59] offset:8192
    v_mfma_f32_16x16x32_bf16 v[60:63], a[88:91], v[116:119], v[60:63]
    buffer_load_dwordx4 a[168:171], v5, s[24:27], s85 offen sc1
    v_mfma_f32_16x16x32_bf16 v[76:79], a[76:79], v[112:115], v[76:79]
    v_lshlrev_b32 v98, 16, v245
    v_and_b32 v99, 0xffff0000, v245
    v_mfma_f32_16x16x32_bf16 v[76:79], a[92:95], v[116:119], v[76:79]
    s_waitcnt vmcnt(13)
    v_lshlrev_b32 v100, 16, v246
    v_and_b32 v101, 0xffff0000, v246
    v_mfma_f32_16x16x32_bf16 v[28:31], a[96:99], v[120:123], v[28:31]
    s_waitcnt vmcnt(12)
    ds_write_b128 v12, v[72:75] offset:12288
    v_mfma_f32_16x16x32_bf16 v[28:31], a[112:115], v[124:127], v[28:31]
    buffer_load_dwordx4 v[112:115], v5, s[24:27], s86 offen sc1
    v_mfma_f32_16x16x32_bf16 v[44:47], a[100:103], v[120:123], v[44:47]
    v_lshlrev_b32 v102, 16, v247
    v_and_b32 v103, 0xffff0000, v247
    v_mfma_f32_16x16x32_bf16 v[44:47], a[116:119], v[124:127], v[44:47]
    v_mfma_f32_16x16x32_bf16 v[60:63], a[104:107], v[120:123], v[60:63]
    v_mfma_f32_16x16x32_bf16 v[60:63], a[120:123], v[124:127], v[60:63]
    buffer_load_dwordx4 v[116:119], v5, s[24:27], s87 offen sc1
    v_mfma_f32_16x16x32_bf16 v[76:79], a[108:111], v[120:123], v[76:79]
    v_mfma_f32_16x16x32_bf16 v[76:79], a[124:127], v[124:127], v[76:79]
    s_waitcnt vmcnt(13)
    v_mfma_f32_16x16x32_bf16 v[28:31], a[128:131], v[128:131], v[28:31]
    s_waitcnt vmcnt(12)
    v_mfma_f32_16x16x32_bf16 v[28:31], a[144:147], v[132:135], v[28:31]
    buffer_load_dwordx4 v[120:123], v5, s[24:27], s88 offen sc1
    v_mfma_f32_16x16x32_bf16 v[44:47], a[132:135], v[128:131], v[44:47]
    v_mfma_f32_16x16x32_bf16 v[44:47], a[148:151], v[132:135], v[44:47]
    v_mfma_f32_16x16x32_bf16 v[60:63], a[136:139], v[128:131], v[60:63]
    v_mfma_f32_16x16x32_bf16 v[60:63], a[152:155], v[132:135], v[60:63]
    buffer_load_dwordx4 v[124:127], v5, s[24:27], s89 offen sc1
    v_mfma_f32_16x16x32_bf16 v[76:79], a[140:143], v[128:131], v[76:79]
    v_mfma_f32_16x16x32_bf16 v[76:79], a[156:159], v[132:135], v[76:79]
    s_waitcnt vmcnt(13)
    v_mfma_f32_16x16x32_bf16 v[28:31], a[0:3], v[136:139], v[28:31]
    s_waitcnt vmcnt(12)
    v_mfma_f32_16x16x32_bf16 v[28:31], a[16:19], v[140:143], v[28:31]
    buffer_load_dwordx4 v[128:131], v5, s[24:27], s90 offen sc1
    v_mfma_f32_16x16x32_bf16 v[44:47], a[4:7], v[136:139], v[44:47]
    v_mfma_f32_16x16x32_bf16 v[44:47], a[20:23], v[140:143], v[44:47]
    v_mfma_f32_16x16x32_bf16 v[60:63], a[8:11], v[136:139], v[60:63]
    v_mfma_f32_16x16x32_bf16 v[60:63], a[24:27], v[140:143], v[60:63]
    buffer_load_dwordx4 v[132:135], v5, s[24:27], s91 offen sc1
    v_mfma_f32_16x16x32_bf16 v[76:79], a[12:15], v[136:139], v[76:79]
    v_mfma_f32_16x16x32_bf16 v[76:79], a[28:31], v[140:143], v[76:79]
    s_waitcnt vmcnt(13)
    v_mfma_f32_16x16x32_bf16 v[28:31], v[152:155], v[144:147], v[28:31]
    s_waitcnt vmcnt(12)
    v_mfma_f32_16x16x32_bf16 v[28:31], v[168:171], v[148:151], v[28:31]
    buffer_load_dwordx4 v[136:139], v5, s[24:27], s92 offen sc1
    v_mfma_f32_16x16x32_bf16 v[44:47], v[156:159], v[144:147], v[44:47]
    v_mfma_f32_16x16x32_bf16 v[44:47], v[172:175], v[148:151], v[44:47]
    v_mfma_f32_16x16x32_bf16 v[60:63], v[160:163], v[144:147], v[60:63]
    v_mfma_f32_16x16x32_bf16 v[60:63], v[176:179], v[148:151], v[60:63]
    buffer_load_dwordx4 v[140:143], v5, s[24:27], s93 offen sc1
    v_mfma_f32_16x16x32_bf16 v[76:79], v[164:167], v[144:147], v[76:79]
    v_mfma_f32_16x16x32_bf16 v[76:79], v[180:183], v[148:151], v[76:79]
    s_waitcnt vmcnt(13)
    v_mfma_f32_16x16x32_bf16 v[28:31], v[184:187], a[176:179], v[28:31]
    s_waitcnt vmcnt(12)
    v_mfma_f32_16x16x32_bf16 v[28:31], v[200:203], a[160:163], v[28:31]
    buffer_load_dwordx4 v[144:147], v5, s[24:27], s94 offen sc1
    v_mfma_f32_16x16x32_bf16 v[44:47], v[188:191], a[176:179], v[44:47]
    v_mfma_f32_16x16x32_bf16 v[44:47], v[204:207], a[160:163], v[44:47]
    v_mfma_f32_16x16x32_bf16 v[60:63], v[192:195], a[176:179], v[60:63]
    v_mfma_f32_16x16x32_bf16 v[60:63], v[208:211], a[160:163], v[60:63]
    v_mfma_f32_16x16x32_bf16 v[76:79], v[196:199], a[176:179], v[76:79]
    buffer_load_dwordx4 v[148:151], v5, s[24:27], s95 offen sc1
    v_mfma_f32_16x16x32_bf16 v[76:79], v[212:215], a[160:163], v[76:79]
    s_waitcnt vmcnt(13)
    v_mfma_f32_16x16x32_bf16 v[28:31], v[216:219], v[104:107], v[28:31]
    s_waitcnt vmcnt(12)
    v_mfma_f32_16x16x32_bf16 v[28:31], v[232:235], a[164:167], v[28:31]
    v_mfma_f32_16x16x32_bf16 v[44:47], v[220:223], v[104:107], v[44:47]
    buffer_load_dwordx4 a[172:175], v5, s[24:27], s96 offen sc1
    v_mfma_f32_16x16x32_bf16 v[44:47], v[236:239], a[164:167], v[44:47]
    v_mfma_f32_16x16x32_bf16 v[60:63], v[224:227], v[104:107], v[60:63]
    v_mfma_f32_16x16x32_bf16 v[60:63], v[248:251], a[164:167], v[60:63]
    v_mfma_f32_16x16x32_bf16 v[76:79], v[228:231], v[104:107], v[76:79]
    buffer_load_dwordx4 a[176:179], v5, s[24:27], s97 offen sc1
    v_mfma_f32_16x16x32_bf16 v[76:79], v[252:255], a[164:167], v[76:79]
    s_waitcnt vmcnt(13)
    v_mfma_f32_16x16x32_bf16 v[32:35], a[32:35], v[108:111], 0
    s_waitcnt vmcnt(12)
    v_mfma_f32_16x16x32_bf16 v[32:35], a[48:51], a[168:171], v[32:35]
    ds_write_b128 v13, v[28:31] offset:16384
    v_mfma_f32_16x16x32_bf16 v[48:51], a[36:39], v[108:111], 0
    buffer_load_dwordx4 v[104:107], v5, s[24:27], s98 offen sc1
    v_mfma_f32_16x16x32_bf16 v[48:51], a[52:55], a[168:171], v[48:51]
    ds_write_b128 v13, v[44:47] offset:20480
    v_mfma_f32_16x16x32_bf16 v[64:67], a[40:43], v[108:111], 0
    v_mfma_f32_16x16x32_bf16 v[64:67], a[56:59], a[168:171], v[64:67]
    ds_write_b128 v13, v[60:63] offset:24576
    v_mfma_f32_16x16x32_bf16 v[80:83], a[44:47], v[108:111], 0
    buffer_load_dwordx4 a[160:163], v5, s[24:27], s99 offen sc1
    v_mfma_f32_16x16x32_bf16 v[80:83], a[60:63], a[168:171], v[80:83]
    s_waitcnt vmcnt(13)
    v_xor_b32 v5, s80, v14
    v_add_u32 v5, s79, v5
    v_mfma_f32_16x16x32_bf16 v[32:35], a[64:67], v[112:115], v[32:35]
    s_waitcnt vmcnt(12)
    ds_write_b128 v13, v[76:79] offset:28672
    v_mfma_f32_16x16x32_bf16 v[32:35], a[80:83], v[116:119], v[32:35]
    v_mfma_f32_16x16x32_bf16 v[48:51], a[68:71], v[112:115], v[48:51]
    buffer_load_dwordx4 v[108:111], v6, s[24:27], s84 offen sc1
    v_mfma_f32_16x16x32_bf16 v[48:51], a[84:87], v[116:119], v[48:51]
    v_mfma_f32_16x16x32_bf16 v[64:67], a[72:75], v[112:115], v[64:67]
    v_mfma_f32_16x16x32_bf16 v[64:67], a[88:91], v[116:119], v[64:67]
    v_mfma_f32_16x16x32_bf16 v[80:83], a[76:79], v[112:115], v[80:83]
    buffer_load_dwordx4 a[164:167], v6, s[24:27], s85 offen sc1
    v_mfma_f32_16x16x32_bf16 v[80:83], a[92:95], v[116:119], v[80:83]
    s_waitcnt vmcnt(13)
    v_mfma_f32_16x16x32_bf16 v[32:35], a[96:99], v[120:123], v[32:35]
    s_waitcnt vmcnt(12)
    v_mfma_f32_16x16x32_bf16 v[32:35], a[112:115], v[124:127], v[32:35]
    v_mfma_f32_16x16x32_bf16 v[48:51], a[100:103], v[120:123], v[48:51]
    buffer_load_dwordx4 v[112:115], v6, s[24:27], s86 offen sc1
    v_mfma_f32_16x16x32_bf16 v[48:51], a[116:119], v[124:127], v[48:51]
    v_mfma_f32_16x16x32_bf16 v[64:67], a[104:107], v[120:123], v[64:67]
    v_mfma_f32_16x16x32_bf16 v[64:67], a[120:123], v[124:127], v[64:67]
    v_mfma_f32_16x16x32_bf16 v[80:83], a[108:111], v[120:123], v[80:83]
    buffer_load_dwordx4 v[116:119], v6, s[24:27], s87 offen sc1
    v_mfma_f32_16x16x32_bf16 v[80:83], a[124:127], v[124:127], v[80:83]
    s_waitcnt vmcnt(13)
    v_mfma_f32_16x16x32_bf16 v[32:35], a[128:131], v[128:131], v[32:35]
    s_waitcnt vmcnt(12)
    v_mfma_f32_16x16x32_bf16 v[32:35], a[144:147], v[132:135], v[32:35]
    v_mfma_f32_16x16x32_bf16 v[48:51], a[132:135], v[128:131], v[48:51]
    buffer_load_dwordx4 v[120:123], v6, s[24:27], s88 offen sc1
    v_mfma_f32_16x16x32_bf16 v[48:51], a[148:151], v[132:135], v[48:51]
    v_mfma_f32_16x16x32_bf16 v[64:67], a[136:139], v[128:131], v[64:67]
    v_mfma_f32_16x16x32_bf16 v[64:67], a[152:155], v[132:135], v[64:67]
    v_mfma_f32_16x16x32_bf16 v[80:83], a[140:143], v[128:131], v[80:83]
    buffer_load_dwordx4 v[124:127], v6, s[24:27], s89 offen sc1
    v_mfma_f32_16x16x32_bf16 v[80:83], a[156:159], v[132:135], v[80:83]
    s_waitcnt vmcnt(13)
    v_mfma_f32_16x16x32_bf16 v[32:35], a[0:3], v[136:139], v[32:35]
    s_waitcnt vmcnt(12)
    v_mfma_f32_16x16x32_bf16 v[32:35], a[16:19], v[140:143], v[32:35]
    v_mfma_f32_16x16x32_bf16 v[48:51], a[4:7], v[136:139], v[48:51]
    buffer_load_dwordx4 v[128:131], v6, s[24:27], s90 offen sc1
    v_mfma_f32_16x16x32_bf16 v[48:51], a[20:23], v[140:143], v[48:51]
    v_mfma_f32_16x16x32_bf16 v[64:67], a[8:11], v[136:139], v[64:67]
    v_mfma_f32_16x16x32_bf16 v[64:67], a[24:27], v[140:143], v[64:67]
    v_mfma_f32_16x16x32_bf16 v[80:83], a[12:15], v[136:139], v[80:83]
    buffer_load_dwordx4 v[132:135], v6, s[24:27], s91 offen sc1
    v_mfma_f32_16x16x32_bf16 v[80:83], a[28:31], v[140:143], v[80:83]
    s_waitcnt vmcnt(13)
    v_mfma_f32_16x16x32_bf16 v[32:35], v[152:155], v[144:147], v[32:35]
    s_waitcnt vmcnt(12)
    v_mfma_f32_16x16x32_bf16 v[32:35], v[168:171], v[148:151], v[32:35]
    v_mfma_f32_16x16x32_bf16 v[48:51], v[156:159], v[144:147], v[48:51]
    buffer_load_dwordx4 v[136:139], v6, s[24:27], s92 offen sc1
    v_mfma_f32_16x16x32_bf16 v[48:51], v[172:175], v[148:151], v[48:51]
    v_mfma_f32_16x16x32_bf16 v[64:67], v[160:163], v[144:147], v[64:67]
    v_mfma_f32_16x16x32_bf16 v[64:67], v[176:179], v[148:151], v[64:67]
    v_mfma_f32_16x16x32_bf16 v[80:83], v[164:167], v[144:147], v[80:83]
    buffer_load_dwordx4 v[140:143], v6, s[24:27], s93 offen sc1
    v_mfma_f32_16x16x32_bf16 v[80:83], v[180:183], v[148:151], v[80:83]
    s_waitcnt vmcnt(13)
    v_mfma_f32_16x16x32_bf16 v[32:35], v[184:187], a[172:175], v[32:35]
    s_waitcnt vmcnt(12)
    v_mfma_f32_16x16x32_bf16 v[32:35], v[200:203], a[176:179], v[32:35]
    v_mfma_f32_16x16x32_bf16 v[48:51], v[188:191], a[172:175], v[48:51]
    buffer_load_dwordx4 v[144:147], v6, s[24:27], s94 offen sc1
    v_mfma_f32_16x16x32_bf16 v[48:51], v[204:207], a[176:179], v[48:51]
    v_mfma_f32_16x16x32_bf16 v[64:67], v[192:195], a[172:175], v[64:67]
    v_mfma_f32_16x16x32_bf16 v[64:67], v[208:211], a[176:179], v[64:67]
    v_mfma_f32_16x16x32_bf16 v[80:83], v[196:199], a[172:175], v[80:83]
    buffer_load_dwordx4 v[148:151], v6, s[24:27], s95 offen sc1
    v_mfma_f32_16x16x32_bf16 v[80:83], v[212:215], a[176:179], v[80:83]
    s_waitcnt vmcnt(13)
    v_mfma_f32_16x16x32_bf16 v[32:35], v[216:219], v[104:107], v[32:35]
    s_waitcnt vmcnt(12)
    v_mfma_f32_16x16x32_bf16 v[32:35], v[232:235], a[160:163], v[32:35]
    v_mfma_f32_16x16x32_bf16 v[48:51], v[220:223], v[104:107], v[48:51]
    buffer_load_dwordx4 a[168:171], v6, s[24:27], s96 offen sc1
    v_mfma_f32_16x16x32_bf16 v[48:51], v[236:239], a[160:163], v[48:51]
    v_mfma_f32_16x16x32_bf16 v[64:67], v[224:227], v[104:107], v[64:67]
    v_mfma_f32_16x16x32_bf16 v[64:67], v[248:251], a[160:163], v[64:67]
    v_mfma_f32_16x16x32_bf16 v[80:83], v[228:231], v[104:107], v[80:83]
    buffer_load_dwordx4 a[172:175], v6, s[24:27], s97 offen sc1
    v_mfma_f32_16x16x32_bf16 v[80:83], v[252:255], a[160:163], v[80:83]
    s_waitcnt vmcnt(13)
    v_mfma_f32_16x16x32_bf16 v[36:39], a[32:35], v[108:111], 0
    s_waitcnt vmcnt(12)
    v_mfma_f32_16x16x32_bf16 v[36:39], a[48:51], a[164:167], v[36:39]
    ds_write_b128 v14, v[32:35] offset:32768
    v_mfma_f32_16x16x32_bf16 v[52:55], a[36:39], v[108:111], 0
    buffer_load_dwordx4 v[104:107], v6, s[24:27], s98 offen sc1
    v_mfma_f32_16x16x32_bf16 v[52:55], a[52:55], a[164:167], v[52:55]
    ds_write_b128 v14, v[48:51] offset:36864
    v_mfma_f32_16x16x32_bf16 v[68:71], a[40:43], v[108:111], 0
    v_mfma_f32_16x16x32_bf16 v[68:71], a[56:59], a[164:167], v[68:71]
    ds_write_b128 v14, v[64:67] offset:40960
    v_mfma_f32_16x16x32_bf16 v[84:87], a[44:47], v[108:111], 0
    buffer_load_dwordx4 a[176:179], v6, s[24:27], s99 offen sc1
    v_mfma_f32_16x16x32_bf16 v[84:87], a[60:63], a[164:167], v[84:87]
    s_waitcnt vmcnt(13)
    v_xor_b32 v6, s80, v15
    v_add_u32 v6, s79, v6
    v_mfma_f32_16x16x32_bf16 v[36:39], a[64:67], v[112:115], v[36:39]
    s_waitcnt vmcnt(12)
    ds_write_b128 v14, v[80:83] offset:45056
    v_mfma_f32_16x16x32_bf16 v[36:39], a[80:83], v[116:119], v[36:39]
    v_mfma_f32_16x16x32_bf16 v[52:55], a[68:71], v[112:115], v[52:55]
    buffer_load_dwordx4 v[108:111], v3, s[24:27], s84 offen sc1
    v_mfma_f32_16x16x32_bf16 v[52:55], a[84:87], v[116:119], v[52:55]
    s_lshr_b32 s64, s2, 3
    s_lshl2_add_u32 s64, s64, s3
    s_lshl_b32 s64, s64, 7
    s_add_u32 s64, s64, 2048
    s_min_u32 s64, s64, L_code_end - L_ct_4 - 64
    s_getpc_b64 s[100:101]
L_ct_4:
    s_add_u32 s100, s100, s64
    s_addc_u32 s101, s101, 0
    global_load_ubyte v22, v1, s[100:101]
    v_mfma_f32_16x16x32_bf16 v[68:71], a[72:75], v[112:115], v[68:71]
    s_waitcnt lgkmcnt(0)
    s_barrier
    v_mfma_f32_16x16x32_bf16 v[68:71], a[88:91], v[116:119], v[68:71]
    ds_read_b128 v[24:27], v15 offset:0
    v_mfma_f32_16x16x32_bf16 v[84:87], a[76:79], v[112:115], v[84:87]
    buffer_load_dwordx4 a[160:163], v3, s[24:27], s85 offen sc1
    v_mfma_f32_16x16x32_bf16 v[84:87], a[92:95], v[116:119], v[84:87]
    s_waitcnt vmcnt(14)
    ds_read_b128 v[28:31], v15 offset:16384
    v_mfma_f32_16x16x32_bf16 v[36:39], a[96:99], v[120:123], v[36:39]
    s_waitcnt vmcnt(13)
    ds_read_b128 v[32:35], v15 offset:32768
    v_mfma_f32_16x16x32_bf16 v[36:39], a[112:115], v[124:127], v[36:39]
    ds_read_b128 v[40:43], v15 offset:4096
    v_mfma_f32_16x16x32_bf16 v[52:55], a[100:103], v[120:123], v[52:55]
    buffer_load_dwordx4 v[112:115], v3, s[24:27], s86 offen sc1
    v_mfma_f32_16x16x32_bf16 v[52:55], a[116:119], v[124:127], v[52:55]
    ds_read_b128 v[44:47], v15 offset:20480
    v_mfma_f32_16x16x32_bf16 v[68:71], a[104:107], v[120:123], v[68:71]
    ds_read_b128 v[48:51], v15 offset:36864
    v_mfma_f32_16x16x32_bf16 v[68:71], a[120:123], v[124:127], v[68:71]
    ds_read_b128 v[56:59], v15 offset:8192
    v_mfma_f32_16x16x32_bf16 v[84:87], a[108:111], v[120:123], v[84:87]
    buffer_load_dwordx4 v[116:119], v3, s[24:27], s87 offen sc1
    v_mfma_f32_16x16x32_bf16 v[84:87], a[124:127], v[124:127], v[84:87]
    s_waitcnt vmcnt(14)
    ds_read_b128 v[60:63], v15 offset:24576
    v_mfma_f32_16x16x32_bf16 v[36:39], a[128:131], v[128:131], v[36:39]
    s_waitcnt vmcnt(13)
    ds_read_b128 v[64:67], v15 offset:40960
    v_mfma_f32_16x16x32_bf16 v[36:39], a[144:147], v[132:135], v[36:39]
    ds_read_b128 v[72:75], v15 offset:12288
    v_mfma_f32_16x16x32_bf16 v[52:55], a[132:135], v[128:131], v[52:55]
    buffer_load_dwordx4 v[120:123], v3, s[24:27], s88 offen sc1
    v_mfma_f32_16x16x32_bf16 v[52:55], a[148:151], v[132:135], v[52:55]
    ds_read_b128 v[76:79], v15 offset:28672
    v_mfma_f32_16x16x32_bf16 v[68:71], a[136:139], v[128:131], v[68:71]
    ds_read_b128 v[80:83], v15 offset:45056
    v_mfma_f32_16x16x32_bf16 v[68:71], a[152:155], v[132:135], v[68:71]
    v_mfma_f32_16x16x32_bf16 v[84:87], a[140:143], v[128:131], v[84:87]
    buffer_load_dwordx4 v[124:127], v3, s[24:27], s89 offen sc1
    v_mfma_f32_16x16x32_bf16 v[84:87], a[156:159], v[132:135], v[84:87]
    s_waitcnt vmcnt(14) lgkmcnt(9)
    v_add_f32 v32, v32, v24
    v_add_f32 v33, v33, v25
    v_mfma_f32_16x16x32_bf16 v[36:39], a[0:3], v[136:139], v[36:39]
    s_waitcnt vmcnt(13)
    v_add_f32 v34, v34, v26
    v_add_f32 v35, v35, v27
    v_mfma_f32_16x16x32_bf16 v[36:39], a[16:19], v[140:143], v[36:39]
    v_mfma_f32_16x16x32_bf16 v[52:55], a[4:7], v[136:139], v[52:55]
    buffer_load_dwordx4 v[128:131], v3, s[24:27], s90 offen sc1
    v_mfma_f32_16x16x32_bf16 v[52:55], a[20:23], v[140:143], v[52:55]
    v_add_f32 v32, v32, v28
    v_add_f32 v33, v33, v29
    v_mfma_f32_16x16x32_bf16 v[68:71], a[8:11], v[136:139], v[68:71]
    v_add_f32 v34, v34, v30
    v_add_f32 v35, v35, v31
    v_mfma_f32_16x16x32_bf16 v[68:71], a[24:27], v[140:143], v[68:71]
    s_waitcnt lgkmcnt(6)
    v_add_f32 v48, v48, v40
    v_add_f32 v49, v49, v41
    v_mfma_f32_16x16x32_bf16 v[84:87], a[12:15], v[136:139], v[84:87]
    v_mfma_f32_16x16x32_bf16 v[84:87], a[28:31], v[140:143], v[84:87]
    s_waitcnt vmcnt(13)
    buffer_load_dwordx4 v[132:135], v3, s[24:27], s91 offen sc1
    v_mfma_f32_16x16x32_bf16 v[36:39], v[152:155], v[144:147], v[36:39]
    s_waitcnt vmcnt(13)
    v_add_f32 v50, v50, v42
    v_add_f32 v51, v51, v43
    v_mfma_f32_16x16x32_bf16 v[36:39], v[168:171], v[148:151], v[36:39]
    v_add_f32 v48, v48, v44
    v_add_f32 v49, v49, v45
    v_mfma_f32_16x16x32_bf16 v[52:55], v[156:159], v[144:147], v[52:55]
    v_mfma_f32_16x16x32_bf16 v[52:55], v[172:175], v[148:151], v[52:55]
    buffer_load_dwordx4 v[136:139], v3, s[24:27], s92 offen sc1
    v_mfma_f32_16x16x32_bf16 v[68:71], v[160:163], v[144:147], v[68:71]
    v_add_f32 v50, v50, v46
    v_add_f32 v51, v51, v47
    v_mfma_f32_16x16x32_bf16 v[68:71], v[176:179], v[148:151], v[68:71]
    s_waitcnt lgkmcnt(3)
    v_add_f32 v64, v64, v56
    v_add_f32 v65, v65, v57
    v_mfma_f32_16x16x32_bf16 v[84:87], v[164:167], v[144:147], v[84:87]
    v_mfma_f32_16x16x32_bf16 v[84:87], v[180:183], v[148:151], v[84:87]
    s_waitcnt vmcnt(13)
    buffer_load_dwordx4 v[140:143], v3, s[24:27], s93 offen sc1
    v_mfma_f32_16x16x32_bf16 v[36:39], v[184:187], a[168:171], v[36:39]
    s_waitcnt vmcnt(13)
    v_add_f32 v66, v66, v58
    v_add_f32 v67, v67, v59
    v_mfma_f32_16x16x32_bf16 v[36:39], v[200:203], a[172:175], v[36:39]
    v_add_f32 v64, v64, v60
    v_add_f32 v65, v65, v61
    v_mfma_f32_16x16x32_bf16 v[52:55], v[188:191], a[168:171], v[52:55]
    v_mfma_f32_16x16x32_bf16 v[52:55], v[204:207], a[172:175], v[52:55]
    buffer_load_dwordx4 v[144:147], v3, s[24:27], s94 offen sc1
    v_mfma_f32_16x16x32_bf16 v[68:71], v[192:195], a[168:171], v[68:71]
    v_add_f32 v66, v66, v62
    v_add_f32 v67, v67, v63
    v_mfma_f32_16x16x32_bf16 v[68:71], v[208:211], a[172:175], v[68:71]
    s_waitcnt lgkmcnt(0)
    v_add_f32 v80, v80, v72
    v_add_f32 v81, v81, v73
    v_mfma_f32_16x16x32_bf16 v[84:87], v[196:199], a[168:171], v[84:87]
    v_mfma_f32_16x16x32_bf16 v[84:87], v[212:215], a[172:175], v[84:87]
    s_waitcnt vmcnt(13)
    buffer_load_dwordx4 v[148:151], v3, s[24:27], s95 offen sc1
    v_mfma_f32_16x16x32_bf16 v[36:39], v[216:219], v[104:107], v[36:39]
    s_waitcnt vmcnt(13)
    v_add_f32 v82, v82, v74
    v_add_f32 v83, v83, v75
    v_mfma_f32_16x16x32_bf16 v[36:39], v[232:235], a[176:179], v[36:39]
    v_add_f32 v80, v80, v76
    v_add_f32 v81, v81, v77
    v_mfma_f32_16x16x32_bf16 v[52:55], v[220:223], v[104:107], v[52:55]
    v_mfma_f32_16x16x32_bf16 v[52:55], v[236:239], a[176:179], v[52:55]
    buffer_load_dwordx4 a[164:167], v3, s[24:27], s96 offen sc1
    v_mfma_f32_16x16x32_bf16 v[68:71], v[224:227], v[104:107], v[68:71]
    v_add_f32 v82, v82, v78
    v_add_f32 v83, v83, v79
    v_mfma_f32_16x16x32_bf16 v[68:71], v[248:251], a[176:179], v[68:71]
    v_mfma_f32_16x16x32_bf16 v[84:87], v[228:231], v[104:107], v[84:87]
    v_mfma_f32_16x16x32_bf16 v[84:87], v[252:255], a[176:179], v[84:87]
    s_waitcnt vmcnt(13)
    buffer_load_dwordx4 v[104:107], v3, s[24:27], s97 offen sc1
    v_mfma_f32_16x16x32_bf16 v[24:27], a[32:35], v[108:111], 0
    s_waitcnt vmcnt(12)
    v_mfma_f32_16x16x32_bf16 v[24:27], a[48:51], a[160:163], v[24:27]
    v_mfma_f32_16x16x32_bf16 v[40:43], a[36:39], v[108:111], 0
    v_mfma_f32_16x16x32_bf16 v[40:43], a[52:55], a[160:163], v[40:43]
    buffer_load_dwordx4 a[168:171], v3, s[24:27], s98 offen sc1
    v_mfma_f32_16x16x32_bf16 v[56:59], a[40:43], v[108:111], 0
    v_mfma_f32_16x16x32_bf16 v[56:59], a[56:59], a[160:163], v[56:59]
    v_mfma_f32_16x16x32_bf16 v[72:75], a[44:47], v[108:111], 0
    v_mfma_f32_16x16x32_bf16 v[72:75], a[60:63], a[160:163], v[72:75]
    s_waitcnt vmcnt(12)
    buffer_load_dwordx4 v[108:111], v3, s[24:27], s99 offen sc1
    v_add_f32 v36, v36, v32
    v_add_f32 v37, v37, v33
    v_mfma_f32_16x16x32_bf16 v[24:27], a[64:67], v[112:115], v[24:27]
    s_waitcnt vmcnt(12)
    v_add_f32 v38, v38, v34
    v_add_f32 v39, v39, v35
    v_mfma_f32_16x16x32_bf16 v[24:27], a[80:83], v[116:119], v[24:27]
    v_add_f32 v52, v52, v48
    v_add_f32 v53, v53, v49
    v_mfma_f32_16x16x32_bf16 v[40:43], a[68:71], v[112:115], v[40:43]
    v_add_f32 v54, v54, v50
    v_add_f32 v55, v55, v51
    v_mfma_f32_16x16x32_bf16 v[40:43], a[84:87], v[116:119], v[40:43]
    buffer_load_dwordx4 a[172:175], v4, s[24:27], s84 offen sc1
    v_add_f32 v68, v68, v64
    v_add_f32 v69, v69, v65
    v_mfma_f32_16x16x32_bf16 v[56:59], a[72:75], v[112:115], v[56:59]
    v_add_f32 v70, v70, v66
    v_add_f32 v71, v71, v67
    v_mfma_f32_16x16x32_bf16 v[56:59], a[88:91], v[116:119], v[56:59]
    v_add_f32 v84, v84, v80
    v_add_f32 v85, v85, v81
    v_mfma_f32_16x16x32_bf16 v[72:75], a[76:79], v[112:115], v[72:75]
    v_add_f32 v86, v86, v82
    v_add_f32 v87, v87, v83
    v_mfma_f32_16x16x32_bf16 v[72:75], a[92:95], v[116:119], v[72:75]
    s_waitcnt vmcnt(12)
    buffer_load_dwordx4 v[112:115], v4, s[24:27], s85 offen sc1
    v_cvt_pk_bf16_f32 v36, v36, v37
    v_cvt_pk_bf16_f32 v37, v38, v39
    v_mfma_f32_16x16x32_bf16 v[24:27], a[96:99], v[120:123], v[24:27]
    s_waitcnt vmcnt(12)
    v_cvt_pk_bf16_f32 v38, v52, v53
    v_cvt_pk_bf16_f32 v39, v54, v55
    v_mfma_f32_16x16x32_bf16 v[24:27], a[112:115], v[124:127], v[24:27]
    v_cvt_pk_bf16_f32 v68, v68, v69
    v_cvt_pk_bf16_f32 v69, v70, v71
    v_mfma_f32_16x16x32_bf16 v[40:43], a[100:103], v[120:123], v[40:43]
    v_cvt_pk_bf16_f32 v70, v84, v85
    v_cvt_pk_bf16_f32 v71, v86, v87
    v_mfma_f32_16x16x32_bf16 v[40:43], a[116:119], v[124:127], v[40:43]
    buffer_load_dwordx4 v[116:119], v4, s[24:27], s86 offen sc1
    v_mfma_f32_16x16x32_bf16 v[56:59], a[104:107], v[120:123], v[56:59]
    buffer_store_dwordx4 v[36:39], v2, s[24:27], s81 offen offset:0 sc1
    v_mfma_f32_16x16x32_bf16 v[56:59], a[120:123], v[124:127], v[56:59]
    buffer_store_dwordx4 v[68:71], v2, s[24:27], s81 offen offset:1024 sc1
    v_mfma_f32_16x16x32_bf16 v[72:75], a[108:111], v[120:123], v[72:75]
    v_mfma_f32_16x16x32_bf16 v[72:75], a[124:127], v[124:127], v[72:75]
    s_waitcnt vmcnt(14)
    buffer_load_dwordx4 v[120:123], v4, s[24:27], s87 offen sc1
    v_mfma_f32_16x16x32_bf16 v[24:27], a[128:131], v[128:131], v[24:27]
    s_waitcnt vmcnt(14)
    v_mfma_f32_16x16x32_bf16 v[24:27], a[144:147], v[132:135], v[24:27]
    v_mfma_f32_16x16x32_bf16 v[40:43], a[132:135], v[128:131], v[40:43]
    v_mfma_f32_16x16x32_bf16 v[40:43], a[148:151], v[132:135], v[40:43]
    buffer_load_dwordx4 v[124:127], v4, s[24:27], s88 offen sc1
    v_mfma_f32_16x16x32_bf16 v[56:59], a[136:139], v[128:131], v[56:59]
    v_mfma_f32_16x16x32_bf16 v[56:59], a[152:155], v[132:135], v[56:59]
    v_mfma_f32_16x16x32_bf16 v[72:75], a[140:143], v[128:131], v[72:75]
    v_mfma_f32_16x16x32_bf16 v[72:75], a[156:159], v[132:135], v[72:75]
    s_waitcnt vmcnt(14)
    buffer_load_dwordx4 v[128:131], v4, s[24:27], s89 offen sc1
    v_mfma_f32_16x16x32_bf16 v[24:27], a[0:3], v[136:139], v[24:27]
    s_waitcnt vmcnt(14)
    v_mfma_f32_16x16x32_bf16 v[24:27], a[16:19], v[140:143], v[24:27]
    v_mfma_f32_16x16x32_bf16 v[40:43], a[4:7], v[136:139], v[40:43]
    v_mfma_f32_16x16x32_bf16 v[40:43], a[20:23], v[140:143], v[40:43]
    buffer_load_dwordx4 v[132:135], v4, s[24:27], s90 offen sc1
    v_mfma_f32_16x16x32_bf16 v[56:59], a[8:11], v[136:139], v[56:59]
    v_mfma_f32_16x16x32_bf16 v[56:59], a[24:27], v[140:143], v[56:59]
    v_mfma_f32_16x16x32_bf16 v[72:75], a[12:15], v[136:139], v[72:75]
    v_mfma_f32_16x16x32_bf16 v[72:75], a[28:31], v[140:143], v[72:75]
    s_waitcnt vmcnt(14)
    buffer_load_dwordx4 v[136:139], v4, s[24:27], s91 offen sc1
    v_mfma_f32_16x16x32_bf16 v[24:27], v[152:155], v[144:147], v[24:27]
    s_waitcnt vmcnt(14)
    v_mfma_f32_16x16x32_bf16 v[24:27], v[168:171], v[148:151], v[24:27]
    v_mfma_f32_16x16x32_bf16 v[40:43], v[156:159], v[144:147], v[40:43]
    v_mfma_f32_16x16x32_bf16 v[40:43], v[172:175], v[148:151], v[40:43]
    buffer_load_dwordx4 v[140:143], v4, s[24:27], s92 offen sc1
    v_mfma_f32_16x16x32_bf16 v[56:59], v[160:163], v[144:147], v[56:59]
    v_mfma_f32_16x16x32_bf16 v[56:59], v[176:179], v[148:151], v[56:59]
    v_mfma_f32_16x16x32_bf16 v[72:75], v[164:167], v[144:147], v[72:75]
    v_mfma_f32_16x16x32_bf16 v[72:75], v[180:183], v[148:151], v[72:75]
    s_waitcnt vmcnt(14)
    buffer_load_dwordx4 v[144:147], v4, s[24:27], s93 offen sc1
    v_mfma_f32_16x16x32_bf16 v[24:27], v[184:187], a[164:167], v[24:27]
    s_waitcnt vmcnt(14)
    v_mfma_f32_16x16x32_bf16 v[24:27], v[200:203], v[104:107], v[24:27]
    v_mfma_f32_16x16x32_bf16 v[40:43], v[188:191], a[164:167], v[40:43]
    v_mfma_f32_16x16x32_bf16 v[40:43], v[204:207], v[104:107], v[40:43]
    buffer_load_dwordx4 v[148:151], v4, s[24:27], s94 offen sc1
    v_mfma_f32_16x16x32_bf16 v[56:59], v[192:195], a[164:167], v[56:59]
    v_mfma_f32_16x16x32_bf16 v[56:59], v[208:211], v[104:107], v[56:59]
    v_mfma_f32_16x16x32_bf16 v[72:75], v[196:199], a[164:167], v[72:75]
    v_mfma_f32_16x16x32_bf16 v[72:75], v[212:215], v[104:107], v[72:75]
    s_waitcnt vmcnt(14)
    buffer_load_dwordx4 a[176:179], v4, s[24:27], s95 offen sc1
    v_mfma_f32_16x16x32_bf16 v[24:27], v[216:219], a[168:171], v[24:27]
    s_waitcnt vmcnt(14)
    v_mfma_f32_16x16x32_bf16 v[24:27], v[232:235], v[108:111], v[24:27]
    v_mfma_f32_16x16x32_bf16 v[40:43], v[220:223], a[168:171], v[40:43]
    v_mfma_f32_16x16x32_bf16 v[40:43], v[236:239], v[108:111], v[40:43]
    buffer_load_dwordx4 v[104:107], v4, s[24:27], s96 offen sc1
    v_mfma_f32_16x16x32_bf16 v[56:59], v[224:227], a[168:171], v[56:59]
    v_mfma_f32_16x16x32_bf16 v[56:59], v[248:251], v[108:111], v[56:59]
    v_mfma_f32_16x16x32_bf16 v[72:75], v[228:231], a[168:171], v[72:75]
    v_mfma_f32_16x16x32_bf16 v[72:75], v[252:255], v[108:111], v[72:75]
    s_waitcnt vmcnt(14)
    buffer_load_dwordx4 a[160:163], v4, s[24:27], s97 offen sc1
    v_mfma_f32_16x16x32_bf16 v[28:31], a[32:35], a[172:175], 0
    s_waitcnt vmcnt(14)
    v_mfma_f32_16x16x32_bf16 v[28:31], a[48:51], v[112:115], v[28:31]
    v_mfma_f32_16x16x32_bf16 v[44:47], a[36:39], a[172:175], 0
    v_mfma_f32_16x16x32_bf16 v[44:47], a[52:55], v[112:115], v[44:47]
    buffer_load_dwordx4 v[108:111], v4, s[24:27], s98 offen sc1
    v_mfma_f32_16x16x32_bf16 v[60:63], a[40:43], a[172:175], 0
    v_mfma_f32_16x16x32_bf16 v[60:63], a[56:59], v[112:115], v[60:63]
    v_mfma_f32_16x16x32_bf16 v[76:79], a[44:47], a[172:175], 0
    v_mfma_f32_16x16x32_bf16 v[76:79], a[60:63], v[112:115], v[76:79]
    s_waitcnt vmcnt(14)
    buffer_load_dwordx4 a[164:167], v4, s[24:27], s99 offen sc1
    v_mfma_f32_16x16x32_bf16 v[28:31], a[64:67], v[116:119], v[28:31]
    s_waitcnt vmcnt(12)
    v_mfma_f32_16x16x32_bf16 v[28:31], a[80:83], v[120:123], v[28:31]
    v_mfma_f32_16x16x32_bf16 v[44:47], a[68:71], v[116:119], v[44:47]
    v_mfma_f32_16x16x32_bf16 v[44:47], a[84:87], v[120:123], v[44:47]
    buffer_load_dwordx4 v[112:115], v5, s[24:27], s84 offen sc1
    v_mfma_f32_16x16x32_bf16 v[60:63], a[72:75], v[116:119], v[60:63]
    v_mfma_f32_16x16x32_bf16 v[60:63], a[88:91], v[120:123], v[60:63]
    v_mfma_f32_16x16x32_bf16 v[76:79], a[76:79], v[116:119], v[76:79]
    v_mfma_f32_16x16x32_bf16 v[76:79], a[92:95], v[120:123], v[76:79]
    s_waitcnt vmcnt(12)
    s_add_u32 s45, s66, 5
    v_mov_b32 v23, s66
    v_mov_b32 v22, s45
    s_mov_b64 exec, 1
    s_barrier
    buffer_store_dwordx2 v[22:23], v2, s[24:27], s41 offen sc1
    s_mov_b64 exec, -1
    v_mfma_f32_16x16x32_bf16 v[28:31], a[96:99], v[124:127], v[28:31]
    s_waitcnt vmcnt(12)
    buffer_load_dwordx4 v[116:119], v5, s[24:27], s85 offen sc1
    v_mfma_f32_16x16x32_bf16 v[28:31], a[112:115], v[128:131], v[28:31]
    ds_write_b128 v12, v[24:27] offset:0
    v_mfma_f32_16x16x32_bf16 v[44:47], a[100:103], v[124:127], v[44:47]
    ds_write_b128 v12, v[40:43] offset:4096
    v_mfma_f32_16x16x32_bf16 v[44:47], a[116:119], v[128:131], v[44:47]
    buffer_load_dwordx4 v[120:123], v5, s[24:27], s86 offen sc1
    v_mfma_f32_16x16x32_bf16 v[60:63], a[104:107], v[124:127], v[60:63]
    ds_write_b128 v12, v[56:59] offset:8192
    v_mfma_f32_16x16x32_bf16 v[60:63], a[120:123], v[128:131], v[60:63]
    ds_write_b128 v12, v[72:75] offset:12288
    v_mfma_f32_16x16x32_bf16 v[76:79], a[108:111], v[124:127], v[76:79]
    v_mfma_f32_16x16x32_bf16 v[76:79], a[124:127], v[128:131], v[76:79]
    s_waitcnt vmcnt(13)
    buffer_load_dwordx4 v[124:127], v5, s[24:27], s87 offen sc1
    v_mfma_f32_16x16x32_bf16 v[28:31], a[128:131], v[132:135], v[28:31]
    s_waitcnt vmcnt(13)
    v_mfma_f32_16x16x32_bf16 v[28:31], a[144:147], v[136:139], v[28:31]
    v_mfma_f32_16x16x32_bf16 v[44:47], a[132:135], v[132:135], v[44:47]
    v_mfma_f32_16x16x32_bf16 v[44:47], a[148:151], v[136:139], v[44:47]
    v_mfma_f32_16x16x32_bf16 v[60:63], a[136:139], v[132:135], v[60:63]
    buffer_load_dwordx4 v[128:131], v5, s[24:27], s88 offen sc1
    v_mfma_f32_16x16x32_bf16 v[60:63], a[152:155], v[136:139], v[60:63]
    v_mfma_f32_16x16x32_bf16 v[76:79], a[140:143], v[132:135], v[76:79]
    v_mfma_f32_16x16x32_bf16 v[76:79], a[156:159], v[136:139], v[76:79]
    s_waitcnt vmcnt(13)
    v_mfma_f32_16x16x32_bf16 v[28:31], a[0:3], v[140:143], v[28:31]
    s_waitcnt vmcnt(12)
    buffer_load_dwordx4 v[132:135], v5, s[24:27], s89 offen sc1
    v_mfma_f32_16x16x32_bf16 v[28:31], a[16:19], v[144:147], v[28:31]
    v_mfma_f32_16x16x32_bf16 v[44:47], a[4:7], v[140:143], v[44:47]
    v_mfma_f32_16x16x32_bf16 v[44:47], a[20:23], v[144:147], v[44:47]
    v_mfma_f32_16x16x32_bf16 v[60:63], a[8:11], v[140:143], v[60:63]
    buffer_load_dwordx4 v[136:139], v5, s[24:27], s90 offen sc1
    v_mfma_f32_16x16x32_bf16 v[60:63], a[24:27], v[144:147], v[60:63]
    v_mfma_f32_16x16x32_bf16 v[76:79], a[12:15], v[140:143], v[76:79]
    v_mfma_f32_16x16x32_bf16 v[76:79], a[28:31], v[144:147], v[76:79]
    s_waitcnt vmcnt(13)
    v_mfma_f32_16x16x32_bf16 v[28:31], v[152:155], v[148:151], v[28:31]
    s_waitcnt vmcnt(12)
    buffer_load_dwordx4 v[140:143], v5, s[24:27], s91 offen sc1
    v_mfma_f32_16x16x32_bf16 v[28:31], v[168:171], a[176:179], v[28:31]
    v_mfma_f32_16x16x32_bf16 v[44:47], v[156:159], v[148:151], v[44:47]
    v_mfma_f32_16x16x32_bf16 v[44:47], v[172:175], a[176:179], v[44:47]
    v_mfma_f32_16x16x32_bf16 v[60:63], v[160:163], v[148:151], v[60:63]
    buffer_load_dwordx4 v[144:147], v5, s[24:27], s92 offen sc1
    v_mfma_f32_16x16x32_bf16 v[60:63], v[176:179], a[176:179], v[60:63]
    v_mfma_f32_16x16x32_bf16 v[76:79], v[164:167], v[148:151], v[76:79]
    v_mfma_f32_16x16x32_bf16 v[76:79], v[180:183], a[176:179], v[76:79]
    s_waitcnt vmcnt(13)
    v_mfma_f32_16x16x32_bf16 v[28:31], v[184:187], v[104:107], v[28:31]
    s_waitcnt vmcnt(12)
    buffer_load_dwordx4 v[148:151], v5, s[24:27], s93 offen sc1
    v_mfma_f32_16x16x32_bf16 v[28:31], v[200:203], a[160:163], v[28:31]
    v_mfma_f32_16x16x32_bf16 v[44:47], v[188:191], v[104:107], v[44:47]
    v_mfma_f32_16x16x32_bf16 v[44:47], v[204:207], a[160:163], v[44:47]
    v_mfma_f32_16x16x32_bf16 v[60:63], v[192:195], v[104:107], v[60:63]
    buffer_load_dwordx4 a[168:171], v5, s[24:27], s94 offen sc1
    v_mfma_f32_16x16x32_bf16 v[60:63], v[208:211], a[160:163], v[60:63]
    v_mfma_f32_16x16x32_bf16 v[76:79], v[196:199], v[104:107], v[76:79]
    v_mfma_f32_16x16x32_bf16 v[76:79], v[212:215], a[160:163], v[76:79]
    s_waitcnt vmcnt(13)
    v_mfma_f32_16x16x32_bf16 v[28:31], v[216:219], v[108:111], v[28:31]
    s_waitcnt vmcnt(12)
    buffer_load_dwordx4 v[104:107], v5, s[24:27], s95 offen sc1
    v_mfma_f32_16x16x32_bf16 v[28:31], v[232:235], a[164:167], v[28:31]
    v_mfma_f32_16x16x32_bf16 v[44:47], v[220:223], v[108:111], v[44:47]
    v_mfma_f32_16x16x32_bf16 v[44:47], v[236:239], a[164:167], v[44:47]
    v_mfma_f32_16x16x32_bf16 v[60:63], v[224:227], v[108:111], v[60:63]
    buffer_load_dwordx4 a[172:175], v5, s[24:27], s96 offen sc1
    v_mfma_f32_16x16x32_bf16 v[60:63], v[248:251], a[164:167], v[60:63]
    v_mfma_f32_16x16x32_bf16 v[76:79], v[228:231], v[108:111], v[76:79]
    v_mfma_f32_16x16x32_bf16 v[76:79], v[252:255], a[164:167], v[76:79]
    s_waitcnt vmcnt(13)
    v_mfma_f32_16x16x32_bf16 v[32:35], a[32:35], v[112:115], 0
    s_waitcnt vmcnt(11)
    buffer_load_dwordx4 v[108:111], v5, s[24:27], s97 offen sc1
    v_mfma_f32_16x16x32_bf16 v[32:35], a[48:51], v[116:119], v[32:35]
    ds_write_b128 v13, v[28:31] offset:16384
    v_mfma_f32_16x16x32_bf16 v[48:51], a[36:39], v[112:115], 0
    v_mfma_f32_16x16x32_bf16 v[48:51], a[52:55], v[116:119], v[48:51]
    ds_write_b128 v13, v[44:47] offset:20480
    v_mfma_f32_16x16x32_bf16 v[64:67], a[40:43], v[112:115], 0
    buffer_load_dwordx4 a[176:179], v5, s[24:27], s98 offen sc1
    v_mfma_f32_16x16x32_bf16 v[64:67], a[56:59], v[116:119], v[64:67]
    ds_write_b128 v13, v[60:63] offset:24576
    v_mfma_f32_16x16x32_bf16 v[80:83], a[44:47], v[112:115], 0
    v_mfma_f32_16x16x32_bf16 v[80:83], a[60:63], v[116:119], v[80:83]
    s_waitcnt vmcnt(12)
    ds_write_b128 v13, v[76:79] offset:28672
    v_mfma_f32_16x16x32_bf16 v[32:35], a[64:67], v[120:123], v[32:35]
    s_waitcnt vmcnt(11)
    buffer_load_dwordx4 a[160:163], v5, s[24:27], s99 offen sc1
    v_mfma_f32_16x16x32_bf16 v[32:35], a[80:83], v[124:127], v[32:35]
    v_mfma_f32_16x16x32_bf16 v[48:51], a[68:71], v[120:123], v[48:51]
    v_mfma_f32_16x16x32_bf16 v[48:51], a[84:87], v[124:127], v[48:51]
    v_mfma_f32_16x16x32_bf16 v[64:67], a[72:75], v[120:123], v[64:67]
    buffer_load_dwordx4 a[164:167], v6, s[24:27], s84 offen sc1
    v_mfma_f32_16x16x32_bf16 v[64:67], a[88:91], v[124:127], v[64:67]
    v_mfma_f32_16x16x32_bf16 v[80:83], a[76:79], v[120:123], v[80:83]
    v_mfma_f32_16x16x32_bf16 v[80:83], a[92:95], v[124:127], v[80:83]
    s_waitcnt vmcnt(12)
    v_mfma_f32_16x16x32_bf16 v[32:35], a[96:99], v[128:131], v[32:35]
    s_waitcnt vmcnt(11)
    ds_read_b128 v[112:115], v7 offset:0
    v_mfma_f32_16x16x32_bf16 v[32:35], a[112:115], v[132:135], v[32:35]
    ds_read_b128 v[116:119], v7 offset:64
    v_mfma_f32_16x16x32_bf16 v[48:51], a[100:103], v[128:131], v[48:51]
    ds_read_b128 v[120:123], v7 offset:128
    v_mfma_f32_16x16x32_bf16 v[48:51], a[116:119], v[132:135], v[48:51]
    ds_read_b128 v[124:127], v7 offset:192
    v_mfma_f32_16x16x32_bf16 v[64:67], a[104:107], v[128:131], v[64:67]
    v_mfma_f32_16x16x32_bf16 v[64:67], a[120:123], v[132:135], v[64:67]
    v_mfma_f32_16x16x32_bf16 v[80:83], a[108:111], v[128:131], v[80:83]
    v_mfma_f32_16x16x32_bf16 v[80:83], a[124:127], v[132:135], v[80:83]
    s_waitcnt vmcnt(10)
    buffer_load_dwordx4 v[128:131], v6, s[24:27], s85 offen sc1
    v_mfma_f32_16x16x32_bf16 v[32:35], a[128:131], v[136:139], v[32:35]
    s_waitcnt vmcnt(10)
    buffer_load_dwordx4 v[132:135], v6, s[24:27], s86 offen sc1
    v_mfma_f32_16x16x32_bf16 v[32:35], a[144:147], v[140:143], v[32:35]
    v_mfma_f32_16x16x32_bf16 v[48:51], a[132:135], v[136:139], v[48:51]
    v_mfma_f32_16x16x32_bf16 v[48:51], a[148:151], v[140:143], v[48:51]
    v_mfma_f32_16x16x32_bf16 v[64:67], a[136:139], v[136:139], v[64:67]
    v_mfma_f32_16x16x32_bf16 v[64:67], a[152:155], v[140:143], v[64:67]
    v_mfma_f32_16x16x32_bf16 v[80:83], a[140:143], v[136:139], v[80:83]
    v_mfma_f32_16x16x32_bf16 v[80:83], a[156:159], v[140:143], v[80:83]
    s_waitcnt vmcnt(10)
    buffer_load_dwordx4 v[136:139], v6, s[24:27], s87 offen sc1
    v_mfma_f32_16x16x32_bf16 v[32:35], a[0:3], v[144:147], v[32:35]
    s_waitcnt vmcnt(10)
    buffer_load_dwordx4 v[140:143], v6, s[24:27], s88 offen sc1
    v_mfma_f32_16x16x32_bf16 v[32:35], a[16:19], v[148:151], v[32:35]
    v_mfma_f32_16x16x32_bf16 v[48:51], a[4:7], v[144:147], v[48:51]
    v_mfma_f32_16x16x32_bf16 v[48:51], a[20:23], v[148:151], v[48:51]
    v_mfma_f32_16x16x32_bf16 v[64:67], a[8:11], v[144:147], v[64:67]
    v_mfma_f32_16x16x32_bf16 v[64:67], a[24:27], v[148:151], v[64:67]
    v_mfma_f32_16x16x32_bf16 v[80:83], a[12:15], v[144:147], v[80:83]
    v_mfma_f32_16x16x32_bf16 v[80:83], a[28:31], v[148:151], v[80:83]
    s_waitcnt vmcnt(10)
    buffer_load_dwordx4 v[144:147], v6, s[24:27], s89 offen sc1
    v_mfma_f32_16x16x32_bf16 v[32:35], v[152:155], a[168:171], v[32:35]
    s_waitcnt vmcnt(10)
    buffer_load_dwordx4 v[148:151], v6, s[24:27], s90 offen sc1
    v_mfma_f32_16x16x32_bf16 v[32:35], v[168:171], v[104:107], v[32:35]
    v_mfma_f32_16x16x32_bf16 v[48:51], v[156:159], a[168:171], v[48:51]
    v_mfma_f32_16x16x32_bf16 v[48:51], v[172:175], v[104:107], v[48:51]
    v_mfma_f32_16x16x32_bf16 v[64:67], v[160:163], a[168:171], v[64:67]
    v_mfma_f32_16x16x32_bf16 v[64:67], v[176:179], v[104:107], v[64:67]
    v_mfma_f32_16x16x32_bf16 v[80:83], v[164:167], a[168:171], v[80:83]
    v_mfma_f32_16x16x32_bf16 v[80:83], v[180:183], v[104:107], v[80:83]
    s_waitcnt vmcnt(10)
    buffer_load_dwordx4 a[168:171], v6, s[24:27], s91 offen sc1
    v_mfma_f32_16x16x32_bf16 v[32:35], v[184:187], a[172:175], v[32:35]
    s_waitcnt vmcnt(10)
    buffer_load_dwordx4 v[104:107], v6, s[24:27], s92 offen sc1
    v_mfma_f32_16x16x32_bf16 v[32:35], v[200:203], v[108:111], v[32:35]
    v_mfma_f32_16x16x32_bf16 v[48:51], v[188:191], a[172:175], v[48:51]
    v_mfma_f32_16x16x32_bf16 v[48:51], v[204:207], v[108:111], v[48:51]
    v_mfma_f32_16x16x32_bf16 v[64:67], v[192:195], a[172:175], v[64:67]
    v_mfma_f32_16x16x32_bf16 v[64:67], v[208:211], v[108:111], v[64:67]
    v_mfma_f32_16x16x32_bf16 v[80:83], v[196:199], a[172:175], v[80:83]
    v_mfma_f32_16x16x32_bf16 v[80:83], v[212:215], v[108:111], v[80:83]
    s_waitcnt vmcnt(10)
    buffer_load_dwordx4 a[172:175], v6, s[24:27], s93 offen sc1
    v_mfma_f32_16x16x32_bf16 v[32:35], v[216:219], a[176:179], v[32:35]
    s_waitcnt vmcnt(10)
    buffer_load_dwordx2 v[22:23], v10, s[24:27], 0 offen sc1
    v_mfma_f32_16x16x32_bf16 v[32:35], v[232:235], a[160:163], v[32:35]
    buffer_load_dwordx4 v[108:111], v6, s[24:27], s94 offen sc1
    v_mfma_f32_16x16x32_bf16 v[48:51], v[220:223], a[176:179], v[48:51]
    v_mfma_f32_16x16x32_bf16 v[48:51], v[236:239], a[160:163], v[48:51]
    v_mfma_f32_16x16x32_bf16 v[64:67], v[224:227], a[176:179], v[64:67]
    v_mfma_f32_16x16x32_bf16 v[64:67], v[248:251], a[160:163], v[64:67]
    v_mfma_f32_16x16x32_bf16 v[80:83], v[228:231], a[176:179], v[80:83]
    v_mfma_f32_16x16x32_bf16 v[80:83], v[252:255], a[160:163], v[80:83]
    s_waitcnt vmcnt(11)
    buffer_load_dwordx4 a[176:179], v6, s[24:27], s95 offen sc1
    v_mfma_f32_16x16x32_bf16 v[36:39], a[32:35], a[164:167], 0
    s_waitcnt vmcnt(11)
    buffer_load_dwordx4 a[160:163], v6, s[24:27], s96 offen sc1
    v_mfma_f32_16x16x32_bf16 v[36:39], a[48:51], v[128:131], v[36:39]
    ds_write_b128 v14, v[32:35] offset:32768
    v_mfma_f32_16x16x32_bf16 v[52:55], a[36:39], a[164:167], 0
    v_mfma_f32_16x16x32_bf16 v[52:55], a[52:55], v[128:131], v[52:55]
    ds_write_b128 v14, v[48:51] offset:36864
    v_mfma_f32_16x16x32_bf16 v[68:71], a[40:43], a[164:167], 0
    v_mfma_f32_16x16x32_bf16 v[68:71], a[56:59], v[128:131], v[68:71]
    ds_write_b128 v14, v[64:67] offset:40960
    v_mfma_f32_16x16x32_bf16 v[84:87], a[44:47], a[164:167], 0
    v_mfma_f32_16x16x32_bf16 v[84:87], a[60:63], v[128:131], v[84:87]
    s_waitcnt vmcnt(11)
    buffer_load_dwordx4 a[164:167], v6, s[24:27], s97 offen sc1
    v_mfma_f32_16x16x32_bf16 v[36:39], a[64:67], v[132:135], v[36:39]
    s_waitcnt vmcnt(11)
    buffer_load_dwordx4 v[128:131], v6, s[24:27], s98 offen sc1
    v_mfma_f32_16x16x32_bf16 v[36:39], a[80:83], v[136:139], v[36:39]
    ds_write_b128 v14, v[80:83] offset:45056
    v_mfma_f32_16x16x32_bf16 v[52:55], a[68:71], v[132:135], v[52:55]
    v_mfma_f32_16x16x32_bf16 v[52:55], a[84:87], v[136:139], v[52:55]
    v_mfma_f32_16x16x32_bf16 v[68:71], a[72:75], v[132:135], v[68:71]
    v_mfma_f32_16x16x32_bf16 v[68:71], a[88:91], v[136:139], v[68:71]
    s_waitcnt lgkmcnt(0)
    s_barrier
    v_mfma_f32_16x16x32_bf16 v[84:87], a[76:79], v[132:135], v[84:87]
    ds_read_b128 v[24:27], v15 offset:0
    v_mfma_f32_16x16x32_bf16 v[84:87], a[92:95], v[136:139], v[84:87]
    s_waitcnt vmcnt(11)
    buffer_load_dwordx4 v[132:135], v6, s[24:27], s99 offen sc1
    s_add_u32 s13, s13, 4096
    v_mfma_f32_16x16x32_bf16 v[36:39], a[96:99], v[140:143], v[36:39]
    s_waitcnt vmcnt(11)
    buffer_load_dwordx4 a[244:247], v2, s[24:27], s13 offen offset:0 sc1
    v_mfma_f32_16x16x32_bf16 v[36:39], a[112:115], v[144:147], v[36:39]
    ds_read_b128 v[28:31], v15 offset:16384
    v_mfma_f32_16x16x32_bf16 v[52:55], a[100:103], v[140:143], v[52:55]
    s_waitcnt vmcnt(7)
    v_subrev_u32 v22, s45, v22
    v_lshrrev_b32 v22, 3, v22
    v_bitop3_b32 v22, v23, s66, v22 bitop3:0xbe
    v_cmp_ne_u32 vcc, 0, v22
    s_cbranch_vccnz L_px_wait
L_px_ok:
    v_mfma_f32_16x16x32_bf16 v[52:55], a[116:119], v[144:147], v[52:55]
    buffer_load_dwordx4 v[240:243], v2, s[24:27], s82 offen offset:0 sc1
    v_mfma_f32_16x16x32_bf16 v[68:71], a[104:107], v[140:143], v[68:71]
    buffer_load_dwordx4 v[244:247], v2, s[24:27], s82 offen offset:1024 sc1
    v_mfma_f32_16x16x32_bf16 v[68:71], a[120:123], v[144:147], v[68:71]
    buffer_load_dwordx4 a[248:251], v2, s[24:27], s13 offen offset:1024 sc1
    v_mfma_f32_16x16x32_bf16 v[84:87], a[108:111], v[140:143], v[84:87]
    ds_read_b128 v[32:35], v15 offset:32768
    v_mfma_f32_16x16x32_bf16 v[84:87], a[124:127], v[144:147], v[84:87]
    ds_read_b128 v[40:43], v15 offset:4096
    v_mfma_f32_16x16x32_bf16 v[36:39], a[128:131], v[148:151], v[36:39]
    ds_read_b128 v[44:47], v15 offset:20480
    v_mfma_f32_16x16x32_bf16 v[36:39], a[144:147], a[168:171], v[36:39]
    ds_read_b128 v[48:51], v15 offset:36864
    v_mfma_f32_16x16x32_bf16 v[52:55], a[132:135], v[148:151], v[52:55]
    buffer_load_dwordx4 a[252:255], v2, s[24:27], s13 offen offset:2048 sc1
    v_mfma_f32_16x16x32_bf16 v[52:55], a[148:151], a[168:171], v[52:55]
    ds_read_b128 v[56:59], v15 offset:8192
    v_mfma_f32_16x16x32_bf16 v[68:71], a[136:139], v[148:151], v[68:71]
    ds_read_b128 v[60:63], v15 offset:24576
    v_mfma_f32_16x16x32_bf16 v[68:71], a[152:155], a[168:171], v[68:71]
    ds_read_b128 v[64:67], v15 offset:40960
    v_mfma_f32_16x16x32_bf16 v[84:87], a[140:143], v[148:151], v[84:87]
    ds_read_b128 v[72:75], v15 offset:12288
    v_mfma_f32_16x16x32_bf16 v[84:87], a[156:159], a[168:171], v[84:87]
    buffer_load_dwordx4 a[32:35], v2, s[24:27], s13 offen offset:3072 sc1
    v_mfma_f32_16x16x32_bf16 v[36:39], a[0:3], v[104:107], v[36:39]
    ds_read_b128 v[76:79], v15 offset:28672
    v_mfma_f32_16x16x32_bf16 v[36:39], a[16:19], a[172:175], v[36:39]
    ds_read_b128 v[80:83], v15 offset:45056
    v_mfma_f32_16x16x32_bf16 v[52:55], a[4:7], v[104:107], v[52:55]
    s_waitcnt lgkmcnt(9)
    v_add_f32 v32, v32, v24
    v_add_f32 v33, v33, v25
    v_mfma_f32_16x16x32_bf16 v[52:55], a[20:23], a[172:175], v[52:55]
    s_add_u32 s14, s14, 4096
    v_mfma_f32_16x16x32_bf16 v[68:71], a[8:11], v[104:107], v[68:71]
    buffer_load_dwordx4 a[48:51], v2, s[24:27], s14 offen offset:0 sc1
    v_mfma_f32_16x16x32_bf16 v[68:71], a[24:27], a[172:175], v[68:71]
    v_add_f32 v34, v34, v26
    v_add_f32 v35, v35, v27
    v_mfma_f32_16x16x32_bf16 v[84:87], a[12:15], v[104:107], v[84:87]
    v_add_f32 v32, v32, v28
    v_add_f32 v33, v33, v29
    v_mfma_f32_16x16x32_bf16 v[84:87], a[28:31], a[172:175], v[84:87]
    s_waitcnt vmcnt(12)
    v_add_f32 v34, v34, v30
    v_add_f32 v35, v35, v31
    v_mfma_f32_16x16x32_bf16 v[36:39], v[152:155], v[108:111], v[36:39]
    s_waitcnt vmcnt(11)
    v_mfma_f32_16x16x32_bf16 v[36:39], v[168:171], a[176:179], v[36:39]
    buffer_load_dwordx4 a[36:39], v2, s[24:27], s14 offen offset:1024 sc1
    v_mfma_f32_16x16x32_bf16 v[52:55], v[156:159], v[108:111], v[52:55]
    v_fmac_f32 v88, v112, v32
    v_fmac_f32 v89, v113, v33
    v_mfma_f32_16x16x32_bf16 v[52:55], v[172:175], a[176:179], v[52:55]
    v_fmac_f32 v90, v114, v34
    v_fmac_f32 v91, v115, v35
    v_mfma_f32_16x16x32_bf16 v[68:71], v[160:163], v[108:111], v[68:71]
    s_waitcnt lgkmcnt(6)
    v_add_f32 v48, v48, v40
    v_add_f32 v49, v49, v41
    v_mfma_f32_16x16x32_bf16 v[68:71], v[176:179], a[176:179], v[68:71]
    v_mfma_f32_16x16x32_bf16 v[84:87], v[164:167], v[108:111], v[84:87]
    buffer_load_dwordx4 a[52:55], v2, s[24:27], s14 offen offset:2048 sc1
    v_mfma_f32_16x16x32_bf16 v[84:87], v[180:183], a[176:179], v[84:87]
    s_waitcnt vmcnt(12)
    v_add_f32 v50, v50, v42
    v_add_f32 v51, v51, v43
    v_mfma_f32_16x16x32_bf16 v[36:39], v[184:187], a[160:163], v[36:39]
    s_waitcnt vmcnt(11)
    v_add_f32 v48, v48, v44
    v_add_f32 v49, v49, v45
    v_mfma_f32_16x16x32_bf16 v[36:39], v[200:203], a[164:167], v[36:39]
    v_add_f32 v50, v50, v46
    v_add_f32 v51, v51, v47
    v_mfma_f32_16x16x32_bf16 v[52:55], v[188:191], a[160:163], v[52:55]
    v_mfma_f32_16x16x32_bf16 v[52:55], v[204:207], a[164:167], v[52:55]
    buffer_load_dwordx4 a[40:43], v2, s[24:27], s14 offen offset:3072 sc1
    v_mfma_f32_16x16x32_bf16 v[68:71], v[192:195], a[160:163], v[68:71]
    v_fmac_f32 v92, v116, v48
    v_fmac_f32 v93, v117, v49
    v_mfma_f32_16x16x32_bf16 v[68:71], v[208:211], a[164:167], v[68:71]
    v_fmac_f32 v94, v118, v50
    v_fmac_f32 v95, v119, v51
    v_mfma_f32_16x16x32_bf16 v[84:87], v[196:199], a[160:163], v[84:87]
    s_waitcnt lgkmcnt(3)
    v_add_f32 v64, v64, v56
    v_add_f32 v65, v65, v57
    v_mfma_f32_16x16x32_bf16 v[84:87], v[212:215], a[164:167], v[84:87]
    s_waitcnt vmcnt(11)
    s_add_u32 s12, s12, 4096
    v_mfma_f32_16x16x32_bf16 v[36:39], v[216:219], v[128:131], v[36:39]
    s_waitcnt vmcnt(10)
    buffer_load_dwordx4 a[56:59], v2, s[24:27], s12 offen offset:0 sc1
    v_mfma_f32_16x16x32_bf16 v[36:39], v[232:235], v[132:135], v[36:39]
    v_add_f32 v66, v66, v58
    v_add_f32 v67, v67, v59
    v_mfma_f32_16x16x32_bf16 v[52:55], v[220:223], v[128:131], v[52:55]
    v_add_f32 v64, v64, v60
    v_add_f32 v65, v65, v61
    v_mfma_f32_16x16x32_bf16 v[52:55], v[236:239], v[132:135], v[52:55]
    v_add_f32 v66, v66, v62
    v_add_f32 v67, v67, v63
    v_mfma_f32_16x16x32_bf16 v[68:71], v[224:227], v[128:131], v[68:71]
    v_mfma_f32_16x16x32_bf16 v[68:71], v[248:251], v[132:135], v[68:71]
    buffer_load_dwordx4 a[44:47], v2, s[24:27], s12 offen offset:1024 sc1
    v_mfma_f32_16x16x32_bf16 v[84:87], v[228:231], v[128:131], v[84:87]
    v_fmac_f32 v96, v120, v64
    v_fmac_f32 v97, v121, v65
    v_mfma_f32_16x16x32_bf16 v[84:87], v[252:255], v[132:135], v[84:87]
    ds_read_b128 v[128:131], v7 offset:256
    ds_read_b128 v[132:135], v7 offset:320
    ds_read_b128 v[136:139], v7 offset:384
    ds_read_b128 v[140:143], v7 offset:448
    buffer_load_dwordx4 a[60:63], v2, s[24:27], s12 offen offset:2048 sc1
    buffer_load_dwordx4 a[64:67], v2, s[24:27], s12 offen offset:3072 sc1
    s_add_u32 s13, s13, 4096
    buffer_load_dwordx4 a[80:83], v2, s[24:27], s13 offen offset:0 sc1
    v_pk_fma_f32 v[98:99], v[122:123], v[66:67], v[98:99]
    s_waitcnt lgkmcnt(4)
    v_pk_add_f32 v[80:81], v[80:81], v[72:73]
    v_pk_add_f32 v[82:83], v[82:83], v[74:75]
    v_pk_add_f32 v[80:81], v[80:81], v[76:77]
    v_pk_add_f32 v[82:83], v[82:83], v[78:79]
    v_pk_fma_f32 v[100:101], v[124:125], v[80:81], v[100:101]
    v_pk_fma_f32 v[102:103], v[126:127], v[82:83], v[102:103]
    s_waitcnt vmcnt(13)
    v_lshlrev_b32 v22, 16, v240
    v_and_b32 v23, 0xffff0000, v240
    v_pk_fma_f32 v[88:89], v[112:113], v[22:23], v[88:89]
    v_lshlrev_b32 v22, 16, v241
    v_and_b32 v23, 0xffff0000, v241
    v_pk_fma_f32 v[90:91], v[114:115], v[22:23], v[90:91]
    v_lshlrev_b32 v22, 16, v242
    v_and_b32 v23, 0xffff0000, v242
    v_pk_fma_f32 v[92:93], v[116:117], v[22:23], v[92:93]
    v_lshlrev_b32 v22, 16, v243
    v_and_b32 v23, 0xffff0000, v243
    v_pk_fma_f32 v[94:95], v[118:119], v[22:23], v[94:95]
    s_waitcnt vmcnt(12)
    v_lshlrev_b32 v22, 16, v244
    v_and_b32 v23, 0xffff0000, v244
    v_pk_fma_f32 v[96:97], v[120:121], v[22:23], v[96:97]
    v_lshlrev_b32 v22, 16, v245
    v_and_b32 v23, 0xffff0000, v245
    v_pk_fma_f32 v[98:99], v[122:123], v[22:23], v[98:99]
    v_lshlrev_b32 v22, 16, v246
    v_and_b32 v23, 0xffff0000, v246
    v_pk_fma_f32 v[100:101], v[124:125], v[22:23], v[100:101]
    v_lshlrev_b32 v22, 16, v247
    v_and_b32 v23, 0xffff0000, v247
    v_pk_fma_f32 v[102:103], v[126:127], v[22:23], v[102:103]
    v_pk_fma_f32 v[88:89], v[112:113], v[36:37], v[88:89]
    v_pk_fma_f32 v[90:91], v[114:115], v[38:39], v[90:91]
    v_pk_fma_f32 v[92:93], v[116:117], v[52:53], v[92:93]
    v_pk_fma_f32 v[94:95], v[118:119], v[54:55], v[94:95]
    s_waitcnt lgkmcnt(2)
    v_pk_mul_f32 v[128:129], v[128:129], v[88:89]
    v_pk_mul_f32 v[130:131], v[130:131], v[90:91]
    v_pk_mul_f32 v[132:133], v[132:133], v[92:93]
    v_pk_mul_f32 v[134:135], v[134:135], v[94:95]
    v_cvt_pk_bf16_f32 v24, v128, v129
    v_cvt_pk_bf16_f32 v25, v130, v131
    v_cvt_pk_bf16_f32 v26, v132, v133
    v_cvt_pk_bf16_f32 v27, v134, v135
    buffer_store_dwordx4 v[24:27], v2, s[24:27], s19 offen offset:0 sc1
    v_pk_fma_f32 v[96:97], v[120:121], v[68:69], v[96:97]
    v_pk_fma_f32 v[98:99], v[122:123], v[70:71], v[98:99]
    v_pk_fma_f32 v[100:101], v[124:125], v[84:85], v[100:101]
    v_pk_fma_f32 v[102:103], v[126:127], v[86:87], v[102:103]
    s_waitcnt lgkmcnt(0)
    v_pk_mul_f32 v[136:137], v[136:137], v[96:97]
    v_pk_mul_f32 v[138:139], v[138:139], v[98:99]
    v_pk_mul_f32 v[140:141], v[140:141], v[100:101]
    v_pk_mul_f32 v[142:143], v[142:143], v[102:103]
    v_cvt_pk_bf16_f32 v28, v136, v137
    v_cvt_pk_bf16_f32 v29, v138, v139
    v_cvt_pk_bf16_f32 v30, v140, v141
    v_cvt_pk_bf16_f32 v31, v142, v143
    buffer_store_dwordx4 v[28:31], v2, s[24:27], s19 offen offset:1024 sc1
    v_pk_add_f32 v[148:149], v[88:89], v[90:91]
    v_pk_mul_f32 v[150:151], v[88:89], v[88:89]
    v_pk_fma_f32 v[150:151], v[90:91], v[90:91], v[150:151]
    v_pk_add_f32 v[148:149], v[148:149], v[92:93]
    v_pk_fma_f32 v[150:151], v[92:93], v[92:93], v[150:151]
    v_pk_add_f32 v[148:149], v[148:149], v[94:95]
    v_pk_fma_f32 v[150:151], v[94:95], v[94:95], v[150:151]
    v_pk_add_f32 v[148:149], v[148:149], v[96:97]
    v_pk_fma_f32 v[150:151], v[96:97], v[96:97], v[150:151]
    v_pk_add_f32 v[148:149], v[148:149], v[98:99]
    v_pk_fma_f32 v[150:151], v[98:99], v[98:99], v[150:151]
    v_pk_add_f32 v[148:149], v[148:149], v[100:101]
    v_pk_fma_f32 v[150:151], v[100:101], v[100:101], v[150:151]
    v_pk_add_f32 v[148:149], v[148:149], v[102:103]
    v_pk_fma_f32 v[150:151], v[102:103], v[102:103], v[150:151]
    v_add_f32 v144, v148, v149
    v_add_f32 v145, v150, v151
    s_nop 1
    v_permlane32_swap_b32 v144, v145
    v_add_f32 v144, v144, v145
    v_mov_b32 v145, v144
    s_nop 1
    v_permlane16_swap_b32 v144, v145
    v_add_f32 v144, v144, v145
    buffer_store_dword v144, v17, s[24:27], s21 offen sc1
    ds_read_b64 v[104:105], v18 offset:0
    ds_read_b64 v[106:107], v18 offset:32
    ds_read_b64 v[108:109], v18 offset:64
    ds_read_b64 v[228:229], v18 offset:1024
    ds_read_b64 v[230:231], v18 offset:1056
    ds_read_b64 v[232:233], v18 offset:1088
    ds_read_b64 v[234:235], v18 offset:1120
    ds_read_b128 v[152:155], v19 offset:0
    ds_read_b128 v[156:159], v19 offset:64
    ds_read_b128 v[160:163], v19 offset:128
    ds_read_b128 v[164:167], v19 offset:192
    ds_read_b128 v[168:171], v19 offset:256
    ds_read_b128 v[172:175], v19 offset:320
    ds_read_b128 v[176:179], v19 offset:384
    ds_read_b128 v[180:183], v19 offset:448
    ds_read_b128 v[184:187], v19 offset:512
    ds_read_b128 v[188:191], v19 offset:576
    ds_read_b128 v[192:195], v19 offset:640
    ds_read_b128 v[196:199], v19 offset:704
    ds_read_b128 v[200:203], v19 offset:768
    ds_read_b128 v[204:207], v19 offset:832
    ds_read_b128 v[208:211], v19 offset:896
    ds_read_b128 v[212:215], v19 offset:960
    ds_read_b128 v[236:239], v7 offset:512
    ds_read_b128 v[240:243], v7 offset:576
    ds_read_b128 v[244:247], v7 offset:640
    ds_read_b128 v[248:251], v7 offset:704
    buffer_load_dwordx4 a[68:71], v2, s[24:27], s13 offen offset:1024 sc1
    buffer_load_dwordx4 a[84:87], v2, s[24:27], s13 offen offset:2048 sc1
    buffer_load_dwordx4 a[72:75], v2, s[24:27], s13 offen offset:3072 sc1
    s_add_u32 s14, s14, 4096
    buffer_load_dwordx4 a[88:91], v2, s[24:27], s14 offen offset:0 sc1
    buffer_load_dwordx4 a[76:79], v2, s[24:27], s14 offen offset:1024 sc1
    v_bfe_u32 v136, v1, 4, 1
    v_lshl_add_u32 v17, v136, 9, v17
    v_add_u32 v9, 49152, v2
    v_and_b32 v19, 15, v1
    v_lshlrev_b32 v19, 3, v19
    v_add_u32 v19, 124928, v19
    v_lshl_add_u32 v147, s3, 7, v19
    s_mul_i32 s53, s62, 176128
    s_add_u32 s53, s53, 0xf00000
    v_add_u32 v16, s53, v2
    s_and_b32 s55, s61, 1
    s_lshl_b32 s55, s55, 11
    v_add_u32 v0, s55, v0
    v_xor_b32 v10, 2048, v0
    v_mov_b32 v111, 0xc0135761
    v_mov_b32 v110, 0xbdd2d3e8
    s_mov_b32 m0, s23
    s_waitcnt lgkmcnt(15)
    v_lshlrev_b32 v124, 16, v104
    v_and_b32 v125, 0xffff0000, v104
    v_lshlrev_b32 v126, 16, v105
    v_and_b32 v127, 0xffff0000, v105
    v_lshlrev_b32 v128, 16, v106
    v_and_b32 v129, 0xffff0000, v106
    v_lshlrev_b32 v130, 16, v107
    v_and_b32 v131, 0xffff0000, v107
    v_lshlrev_b32 v132, 16, v108
    v_and_b32 v133, 0xffff0000, v108
    v_lshlrev_b32 v134, 16, v109
    v_and_b32 v135, 0xffff0000, v109
    v_mov_b32 v104, 1.0
    s_add_u32 s45, s66, 6
    v_mov_b32 v23, s66
    v_mov_b32 v22, s45
    s_mov_b64 exec, 1
    s_waitcnt vmcnt(5)
    s_barrier
    buffer_store_dwordx2 v[22:23], v2, s[24:27], s41 offen sc1
    s_mov_b64 exec, -1
    buffer_load_dwordx4 a[92:95], v2, s[24:27], s14 offen offset:2048 sc1
    v_mfma_f32_16x16x32_bf16 v[216:219], a[180:183], v[152:155], 0
    v_mfma_f32_16x16x32_bf16 v[216:219], a[184:187], v[156:159], v[216:219]
    v_mfma_f32_16x16x32_bf16 v[216:219], a[188:191], v[160:163], v[216:219]
    v_mfma_f32_16x16x32_bf16 v[216:219], a[192:195], v[164:167], v[216:219]
    v_mfma_f32_16x16x32_bf16 v[220:223], a[196:199], v[152:155], 0
    v_mfma_f32_16x16x32_bf16 v[220:223], a[200:203], v[156:159], v[220:223]
    v_mfma_f32_16x16x32_bf16 v[220:223], a[204:207], v[160:163], v[220:223]
    v_mfma_f32_16x16x32_bf16 v[220:223], a[208:211], v[164:167], v[220:223]
    v_mfma_f32_16x16x32_bf16 v[224:227], a[212:215], v[152:155], 0
    v_mfma_f32_16x16x32_bf16 v[224:227], a[216:219], v[156:159], v[224:227]
    v_mfma_f32_16x16x32_bf16 v[224:227], a[220:223], v[160:163], v[224:227]
    v_mfma_f32_16x16x32_bf16 v[224:227], a[224:227], v[164:167], v[224:227]
    v_mfma_f32_16x16x32_bf16 v[216:219], a[228:231], v[168:171], v[216:219]
    s_waitcnt lgkmcnt(14)
    v_mfma_f32_16x16x32_bf16 v[216:219], a[232:235], v[172:175], v[216:219]
    s_waitcnt lgkmcnt(13)
    v_mfma_f32_16x16x32_bf16 v[216:219], a[236:239], v[176:179], v[216:219]
    s_waitcnt lgkmcnt(12)
    v_mfma_f32_16x16x32_bf16 v[216:219], a[240:243], v[180:183], v[216:219]
    v_mfma_f32_16x16x32_bf16 v[220:223], a[244:247], v[168:171], v[220:223]
    v_mfma_f32_16x16x32_bf16 v[220:223], a[248:251], v[172:175], v[220:223]
    v_mfma_f32_16x16x32_bf16 v[220:223], a[252:255], v[176:179], v[220:223]
    v_mfma_f32_16x16x32_bf16 v[220:223], a[32:35], v[180:183], v[220:223]
    v_mfma_f32_16x16x32_bf16 v[224:227], a[48:51], v[168:171], v[224:227]
    v_mfma_f32_16x16x32_bf16 v[224:227], a[36:39], v[172:175], v[224:227]
    v_mfma_f32_16x16x32_bf16 v[224:227], a[52:55], v[176:179], v[224:227]
    v_mfma_f32_16x16x32_bf16 v[224:227], a[40:43], v[180:183], v[224:227]
    s_waitcnt lgkmcnt(11)
    v_mfma_f32_16x16x32_bf16 v[216:219], a[56:59], v[184:187], v[216:219]
    s_waitcnt lgkmcnt(10)
    v_mfma_f32_16x16x32_bf16 v[216:219], a[44:47], v[188:191], v[216:219]
    s_waitcnt lgkmcnt(9)
    v_mfma_f32_16x16x32_bf16 v[216:219], a[60:63], v[192:195], v[216:219]
    s_waitcnt lgkmcnt(8)
    v_mfma_f32_16x16x32_bf16 v[216:219], a[64:67], v[196:199], v[216:219]
    buffer_load_dwordx4 a[96:99], v2, s[24:27], s14 offen offset:3072 sc1
    v_mfma_f32_16x16x32_bf16 v[220:223], a[80:83], v[184:187], v[220:223]
    s_add_u32 s12, s12, 4096
    buffer_load_dwordx4 a[112:115], v2, s[24:27], s12 offen offset:0 sc1
    s_waitcnt vmcnt(8)
    v_mfma_f32_16x16x32_bf16 v[220:223], a[68:71], v[188:191], v[220:223]
    buffer_load_dwordx4 a[100:103], v2, s[24:27], s12 offen offset:1024 sc1
    s_waitcnt vmcnt(8)
    v_mfma_f32_16x16x32_bf16 v[220:223], a[84:87], v[192:195], v[220:223]
    buffer_load_dwordx4 a[116:119], v2, s[24:27], s12 offen offset:2048 sc1
    s_waitcnt vmcnt(8)
    v_mfma_f32_16x16x32_bf16 v[220:223], a[72:75], v[196:199], v[220:223]
    buffer_load_dwordx4 a[104:107], v2, s[24:27], s12 offen offset:3072 sc1
    s_waitcnt vmcnt(8)
    v_mfma_f32_16x16x32_bf16 v[224:227], a[88:91], v[184:187], v[224:227]
    s_add_u32 s13, s13, 4096
    buffer_load_dwordx4 a[120:123], v2, s[24:27], s13 offen offset:0 sc1
    s_waitcnt vmcnt(8)
    v_mfma_f32_16x16x32_bf16 v[224:227], a[76:79], v[188:191], v[224:227]
    buffer_load_dwordx4 a[108:111], v2, s[24:27], s13 offen offset:1024 sc1
    s_waitcnt vmcnt(7)
    v_mfma_f32_16x16x32_bf16 v[224:227], a[92:95], v[192:195], v[224:227]
    buffer_load_dwordx4 a[124:127], v2, s[24:27], s13 offen offset:2048 sc1
    s_waitcnt vmcnt(7)
    v_mfma_f32_16x16x32_bf16 v[224:227], a[96:99], v[196:199], v[224:227]
    buffer_load_dwordx4 a[128:131], v2, s[24:27], s13 offen offset:3072 sc1
    s_waitcnt vmcnt(7) lgkmcnt(7)
    v_mfma_f32_16x16x32_bf16 v[216:219], a[112:115], v[200:203], v[216:219]
    s_add_u32 s14, s14, 4096
    buffer_load_dwordx4 a[144:147], v2, s[24:27], s14 offen offset:0 sc1
    s_waitcnt vmcnt(7) lgkmcnt(6)
    v_mfma_f32_16x16x32_bf16 v[216:219], a[100:103], v[204:207], v[216:219]
    buffer_load_dwordx4 a[132:135], v2, s[24:27], s14 offen offset:1024 sc1
    s_waitcnt vmcnt(7) lgkmcnt(5)
    v_mfma_f32_16x16x32_bf16 v[216:219], a[116:119], v[208:211], v[216:219]
    buffer_load_dwordx4 a[148:151], v2, s[24:27], s14 offen offset:2048 sc1
    s_waitcnt vmcnt(7) lgkmcnt(4)
    v_mfma_f32_16x16x32_bf16 v[216:219], a[104:107], v[212:215], v[216:219]
    buffer_load_dwordx4 a[136:139], v2, s[24:27], s14 offen offset:3072 sc1
    s_waitcnt vmcnt(7)
    v_mfma_f32_16x16x32_bf16 v[220:223], a[120:123], v[200:203], v[220:223]
    s_mov_b32 s49, 0x80000
    s_add_u32 s45, s66, 6
    buffer_load_dwordx2 v[22:23], v20, s[24:27], 0 offen sc1
    s_waitcnt vmcnt(0)
    s_branch L_ptest_12
L_poll_10:
    buffer_load_dwordx2 v[22:23], v20, s[24:27], 0 offen sc1
    s_sub_u32 s49, s49, 1
    s_waitcnt vmcnt(0)
    s_cbranch_scc1 L_polled_11
L_ptest_12:
    v_subrev_u32 v22, s45, v22
    v_lshrrev_b32 v22, 3, v22
    v_bitop3_b32 v22, v23, s66, v22 bitop3:0xbe
    v_cmp_ne_u32 vcc, 0, v22
    s_cbranch_vccnz L_poll_10
L_polled_11:
    buffer_load_dwordx4 v2, s[24:27], s18 offen offset:0 sc1 lds
    buffer_load_dwordx4 v2, s[24:27], s18 offen offset:1024 sc1 lds
    buffer_load_dwordx4 v2, s[24:27], s18 offen offset:2048 sc1 lds
    buffer_load_dwordx4 v2, s[24:27], s18 offen offset:3072 sc1 lds
    s_add_u32 m0, m0, 16384
    s_add_u32 s18, s18, 16384
    buffer_load_dword v136, v17, s[24:27], s20 offen offset:0 sc1
    buffer_load_dword v137, v17, s[24:27], s20 offen offset:128 sc1
    buffer_load_dword v138, v17, s[24:27], s20 offen offset:256 sc1
    buffer_load_dword v139, v17, s[24:27], s20 offen offset:384 sc1
    buffer_load_dwordx4 v2, s[24:27], s18 offen offset:0 sc1 lds
    buffer_load_dwordx4 v2, s[24:27], s18 offen offset:1024 sc1 lds
    buffer_load_dwordx4 v2, s[24:27], s18 offen offset:2048 sc1 lds
    buffer_load_dwordx4 v2, s[24:27], s18 offen offset:3072 sc1 lds
    s_add_u32 m0, m0, 16384
    s_add_u32 s18, s18, 16384
    v_mfma_f32_16x16x32_bf16 v[220:223], a[108:111], v[204:207], v[220:223]
    v_mfma_f32_16x16x32_bf16 v[220:223], a[124:127], v[208:211], v[220:223]
    v_mfma_f32_16x16x32_bf16 v[220:223], a[128:131], v[212:215], v[220:223]
    v_mfma_f32_16x16x32_bf16 v[224:227], a[144:147], v[200:203], v[224:227]
    v_mfma_f32_16x16x32_bf16 v[224:227], a[132:135], v[204:207], v[224:227]
    v_mfma_f32_16x16x32_bf16 v[224:227], a[148:151], v[208:211], v[224:227]
    v_mfma_f32_16x16x32_bf16 v[224:227], a[136:139], v[212:215], v[224:227]
    v_mov_b32_dpp v112, v216 quad_perm:[0,0,2,2] row_mask:0xf bank_mask:0xf
    v_add_f32_dpp v124, v216, v124 quad_perm:[1,1,3,3] row_mask:0xf bank_mask:0xf
    v_mov_b32_dpp v113, v217 quad_perm:[0,0,2,2] row_mask:0xf bank_mask:0xf
    v_add_f32_dpp v125, v217, v125 quad_perm:[1,1,3,3] row_mask:0xf bank_mask:0xf
    v_mov_b32_dpp v114, v218 quad_perm:[0,0,2,2] row_mask:0xf bank_mask:0xf
    v_add_f32_dpp v126, v218, v126 quad_perm:[1,1,3,3] row_mask:0xf bank_mask:0xf
    v_mov_b32_dpp v115, v219 quad_perm:[0,0,2,2] row_mask:0xf bank_mask:0xf
    v_add_f32_dpp v127, v219, v127 quad_perm:[1,1,3,3] row_mask:0xf bank_mask:0xf
    v_mov_b32_dpp v116, v220 quad_perm:[0,0,2,2] row_mask:0xf bank_mask:0xf
    v_add_f32_dpp v128, v220, v128 quad_perm:[1,1,3,3] row_mask:0xf bank_mask:0xf
    v_mov_b32_dpp v117, v221 quad_perm:[0,0,2,2] row_mask:0xf bank_mask:0xf
    v_add_f32_dpp v129, v221, v129 quad_perm:[1,1,3,3] row_mask:0xf bank_mask:0xf
    v_mov_b32_dpp v118, v222 quad_perm:[0,0,2,2] row_mask:0xf bank_mask:0xf
    v_add_f32_dpp v130, v222, v130 quad_perm:[1,1,3,3] row_mask:0xf bank_mask:0xf
    v_mov_b32_dpp v119, v223 quad_perm:[0,0,2,2] row_mask:0xf bank_mask:0xf
    v_add_f32_dpp v131, v223, v131 quad_perm:[1,1,3,3] row_mask:0xf bank_mask:0xf
    v_mov_b32_dpp v120, v224 quad_perm:[0,0,2,2] row_mask:0xf bank_mask:0xf
    v_add_f32_dpp v132, v224, v132 quad_perm:[1,1,3,3] row_mask:0xf bank_mask:0xf
    v_mov_b32_dpp v121, v225 quad_perm:[0,0,2,2] row_mask:0xf bank_mask:0xf
    v_add_f32_dpp v133, v225, v133 quad_perm:[1,1,3,3] row_mask:0xf bank_mask:0xf
    v_mov_b32_dpp v122, v226 quad_perm:[0,0,2,2] row_mask:0xf bank_mask:0xf
    v_add_f32_dpp v134, v226, v134 quad_perm:[1,1,3,3] row_mask:0xf bank_mask:0xf
    v_mov_b32_dpp v123, v227 quad_perm:[0,0,2,2] row_mask:0xf bank_mask:0xf
    v_add_f32_dpp v135, v227, v135 quad_perm:[1,1,3,3] row_mask:0xf bank_mask:0xf
    s_waitcnt vmcnt(8) lgkmcnt(0)
    s_barrier
    ds_read_b128 a[0:3], v9 offset:0
    ds_read_b128 a[4:7], v9 offset:1024
    ds_read_b128 a[8:11], v9 offset:2048
    ds_read_b128 a[12:15], v9 offset:3072
    ds_read_b128 a[16:19], v9 offset:4096
    ds_read_b128 a[20:23], v9 offset:5120
    ds_read_b128 a[24:27], v9 offset:6144
    ds_read_b128 a[28:31], v9 offset:7168
    s_waitcnt lgkmcnt(7)
    v_mfma_f32_16x16x32_bf16 v[24:27], a[180:183], a[0:3], 0
    s_waitcnt lgkmcnt(6)
    buffer_load_dwordx4 v2, s[24:27], s18 offen offset:0 sc1 lds
    v_mfma_f32_16x16x32_bf16 v[24:27], a[184:187], a[4:7], v[24:27]
    s_waitcnt vmcnt(5) lgkmcnt(5)
    v_add_f32 v136, v136, v137
    v_add_f32 v138, v138, v139
    v_mfma_f32_16x16x32_bf16 v[24:27], a[188:191], a[8:11], v[24:27]
    s_waitcnt lgkmcnt(4)
    v_add_f32 v136, v136, v138
    v_mov_b32 v137, v136
    v_mfma_f32_16x16x32_bf16 v[24:27], a[192:195], a[12:15], v[24:27]
    buffer_load_dwordx4 v2, s[24:27], s18 offen offset:1024 sc1 lds
    v_mfma_f32_16x16x32_bf16 v[28:31], a[196:199], a[0:3], 0
    v_permlane16_swap_b32 v136, v137
    v_add_f32 v136, v136, v137
    v_mfma_f32_16x16x32_bf16 v[28:31], a[200:203], a[4:7], v[28:31]
    v_mul_f32 v136, 0x3b000000, v136
    v_mov_b32 v137, v136
    v_mfma_f32_16x16x32_bf16 v[28:31], a[204:207], a[8:11], v[28:31]
    buffer_load_dwordx4 v2, s[24:27], s18 offen offset:2048 sc1 lds
    v_mfma_f32_16x16x32_bf16 v[28:31], a[208:211], a[12:15], v[28:31]
    v_permlane32_swap_b32 v136, v137
    v_fma_f32 v137, -v136, v136, v137
    v_mfma_f32_16x16x32_bf16 v[32:35], a[212:215], a[0:3], 0
    v_max_f32 v137, 0, v137
    v_add_f32 v137, 0x3727c5ac, v137
    v_mfma_f32_16x16x32_bf16 v[32:35], a[216:219], a[4:7], v[32:35]
    buffer_load_dwordx4 v2, s[24:27], s18 offen offset:3072 sc1 lds
    v_mfma_f32_16x16x32_bf16 v[32:35], a[220:223], a[8:11], v[32:35]
    s_add_u32 m0, m0, 16384
    s_add_u32 s18, s18, 16384
    ds_read_b128 a[140:143], v9 offset:8192
    v_mfma_f32_16x16x32_bf16 v[32:35], a[224:227], a[12:15], v[32:35]
    s_waitcnt lgkmcnt(4)
    ds_read_b128 a[152:155], v9 offset:9216
    v_rsq_f32 v138, v137
    v_mfma_f32_16x16x32_bf16 v[24:27], a[228:231], a[16:19], v[24:27]
    s_waitcnt lgkmcnt(4)
    ds_read_b128 a[0:3], v9 offset:10240
    v_mul_f32 v139, -v136, v138
    v_mfma_f32_16x16x32_bf16 v[24:27], a[232:235], a[20:23], v[24:27]
    s_waitcnt lgkmcnt(4)
    ds_read_b128 a[4:7], v9 offset:11264
    ds_write_b64 v147, v[138:139]
    v_mfma_f32_16x16x32_bf16 v[24:27], a[236:239], a[24:27], v[24:27]
    s_waitcnt lgkmcnt(5)
    buffer_load_dwordx4 v2, s[24:27], s18 offen offset:0 sc1 lds
    v_mfma_f32_16x16x32_bf16 v[24:27], a[240:243], a[28:31], v[24:27]
    v_mfma_f32_16x16x32_bf16 v[28:31], a[244:247], a[16:19], v[28:31]
    v_mfma_f32_16x16x32_bf16 v[28:31], a[248:251], a[20:23], v[28:31]
    buffer_load_dwordx4 v2, s[24:27], s18 offen offset:1024 sc1 lds
    v_mfma_f32_16x16x32_bf16 v[28:31], a[252:255], a[24:27], v[28:31]
    v_mfma_f32_16x16x32_bf16 v[28:31], a[32:35], a[28:31], v[28:31]
    v_mfma_f32_16x16x32_bf16 v[32:35], a[48:51], a[16:19], v[32:35]
    buffer_load_dwordx4 v2, s[24:27], s18 offen offset:2048 sc1 lds
    v_mfma_f32_16x16x32_bf16 v[32:35], a[36:39], a[20:23], v[32:35]
    v_mfma_f32_16x16x32_bf16 v[32:35], a[52:55], a[24:27], v[32:35]
    ds_read_b128 a[8:11], v9 offset:12288
    v_mfma_f32_16x16x32_bf16 v[32:35], a[40:43], a[28:31], v[32:35]
    s_waitcnt lgkmcnt(5)
    ds_read_b128 a[12:15], v9 offset:13312
    v_mfma_f32_16x16x32_bf16 v[24:27], a[56:59], a[140:143], v[24:27]
    s_waitcnt lgkmcnt(5)
    ds_read_b128 a[16:19], v9 offset:14336
    v_mfma_f32_16x16x32_bf16 v[24:27], a[44:47], a[152:155], v[24:27]
    s_waitcnt lgkmcnt(5)
    ds_read_b128 a[20:23], v9 offset:15360
    v_mfma_f32_16x16x32_bf16 v[24:27], a[60:63], a[0:3], v[24:27]
    s_waitcnt lgkmcnt(5)
    buffer_load_dwordx4 v2, s[24:27], s18 offen offset:3072 sc1 lds
    v_mfma_f32_16x16x32_bf16 v[24:27], a[64:67], a[4:7], v[24:27]
    s_add_u32 m0, m0, 16384
    s_add_u32 s18, s18, 16384
    v_mfma_f32_16x16x32_bf16 v[28:31], a[80:83], a[140:143], v[28:31]
    v_mfma_f32_16x16x32_bf16 v[28:31], a[68:71], a[152:155], v[28:31]
    buffer_load_dwordx4 a[156:159], v16, s[24:27], s68 offen offset:0 sc1
    v_mfma_f32_16x16x32_bf16 v[28:31], a[84:87], a[0:3], v[28:31]
    v_mfma_f32_16x16x32_bf16 v[28:31], a[72:75], a[4:7], v[28:31]
    v_mfma_f32_16x16x32_bf16 v[32:35], a[88:91], a[140:143], v[32:35]
    v_mfma_f32_16x16x32_bf16 v[32:35], a[76:79], a[152:155], v[32:35]
    v_mfma_f32_16x16x32_bf16 v[32:35], a[92:95], a[0:3], v[32:35]
    s_waitcnt vmcnt(9) lgkmcnt(4)
    s_barrier
    ds_read_b128 a[24:27], v9 offset:16384
    ds_read_b64 v[140:141], v19 offset:0
    v_mfma_f32_16x16x32_bf16 v[32:35], a[96:99], a[4:7], v[32:35]
    s_waitcnt lgkmcnt(5)
    ds_read_b128 a[28:31], v9 offset:17408
    ds_read_b64 v[142:143], v19 offset:128
    v_mfma_f32_16x16x32_bf16 v[24:27], a[112:115], a[8:11], v[24:27]
    s_waitcnt lgkmcnt(6)
    ds_read_b128 a[140:143], v9 offset:18432
    ds_read_b64 v[144:145], v19 offset:256
    v_mfma_f32_16x16x32_bf16 v[24:27], a[100:103], a[12:15], v[24:27]
    s_waitcnt lgkmcnt(7)
    ds_read_b128 a[152:155], v9 offset:19456
    ds_read_b64 v[146:147], v19 offset:384
    v_mfma_f32_16x16x32_bf16 v[24:27], a[116:119], a[16:19], v[24:27]
    s_waitcnt lgkmcnt(8)
    buffer_load_dwordx4 a[160:163], v16, s[24:27], s68 offen offset:1024 sc1
    v_mfma_f32_16x16x32_bf16 v[24:27], a[104:107], a[20:23], v[24:27]
    v_mfma_f32_16x16x32_bf16 v[28:31], a[120:123], a[8:11], v[28:31]
    v_mfma_f32_16x16x32_bf16 v[28:31], a[108:111], a[12:15], v[28:31]
    v_mfma_f32_16x16x32_bf16 v[28:31], a[124:127], a[16:19], v[28:31]
    v_mfma_f32_16x16x32_bf16 v[28:31], a[128:131], a[20:23], v[28:31]
    v_mfma_f32_16x16x32_bf16 v[32:35], a[144:147], a[8:11], v[32:35]
    buffer_load_dwordx4 a[164:167], v16, s[24:27], s68 offen offset:2048 sc1
    v_mfma_f32_16x16x32_bf16 v[32:35], a[132:135], a[12:15], v[32:35]
    v_mfma_f32_16x16x32_bf16 v[32:35], a[148:151], a[16:19], v[32:35]
    ds_read_b128 a[0:3], v9 offset:20480
    v_mfma_f32_16x16x32_bf16 v[32:35], a[136:139], a[20:23], v[32:35]
    s_waitcnt lgkmcnt(1)
    ds_read_b128 a[4:7], v9 offset:21504
    v_fma_f32 v152, v141, v112, v124
    v_mfma_f32_16x16x32_bf16 v[36:39], a[180:183], a[24:27], 0
    ds_read_b128 a[8:11], v9 offset:22528
    v_fma_f32 v153, v141, v113, v125
    v_mfma_f32_16x16x32_bf16 v[36:39], a[184:187], a[28:31], v[36:39]
    ds_read_b128 a[12:15], v9 offset:23552
    v_fma_f32 v154, v141, v114, v126
    v_mfma_f32_16x16x32_bf16 v[36:39], a[188:191], a[140:143], v[36:39]
    buffer_load_dwordx4 a[168:171], v16, s[24:27], s68 offen offset:3072 sc1
    v_mfma_f32_16x16x32_bf16 v[36:39], a[192:195], a[152:155], v[36:39]
    v_fma_f32 v155, v141, v115, v127
    v_fmac_f32 v152, v24, v140
    v_mfma_f32_16x16x32_bf16 v[40:43], a[196:199], a[24:27], 0
    v_fmac_f32 v153, v25, v140
    v_fmac_f32 v154, v26, v140
    v_mfma_f32_16x16x32_bf16 v[40:43], a[200:203], a[28:31], v[40:43]
    v_fmac_f32 v155, v27, v140
    v_mul_f32 v24, v152, v152
    v_mfma_f32_16x16x32_bf16 v[40:43], a[204:207], a[140:143], v[40:43]
    v_mul_f32 v25, v153, v153
    v_mul_f32 v26, v154, v154
    v_mfma_f32_16x16x32_bf16 v[40:43], a[208:211], a[152:155], v[40:43]
    v_mul_f32 v27, v155, v155
    v_fma_f32 v24, v24, v110, v111
    v_mfma_f32_16x16x32_bf16 v[44:47], a[212:215], a[24:27], 0
    buffer_load_dwordx4 a[172:175], v16, s[24:27], s69 offen offset:0 sc1
    v_mfma_f32_16x16x32_bf16 v[44:47], a[216:219], a[28:31], v[44:47]
    v_fma_f32 v25, v25, v110, v111
    v_fma_f32 v26, v26, v110, v111
    v_mfma_f32_16x16x32_bf16 v[44:47], a[220:223], a[140:143], v[44:47]
    ds_read_b128 a[16:19], v9 offset:24576
    v_fma_f32 v27, v27, v110, v111
    v_mfma_f32_16x16x32_bf16 v[44:47], a[224:227], a[152:155], v[44:47]
    s_waitcnt lgkmcnt(4)
    ds_read_b128 a[20:23], v9 offset:25600
    v_mul_f32 v24, v24, v152
    v_mfma_f32_16x16x32_bf16 v[36:39], a[228:231], a[0:3], v[36:39]
    s_waitcnt lgkmcnt(4)
    ds_read_b128 a[24:27], v9 offset:26624
    v_mul_f32 v25, v25, v153
    v_mfma_f32_16x16x32_bf16 v[36:39], a[232:235], a[4:7], v[36:39]
    s_waitcnt lgkmcnt(4)
    ds_read_b128 a[28:31], v9 offset:27648
    v_mul_f32 v26, v26, v154
    v_mfma_f32_16x16x32_bf16 v[36:39], a[236:239], a[8:11], v[36:39]
    s_waitcnt lgkmcnt(4)
    buffer_load_dwordx4 a[176:179], v16, s[24:27], s69 offen offset:1024 sc1
    v_mfma_f32_16x16x32_bf16 v[36:39], a[240:243], a[12:15], v[36:39]
    v_mul_f32 v27, v27, v155
    v_exp_f32 v24, v24
    v_mfma_f32_16x16x32_bf16 v[40:43], a[244:247], a[0:3], v[40:43]
    v_exp_f32 v25, v25
    v_mfma_f32_16x16x32_bf16 v[40:43], a[248:251], a[4:7], v[40:43]
    v_exp_f32 v26, v26
    v_mfma_f32_16x16x32_bf16 v[40:43], a[252:255], a[8:11], v[40:43]
    v_exp_f32 v27, v27
    v_mfma_f32_16x16x32_bf16 v[40:43], a[32:35], a[12:15], v[40:43]
    v_add_f32 v24, v104, v24
    v_add_f32 v25, v104, v25
    v_mfma_f32_16x16x32_bf16 v[44:47], a[48:51], a[0:3], v[44:47]
    buffer_load_dwordx4 v[160:163], v16, s[24:27], s69 offen offset:2048 sc1
    v_mfma_f32_16x16x32_bf16 v[44:47], a[36:39], a[4:7], v[44:47]
    v_add_f32 v26, v104, v26
    v_add_f32 v27, v104, v27
    v_mfma_f32_16x16x32_bf16 v[44:47], a[52:55], a[8:11], v[44:47]
    ds_read_b128 a[140:143], v9 offset:28672
    v_rcp_f32 v24, v24
    v_mfma_f32_16x16x32_bf16 v[44:47], a[40:43], a[12:15], v[44:47]
    s_waitcnt lgkmcnt(4)
    ds_read_b128 a[152:155], v9 offset:29696
    v_rcp_f32 v25, v25
    v_mfma_f32_16x16x32_bf16 v[36:39], a[56:59], a[16:19], v[36:39]
    s_waitcnt lgkmcnt(4)
    ds_read_b128 a[0:3], v9 offset:30720
    v_rcp_f32 v26, v26
    v_mfma_f32_16x16x32_bf16 v[36:39], a[44:47], a[20:23], v[36:39]
    s_waitcnt lgkmcnt(4)
    ds_read_b128 a[4:7], v9 offset:31744
    v_rcp_f32 v27, v27
    v_mfma_f32_16x16x32_bf16 v[36:39], a[60:63], a[24:27], v[36:39]
    s_waitcnt lgkmcnt(4)
    buffer_load_dwordx4 v[164:167], v16, s[24:27], s69 offen offset:3072 sc1
    v_mfma_f32_16x16x32_bf16 v[36:39], a[64:67], a[28:31], v[36:39]
    v_mul_f32 v24, v24, v152
    v_mul_f32 v25, v25, v153
    v_mfma_f32_16x16x32_bf16 v[40:43], a[80:83], a[16:19], v[40:43]
    v_mul_f32 v26, v26, v154
    v_mul_f32 v27, v27, v155
    v_mfma_f32_16x16x32_bf16 v[40:43], a[68:71], a[20:23], v[40:43]
    v_cvt_pk_bf16_f32 v72, v24, v25
    v_cvt_pk_bf16_f32 v73, v26, v27
    v_mfma_f32_16x16x32_bf16 v[40:43], a[84:87], a[24:27], v[40:43]
    v_fma_f32 v156, v141, v116, v128
    v_fma_f32 v157, v141, v117, v129
    v_mfma_f32_16x16x32_bf16 v[40:43], a[72:75], a[28:31], v[40:43]
    v_fma_f32 v158, v141, v118, v130
    v_fma_f32 v159, v141, v119, v131
    v_mfma_f32_16x16x32_bf16 v[44:47], a[88:91], a[16:19], v[44:47]
    buffer_load_dwordx4 v[168:171], v16, s[24:27], s70 offen offset:0 sc1
    v_mfma_f32_16x16x32_bf16 v[44:47], a[76:79], a[20:23], v[44:47]
    v_fmac_f32 v156, v28, v140
    v_fmac_f32 v157, v29, v140
    v_mfma_f32_16x16x32_bf16 v[44:47], a[92:95], a[24:27], v[44:47]
    s_waitcnt vmcnt(13)
    s_barrier
    ds_read_b128 a[8:11], v9 offset:32768
    v_mfma_f32_16x16x32_bf16 v[44:47], a[96:99], a[28:31], v[44:47]
    s_waitcnt lgkmcnt(4)
    ds_read_b128 a[12:15], v9 offset:33792
    v_fmac_f32 v158, v30, v140
    v_mfma_f32_16x16x32_bf16 v[36:39], a[112:115], a[140:143], v[36:39]
    s_waitcnt lgkmcnt(4)
    ds_read_b128 a[16:19], v9 offset:34816
    v_fmac_f32 v159, v31, v140
    v_mfma_f32_16x16x32_bf16 v[36:39], a[100:103], a[152:155], v[36:39]
    s_waitcnt lgkmcnt(4)
    ds_read_b128 a[20:23], v9 offset:35840
    v_mul_f32 v28, v156, v156
    v_mfma_f32_16x16x32_bf16 v[36:39], a[116:119], a[0:3], v[36:39]
    s_waitcnt lgkmcnt(4)
    buffer_load_dwordx4 v[172:175], v16, s[24:27], s70 offen offset:1024 sc1
    v_mfma_f32_16x16x32_bf16 v[36:39], a[104:107], a[4:7], v[36:39]
    v_mul_f32 v29, v157, v157
    v_mul_f32 v30, v158, v158
    v_mfma_f32_16x16x32_bf16 v[40:43], a[120:123], a[140:143], v[40:43]
    v_mul_f32 v31, v159, v159
    v_fma_f32 v28, v28, v110, v111
    v_mfma_f32_16x16x32_bf16 v[40:43], a[108:111], a[152:155], v[40:43]
    v_fma_f32 v29, v29, v110, v111
    v_fma_f32 v30, v30, v110, v111
    v_mfma_f32_16x16x32_bf16 v[40:43], a[124:127], a[0:3], v[40:43]
    v_fma_f32 v31, v31, v110, v111
    v_mul_f32 v28, v28, v156
    v_mfma_f32_16x16x32_bf16 v[40:43], a[128:131], a[4:7], v[40:43]
    v_mul_f32 v29, v29, v157
    v_mul_f32 v30, v30, v158
    v_mfma_f32_16x16x32_bf16 v[44:47], a[144:147], a[140:143], v[44:47]
    buffer_load_dwordx4 v[176:179], v16, s[24:27], s70 offen offset:2048 sc1
    v_mfma_f32_16x16x32_bf16 v[44:47], a[132:135], a[152:155], v[44:47]
    v_mul_f32 v31, v31, v159
    v_exp_f32 v28, v28
    v_mfma_f32_16x16x32_bf16 v[44:47], a[148:151], a[0:3], v[44:47]
    ds_read_b128 a[24:27], v9 offset:36864
    v_exp_f32 v29, v29
    v_mfma_f32_16x16x32_bf16 v[44:47], a[136:139], a[4:7], v[44:47]
    s_waitcnt lgkmcnt(4)
    ds_read_b128 a[28:31], v9 offset:37888
    v_exp_f32 v30, v30
    v_mfma_f32_16x16x32_bf16 v[48:51], a[180:183], a[8:11], 0
    s_waitcnt lgkmcnt(4)
    ds_read_b128 a[140:143], v9 offset:38912
    v_exp_f32 v31, v31
    v_mfma_f32_16x16x32_bf16 v[48:51], a[184:187], a[12:15], v[48:51]
    s_waitcnt lgkmcnt(4)
    ds_read_b128 a[152:155], v9 offset:39936
    v_add_f32 v28, v104, v28
    v_mfma_f32_16x16x32_bf16 v[48:51], a[188:191], a[16:19], v[48:51]
    s_waitcnt lgkmcnt(4)
    buffer_load_dwordx4 v[180:183], v16, s[24:27], s70 offen offset:3072 sc1
    v_mfma_f32_16x16x32_bf16 v[48:51], a[192:195], a[20:23], v[48:51]
    v_add_f32 v29, v104, v29
    v_add_f32 v30, v104, v30
    v_mfma_f32_16x16x32_bf16 v[52:55], a[196:199], a[8:11], 0
    v_add_f32 v31, v104, v31
    v_rcp_f32 v28, v28
    v_mfma_f32_16x16x32_bf16 v[52:55], a[200:203], a[12:15], v[52:55]
    v_rcp_f32 v29, v29
    v_mfma_f32_16x16x32_bf16 v[52:55], a[204:207], a[16:19], v[52:55]
    v_rcp_f32 v30, v30
    v_mfma_f32_16x16x32_bf16 v[52:55], a[208:211], a[20:23], v[52:55]
    v_rcp_f32 v31, v31
    v_mfma_f32_16x16x32_bf16 v[56:59], a[212:215], a[8:11], 0
    buffer_load_dwordx4 v[184:187], v16, s[24:27], s71 offen offset:0 sc1
    v_mfma_f32_16x16x32_bf16 v[56:59], a[216:219], a[12:15], v[56:59]
    v_mul_f32 v28, v28, v156
    v_mul_f32 v29, v29, v157
    v_mfma_f32_16x16x32_bf16 v[56:59], a[220:223], a[16:19], v[56:59]
    ds_read_b128 a[0:3], v9 offset:40960
    v_mul_f32 v30, v30, v158
    v_mfma_f32_16x16x32_bf16 v[56:59], a[224:227], a[20:23], v[56:59]
    s_waitcnt lgkmcnt(4)
    ds_read_b128 a[4:7], v9 offset:41984
    v_mul_f32 v31, v31, v159
    v_mfma_f32_16x16x32_bf16 v[48:51], a[228:231], a[24:27], v[48:51]
    s_waitcnt lgkmcnt(4)
    ds_read_b128 a[8:11], v9 offset:43008
    v_cvt_pk_bf16_f32 v76, v28, v29
    v_mfma_f32_16x16x32_bf16 v[48:51], a[232:235], a[28:31], v[48:51]
    s_waitcnt lgkmcnt(4)
    ds_read_b128 a[12:15], v9 offset:44032
    v_cvt_pk_bf16_f32 v77, v30, v31
    v_mfma_f32_16x16x32_bf16 v[48:51], a[236:239], a[140:143], v[48:51]
    s_waitcnt lgkmcnt(4)
    buffer_load_dwordx4 v[188:191], v16, s[24:27], s71 offen offset:1024 sc1
    v_mfma_f32_16x16x32_bf16 v[48:51], a[240:243], a[152:155], v[48:51]
    v_fma_f32 v152, v141, v120, v132
    v_fma_f32 v153, v141, v121, v133
    v_mfma_f32_16x16x32_bf16 v[52:55], a[244:247], a[24:27], v[52:55]
    v_fma_f32 v154, v141, v122, v134
    v_fma_f32 v155, v141, v123, v135
    v_mfma_f32_16x16x32_bf16 v[52:55], a[248:251], a[28:31], v[52:55]
    v_fmac_f32 v152, v32, v140
    v_fmac_f32 v153, v33, v140
    v_mfma_f32_16x16x32_bf16 v[52:55], a[252:255], a[140:143], v[52:55]
    v_fmac_f32 v154, v34, v140
    v_fmac_f32 v155, v35, v140
    v_mfma_f32_16x16x32_bf16 v[52:55], a[32:35], a[152:155], v[52:55]
    v_mul_f32 v32, v152, v152
    v_mul_f32 v33, v153, v153
    v_mfma_f32_16x16x32_bf16 v[56:59], a[48:51], a[24:27], v[56:59]
    buffer_load_dwordx4 v[192:195], v16, s[24:27], s71 offen offset:2048 sc1
    v_mfma_f32_16x16x32_bf16 v[56:59], a[36:39], a[28:31], v[56:59]
    v_mul_f32 v34, v154, v154
    v_mul_f32 v35, v155, v155
    v_mfma_f32_16x16x32_bf16 v[56:59], a[52:55], a[140:143], v[56:59]
    ds_read_b128 a[16:19], v9 offset:45056
    v_fma_f32 v32, v32, v110, v111
    v_mfma_f32_16x16x32_bf16 v[56:59], a[40:43], a[152:155], v[56:59]
    s_waitcnt lgkmcnt(4)
    ds_read_b128 a[20:23], v9 offset:46080
    v_fma_f32 v33, v33, v110, v111
    v_mfma_f32_16x16x32_bf16 v[48:51], a[56:59], a[0:3], v[48:51]
    s_waitcnt lgkmcnt(4)
    ds_read_b128 a[24:27], v9 offset:47104
    v_fma_f32 v34, v34, v110, v111
    v_mfma_f32_16x16x32_bf16 v[48:51], a[44:47], a[4:7], v[48:51]
    s_waitcnt lgkmcnt(4)
    ds_read_b128 a[28:31], v9 offset:48128
    v_fma_f32 v35, v35, v110, v111
    v_mfma_f32_16x16x32_bf16 v[48:51], a[60:63], a[8:11], v[48:51]
    s_waitcnt lgkmcnt(4)
    buffer_load_dwordx4 v[196:199], v16, s[24:27], s71 offen offset:3072 sc1
    v_mfma_f32_16x16x32_bf16 v[48:51], a[64:67], a[12:15], v[48:51]
    v_mul_f32 v32, v32, v152
    v_mul_f32 v33, v33, v153
    v_mfma_f32_16x16x32_bf16 v[52:55], a[80:83], a[0:3], v[52:55]
    v_mul_f32 v34, v34, v154
    v_mul_f32 v35, v35, v155
    v_mfma_f32_16x16x32_bf16 v[52:55], a[68:71], a[4:7], v[52:55]
    v_exp_f32 v32, v32
    v_mfma_f32_16x16x32_bf16 v[52:55], a[84:87], a[8:11], v[52:55]
    v_exp_f32 v33, v33
    v_mfma_f32_16x16x32_bf16 v[52:55], a[72:75], a[12:15], v[52:55]
    v_exp_f32 v34, v34
    v_mfma_f32_16x16x32_bf16 v[56:59], a[88:91], a[0:3], v[56:59]
    buffer_load_dwordx4 v[200:203], v16, s[24:27], s72 offen offset:0 sc1
    v_mfma_f32_16x16x32_bf16 v[56:59], a[76:79], a[4:7], v[56:59]
    v_exp_f32 v35, v35
    v_mfma_f32_16x16x32_bf16 v[56:59], a[92:95], a[8:11], v[56:59]
    s_waitcnt vmcnt(17)
    s_barrier
    ds_read_b128 a[140:143], v9 offset:49152
    v_mfma_f32_16x16x32_bf16 v[56:59], a[96:99], a[12:15], v[56:59]
    s_waitcnt lgkmcnt(4)
    ds_read_b128 a[152:155], v9 offset:50176
    v_add_f32 v32, v104, v32
    v_mfma_f32_16x16x32_bf16 v[48:51], a[112:115], a[16:19], v[48:51]
    s_waitcnt lgkmcnt(4)
    ds_read_b128 a[0:3], v9 offset:51200
    v_add_f32 v33, v104, v33
    v_mfma_f32_16x16x32_bf16 v[48:51], a[100:103], a[20:23], v[48:51]
    s_waitcnt lgkmcnt(4)
    ds_read_b128 a[4:7], v9 offset:52224
    v_add_f32 v34, v104, v34
    v_mfma_f32_16x16x32_bf16 v[48:51], a[116:119], a[24:27], v[48:51]
    s_waitcnt lgkmcnt(4)
    buffer_load_dwordx4 v[204:207], v16, s[24:27], s72 offen offset:1024 sc1
    v_mfma_f32_16x16x32_bf16 v[48:51], a[104:107], a[28:31], v[48:51]
    v_add_f32 v35, v104, v35
    v_rcp_f32 v32, v32
    v_mfma_f32_16x16x32_bf16 v[52:55], a[120:123], a[16:19], v[52:55]
    v_rcp_f32 v33, v33
    v_mfma_f32_16x16x32_bf16 v[52:55], a[108:111], a[20:23], v[52:55]
    v_rcp_f32 v34, v34
    v_mfma_f32_16x16x32_bf16 v[52:55], a[124:127], a[24:27], v[52:55]
    v_rcp_f32 v35, v35
    v_mfma_f32_16x16x32_bf16 v[52:55], a[128:131], a[28:31], v[52:55]
    v_mul_f32 v32, v32, v152
    v_mul_f32 v33, v33, v153
    v_mfma_f32_16x16x32_bf16 v[56:59], a[144:147], a[16:19], v[56:59]
    buffer_load_dwordx4 v[208:211], v16, s[24:27], s72 offen offset:2048 sc1
    v_mfma_f32_16x16x32_bf16 v[56:59], a[132:135], a[20:23], v[56:59]
    v_mul_f32 v34, v34, v154
    v_mul_f32 v35, v35, v155
    v_mfma_f32_16x16x32_bf16 v[56:59], a[148:151], a[24:27], v[56:59]
    ds_read_b128 a[8:11], v9 offset:53248
    v_cvt_pk_bf16_f32 v80, v32, v33
    v_mfma_f32_16x16x32_bf16 v[56:59], a[136:139], a[28:31], v[56:59]
    s_waitcnt lgkmcnt(4)
    ds_read_b128 a[12:15], v9 offset:54272
    v_cvt_pk_bf16_f32 v81, v34, v35
    v_mfma_f32_16x16x32_bf16 v[60:63], a[180:183], a[140:143], 0
    s_waitcnt lgkmcnt(4)
    ds_read_b128 a[16:19], v9 offset:55296
    v_fma_f32 v156, v143, v112, v124
    v_mfma_f32_16x16x32_bf16 v[60:63], a[184:187], a[152:155], v[60:63]
    s_waitcnt lgkmcnt(4)
    ds_read_b128 a[20:23], v9 offset:56320
    v_fma_f32 v157, v143, v113, v125
    v_mfma_f32_16x16x32_bf16 v[60:63], a[188:191], a[0:3], v[60:63]
    s_waitcnt lgkmcnt(4)
    buffer_load_dwordx4 v[212:215], v16, s[24:27], s72 offen offset:3072 sc1
    v_mfma_f32_16x16x32_bf16 v[60:63], a[192:195], a[4:7], v[60:63]
    v_fma_f32 v158, v143, v114, v126
    v_fma_f32 v159, v143, v115, v127
    v_mfma_f32_16x16x32_bf16 v[64:67], a[196:199], a[140:143], 0
    v_fmac_f32 v156, v36, v142
    v_fmac_f32 v157, v37, v142
    v_mfma_f32_16x16x32_bf16 v[64:67], a[200:203], a[152:155], v[64:67]
    v_fmac_f32 v158, v38, v142
    v_fmac_f32 v159, v39, v142
    v_mfma_f32_16x16x32_bf16 v[64:67], a[204:207], a[0:3], v[64:67]
    v_mul_f32 v36, v156, v156
    v_mul_f32 v37, v157, v157
    v_mfma_f32_16x16x32_bf16 v[64:67], a[208:211], a[4:7], v[64:67]
    v_mul_f32 v38, v158, v158
    v_mul_f32 v39, v159, v159
    v_mfma_f32_16x16x32_bf16 v[68:71], a[212:215], a[140:143], 0
    buffer_load_dwordx4 v[216:219], v16, s[24:27], s73 offen offset:0 sc1
    v_mfma_f32_16x16x32_bf16 v[68:71], a[216:219], a[152:155], v[68:71]
    v_fma_f32 v36, v36, v110, v111
    v_fma_f32 v37, v37, v110, v111
    v_mfma_f32_16x16x32_bf16 v[68:71], a[220:223], a[0:3], v[68:71]
    ds_read_b128 a[24:27], v9 offset:57344
    v_fma_f32 v38, v38, v110, v111
    v_mfma_f32_16x16x32_bf16 v[68:71], a[224:227], a[4:7], v[68:71]
    s_waitcnt lgkmcnt(4)
    ds_read_b128 a[28:31], v9 offset:58368
    v_fma_f32 v39, v39, v110, v111
    v_mfma_f32_16x16x32_bf16 v[60:63], a[228:231], a[8:11], v[60:63]
    s_waitcnt lgkmcnt(4)
    ds_read_b128 a[140:143], v9 offset:59392
    v_mul_f32 v36, v36, v156
    v_mfma_f32_16x16x32_bf16 v[60:63], a[232:235], a[12:15], v[60:63]
    s_waitcnt lgkmcnt(4)
    ds_read_b128 a[152:155], v9 offset:60416
    v_mul_f32 v37, v37, v157
    v_mfma_f32_16x16x32_bf16 v[60:63], a[236:239], a[16:19], v[60:63]
    s_waitcnt lgkmcnt(4)
    buffer_load_dwordx4 v[220:223], v16, s[24:27], s73 offen offset:1024 sc1
    v_mfma_f32_16x16x32_bf16 v[60:63], a[240:243], a[20:23], v[60:63]
    v_mul_f32 v38, v38, v158
    v_mul_f32 v39, v39, v159
    v_mfma_f32_16x16x32_bf16 v[64:67], a[244:247], a[8:11], v[64:67]
    v_exp_f32 v36, v36
    v_mfma_f32_16x16x32_bf16 v[64:67], a[248:251], a[12:15], v[64:67]
    v_exp_f32 v37, v37
    v_mfma_f32_16x16x32_bf16 v[64:67], a[252:255], a[16:19], v[64:67]
    v_exp_f32 v38, v38
    v_mfma_f32_16x16x32_bf16 v[64:67], a[32:35], a[20:23], v[64:67]
    v_exp_f32 v39, v39
    v_mfma_f32_16x16x32_bf16 v[68:71], a[48:51], a[8:11], v[68:71]
    buffer_load_dwordx4 v[224:227], v16, s[24:27], s73 offen offset:2048 sc1
    v_mfma_f32_16x16x32_bf16 v[68:71], a[36:39], a[12:15], v[68:71]
    v_add_f32 v36, v104, v36
    v_add_f32 v37, v104, v37
    v_mfma_f32_16x16x32_bf16 v[68:71], a[52:55], a[16:19], v[68:71]
    ds_read_b128 a[0:3], v9 offset:61440
    v_add_f32 v38, v104, v38
    v_mfma_f32_16x16x32_bf16 v[68:71], a[40:43], a[20:23], v[68:71]
    s_waitcnt lgkmcnt(4)
    ds_read_b128 a[4:7], v9 offset:62464
    v_add_f32 v39, v104, v39
    v_mfma_f32_16x16x32_bf16 v[60:63], a[56:59], a[24:27], v[60:63]
    s_waitcnt lgkmcnt(4)
    ds_read_b128 a[8:11], v9 offset:63488
    v_rcp_f32 v36, v36
    v_mfma_f32_16x16x32_bf16 v[60:63], a[44:47], a[28:31], v[60:63]
    s_waitcnt lgkmcnt(4)
    ds_read_b128 a[12:15], v9 offset:64512
    v_rcp_f32 v37, v37
    v_mfma_f32_16x16x32_bf16 v[60:63], a[60:63], a[140:143], v[60:63]
    s_waitcnt lgkmcnt(4)
    buffer_load_dwordx4 v[252:255], v16, s[24:27], s73 offen offset:3072 sc1
    v_mfma_f32_16x16x32_bf16 v[60:63], a[64:67], a[152:155], v[60:63]
    v_rcp_f32 v38, v38
    v_mfma_f32_16x16x32_bf16 v[64:67], a[80:83], a[24:27], v[64:67]
    v_rcp_f32 v39, v39
    v_mfma_f32_16x16x32_bf16 v[64:67], a[68:71], a[28:31], v[64:67]
    v_mul_f32 v36, v36, v156
    v_mul_f32 v37, v37, v157
    v_mfma_f32_16x16x32_bf16 v[64:67], a[84:87], a[140:143], v[64:67]
    v_mul_f32 v38, v38, v158
    v_mul_f32 v39, v39, v159
    v_mfma_f32_16x16x32_bf16 v[64:67], a[72:75], a[152:155], v[64:67]
    v_cvt_pk_bf16_f32 v74, v36, v37
    v_cvt_pk_bf16_f32 v75, v38, v39
    v_mfma_f32_16x16x32_bf16 v[68:71], a[88:91], a[24:27], v[68:71]
    buffer_load_dwordx4 v[148:151], v16, s[24:27], s74 offen offset:0 sc1
    v_mfma_f32_16x16x32_bf16 v[68:71], a[76:79], a[28:31], v[68:71]
    v_fma_f32 v152, v143, v116, v128
    v_fma_f32 v153, v143, v117, v129
    v_mfma_f32_16x16x32_bf16 v[68:71], a[92:95], a[140:143], v[68:71]
    v_fma_f32 v154, v143, v118, v130
    v_fma_f32 v155, v143, v119, v131
    v_mfma_f32_16x16x32_bf16 v[68:71], a[96:99], a[152:155], v[68:71]
    s_waitcnt lgkmcnt(3)
    v_permlane16_swap_b32 v72, v74
    v_permlane16_swap_b32 v73, v75
    v_mfma_f32_16x16x32_bf16 v[60:63], a[112:115], a[0:3], v[60:63]
    s_waitcnt lgkmcnt(2)
    buffer_store_dwordx4 v[72:75], v0, s[24:27], s15 offen sc1
    v_mfma_f32_16x16x32_bf16 v[60:63], a[100:103], a[4:7], v[60:63]
    s_waitcnt lgkmcnt(1)
    v_fmac_f32 v152, v40, v142
    v_fmac_f32 v153, v41, v142
    v_mfma_f32_16x16x32_bf16 v[60:63], a[116:119], a[8:11], v[60:63]
    s_waitcnt lgkmcnt(0)
    v_fmac_f32 v154, v42, v142
    v_fmac_f32 v155, v43, v142
    v_mfma_f32_16x16x32_bf16 v[60:63], a[104:107], a[12:15], v[60:63]
    v_mul_f32 v40, v152, v152
    v_mul_f32 v41, v153, v153
    v_mfma_f32_16x16x32_bf16 v[64:67], a[120:123], a[0:3], v[64:67]
    v_mul_f32 v42, v154, v154
    v_mul_f32 v43, v155, v155
    v_mfma_f32_16x16x32_bf16 v[64:67], a[108:111], a[4:7], v[64:67]
    v_fma_f32 v40, v40, v110, v111
    v_fma_f32 v41, v41, v110, v111
    v_mfma_f32_16x16x32_bf16 v[64:67], a[124:127], a[8:11], v[64:67]
    v_fma_f32 v42, v42, v110, v111
    v_fma_f32 v43, v43, v110, v111
    v_mfma_f32_16x16x32_bf16 v[64:67], a[128:131], a[12:15], v[64:67]
    v_mul_f32 v40, v40, v152
    v_mul_f32 v41, v41, v153
    v_mfma_f32_16x16x32_bf16 v[68:71], a[144:147], a[0:3], v[68:71]
    v_mul_f32 v42, v42, v154
    v_mul_f32 v43, v43, v155
    v_mfma_f32_16x16x32_bf16 v[68:71], a[132:135], a[4:7], v[68:71]
    v_exp_f32 v40, v40
    v_mfma_f32_16x16x32_bf16 v[68:71], a[148:151], a[8:11], v[68:71]
    v_exp_f32 v41, v41
    v_mfma_f32_16x16x32_bf16 v[68:71], a[136:139], a[12:15], v[68:71]
    v_exp_f32 v42, v42
    v_exp_f32 v43, v43
    v_pk_add_f32 v[40:41], v[104:105], v[40:41] op_sel_hi:[0,1]
    v_pk_add_f32 v[42:43], v[104:105], v[42:43] op_sel_hi:[0,1]
    v_rcp_f32 v40, v40
    v_rcp_f32 v41, v41
    v_rcp_f32 v42, v42
    v_rcp_f32 v43, v43
    v_pk_mul_f32 v[40:41], v[40:41], v[152:153]
    v_pk_mul_f32 v[42:43], v[42:43], v[154:155]
    v_cvt_pk_bf16_f32 v78, v40, v41
    v_cvt_pk_bf16_f32 v79, v42, v43
    v_pk_fma_f32 v[156:157], v[142:143], v[120:121], v[132:133] op_sel:[1,0,0]
    v_pk_fma_f32 v[158:159], v[142:143], v[122:123], v[134:135] op_sel:[1,0,0]
    v_permlane16_swap_b32 v76, v78
    v_permlane16_swap_b32 v77, v79
    buffer_store_dwordx4 v[76:79], v0, s[24:27], s16 offen sc1
    v_pk_fma_f32 v[156:157], v[44:45], v[142:143], v[156:157] op_sel_hi:[1,0,1]
    v_pk_fma_f32 v[158:159], v[46:47], v[142:143], v[158:159] op_sel_hi:[1,0,1]
    v_pk_mul_f32 v[44:45], v[156:157], v[156:157]
    v_pk_mul_f32 v[46:47], v[158:159], v[158:159]
    v_pk_fma_f32 v[44:45], v[44:45], v[110:111], v[110:111] op_sel:[0,0,1] op_sel_hi:[1,0,1]
    v_pk_fma_f32 v[46:47], v[46:47], v[110:111], v[110:111] op_sel:[0,0,1] op_sel_hi:[1,0,1]
    v_pk_mul_f32 v[44:45], v[44:45], v[156:157]
    v_pk_mul_f32 v[46:47], v[46:47], v[158:159]
    v_exp_f32 v44, v44
    v_exp_f32 v45, v45
    v_exp_f32 v46, v46
    v_exp_f32 v47, v47
    v_pk_add_f32 v[44:45], v[104:105], v[44:45] op_sel_hi:[0,1]
    v_pk_add_f32 v[46:47], v[104:105], v[46:47] op_sel_hi:[0,1]
    v_rcp_f32 v44, v44
    v_rcp_f32 v45, v45
    v_rcp_f32 v46, v46
    v_rcp_f32 v47, v47
    v_pk_mul_f32 v[44:45], v[44:45], v[156:157]
    v_pk_mul_f32 v[46:47], v[46:47], v[158:159]
    v_cvt_pk_bf16_f32 v82, v44, v45
    v_cvt_pk_bf16_f32 v83, v46, v47
    v_pk_fma_f32 v[152:153], v[144:145], v[112:113], v[124:125] op_sel:[1,0,0]
    v_pk_fma_f32 v[154:155], v[144:145], v[114:115], v[126:127] op_sel:[1,0,0]
    v_permlane16_swap_b32 v80, v82
    v_permlane16_swap_b32 v81, v83
    buffer_store_dwordx4 v[80:83], v0, s[24:27], s17 offen sc1
    v_pk_fma_f32 v[152:153], v[48:49], v[144:145], v[152:153] op_sel_hi:[1,0,1]
    v_pk_fma_f32 v[154:155], v[50:51], v[144:145], v[154:155] op_sel_hi:[1,0,1]
    v_pk_mul_f32 v[48:49], v[152:153], v[152:153]
    v_pk_mul_f32 v[50:51], v[154:155], v[154:155]
    v_pk_fma_f32 v[48:49], v[48:49], v[110:111], v[110:111] op_sel:[0,0,1] op_sel_hi:[1,0,1]
    v_pk_fma_f32 v[50:51], v[50:51], v[110:111], v[110:111] op_sel:[0,0,1] op_sel_hi:[1,0,1]
    v_pk_mul_f32 v[48:49], v[48:49], v[152:153]
    v_pk_mul_f32 v[50:51], v[50:51], v[154:155]
    v_exp_f32 v48, v48
    v_exp_f32 v49, v49
    v_exp_f32 v50, v50
    v_exp_f32 v51, v51
    v_pk_add_f32 v[48:49], v[104:105], v[48:49] op_sel_hi:[0,1]
    v_pk_add_f32 v[50:51], v[104:105], v[50:51] op_sel_hi:[0,1]
    v_rcp_f32 v48, v48
    v_rcp_f32 v49, v49
    v_rcp_f32 v50, v50
    v_rcp_f32 v51, v51
    v_pk_mul_f32 v[48:49], v[48:49], v[152:153]
    v_pk_mul_f32 v[50:51], v[50:51], v[154:155]
    v_cvt_pk_bf16_f32 v72, v48, v49
    v_cvt_pk_bf16_f32 v73, v50, v51
    v_pk_fma_f32 v[156:157], v[144:145], v[116:117], v[128:129] op_sel:[1,0,0]
    v_pk_fma_f32 v[158:159], v[144:145], v[118:119], v[130:131] op_sel:[1,0,0]
    v_pk_fma_f32 v[156:157], v[52:53], v[144:145], v[156:157] op_sel_hi:[1,0,1]
    v_pk_fma_f32 v[158:159], v[54:55], v[144:145], v[158:159] op_sel_hi:[1,0,1]
    v_pk_mul_f32 v[52:53], v[156:157], v[156:157]
    v_pk_mul_f32 v[54:55], v[158:159], v[158:159]
    v_pk_fma_f32 v[52:53], v[52:53], v[110:111], v[110:111] op_sel:[0,0,1] op_sel_hi:[1,0,1]
    v_pk_fma_f32 v[54:55], v[54:55], v[110:111], v[110:111] op_sel:[0,0,1] op_sel_hi:[1,0,1]
    v_pk_mul_f32 v[52:53], v[52:53], v[156:157]
    v_pk_mul_f32 v[54:55], v[54:55], v[158:159]
    v_exp_f32 v52, v52
    v_exp_f32 v53, v53
    v_exp_f32 v54, v54
    v_exp_f32 v55, v55
    v_pk_add_f32 v[52:53], v[104:105], v[52:53] op_sel_hi:[0,1]
    v_pk_add_f32 v[54:55], v[104:105], v[54:55] op_sel_hi:[0,1]
    v_rcp_f32 v52, v52
    v_rcp_f32 v53, v53
    v_rcp_f32 v54, v54
    v_rcp_f32 v55, v55
    v_pk_mul_f32 v[52:53], v[52:53], v[156:157]
    v_pk_mul_f32 v[54:55], v[54:55], v[158:159]
    v_cvt_pk_bf16_f32 v76, v52, v53
    v_cvt_pk_bf16_f32 v77, v54, v55
    v_pk_fma_f32 v[152:153], v[144:145], v[120:121], v[132:133] op_sel:[1,0,0]
    v_pk_fma_f32 v[154:155], v[144:145], v[122:123], v[134:135] op_sel:[1,0,0]
    v_pk_fma_f32 v[152:153], v[56:57], v[144:145], v[152:153] op_sel_hi:[1,0,1]
    v_pk_fma_f32 v[154:155], v[58:59], v[144:145], v[154:155] op_sel_hi:[1,0,1]
    v_pk_mul_f32 v[56:57], v[152:153], v[152:153]
    v_pk_mul_f32 v[58:59], v[154:155], v[154:155]
    v_pk_fma_f32 v[56:57], v[56:57], v[110:111], v[110:111] op_sel:[0,0,1] op_sel_hi:[1,0,1]
    v_pk_fma_f32 v[58:59], v[58:59], v[110:111], v[110:111] op_sel:[0,0,1] op_sel_hi:[1,0,1]
    v_pk_mul_f32 v[56:57], v[56:57], v[152:153]
    v_pk_mul_f32 v[58:59], v[58:59], v[154:155]
    v_exp_f32 v56, v56
    v_exp_f32 v57, v57
    v_exp_f32 v58, v58
    v_exp_f32 v59, v59
    v_pk_add_f32 v[56:57], v[104:105], v[56:57] op_sel_hi:[0,1]
    v_pk_add_f32 v[58:59], v[104:105], v[58:59] op_sel_hi:[0,1]
    v_rcp_f32 v56, v56
    v_rcp_f32 v57, v57
    v_rcp_f32 v58, v58
    v_rcp_f32 v59, v59
    v_pk_mul_f32 v[56:57], v[56:57], v[152:153]
    v_pk_mul_f32 v[58:59], v[58:59], v[154:155]
    v_cvt_pk_bf16_f32 v80, v56, v57
    v_cvt_pk_bf16_f32 v81, v58, v59
    v_pk_fma_f32 v[156:157], v[146:147], v[112:113], v[124:125] op_sel:[1,0,0]
    v_pk_fma_f32 v[158:159], v[146:147], v[114:115], v[126:127] op_sel:[1,0,0]
    v_pk_fma_f32 v[156:157], v[60:61], v[146:147], v[156:157] op_sel_hi:[1,0,1]
    v_pk_fma_f32 v[158:159], v[62:63], v[146:147], v[158:159] op_sel_hi:[1,0,1]
    v_pk_mul_f32 v[60:61], v[156:157], v[156:157]
    v_pk_mul_f32 v[62:63], v[158:159], v[158:159]
    v_pk_fma_f32 v[60:61], v[60:61], v[110:111], v[110:111] op_sel:[0,0,1] op_sel_hi:[1,0,1]
    v_pk_fma_f32 v[62:63], v[62:63], v[110:111], v[110:111] op_sel:[0,0,1] op_sel_hi:[1,0,1]
    v_pk_mul_f32 v[60:61], v[60:61], v[156:157]
    v_pk_mul_f32 v[62:63], v[62:63], v[158:159]
    v_exp_f32 v60, v60
    v_exp_f32 v61, v61
    v_exp_f32 v62, v62
    v_exp_f32 v63, v63
    v_pk_add_f32 v[60:61], v[104:105], v[60:61] op_sel_hi:[0,1]
    v_pk_add_f32 v[62:63], v[104:105], v[62:63] op_sel_hi:[0,1]
    v_rcp_f32 v60, v60
    v_rcp_f32 v61, v61
    v_rcp_f32 v62, v62
    v_rcp_f32 v63, v63
    v_pk_mul_f32 v[60:61], v[60:61], v[156:157]
    v_pk_mul_f32 v[62:63], v[62:63], v[158:159]
    v_cvt_pk_bf16_f32 v74, v60, v61
    v_cvt_pk_bf16_f32 v75, v62, v63
    v_pk_fma_f32 v[152:153], v[146:147], v[116:117], v[128:129] op_sel:[1,0,0]
    v_pk_fma_f32 v[154:155], v[146:147], v[118:119], v[130:131] op_sel:[1,0,0]
    v_permlane16_swap_b32 v72, v74
    v_permlane16_swap_b32 v73, v75
    buffer_store_dwordx4 v[72:75], v10, s[24:27], s15 offen sc1
    v_pk_fma_f32 v[152:153], v[64:65], v[146:147], v[152:153] op_sel_hi:[1,0,1]
    v_pk_fma_f32 v[154:155], v[66:67], v[146:147], v[154:155] op_sel_hi:[1,0,1]
    v_pk_mul_f32 v[64:65], v[152:153], v[152:153]
    v_pk_mul_f32 v[66:67], v[154:155], v[154:155]
    v_pk_fma_f32 v[64:65], v[64:65], v[110:111], v[110:111] op_sel:[0,0,1] op_sel_hi:[1,0,1]
    v_pk_fma_f32 v[66:67], v[66:67], v[110:111], v[110:111] op_sel:[0,0,1] op_sel_hi:[1,0,1]
    v_pk_mul_f32 v[64:65], v[64:65], v[152:153]
    v_pk_mul_f32 v[66:67], v[66:67], v[154:155]
    v_exp_f32 v64, v64
    v_exp_f32 v65, v65
    v_exp_f32 v66, v66
    v_exp_f32 v67, v67
    v_pk_add_f32 v[64:65], v[104:105], v[64:65] op_sel_hi:[0,1]
    v_pk_add_f32 v[66:67], v[104:105], v[66:67] op_sel_hi:[0,1]
    v_rcp_f32 v64, v64
    v_rcp_f32 v65, v65
    v_rcp_f32 v66, v66
    v_rcp_f32 v67, v67
    v_pk_mul_f32 v[64:65], v[64:65], v[152:153]
    v_pk_mul_f32 v[66:67], v[66:67], v[154:155]
    v_cvt_pk_bf16_f32 v78, v64, v65
    v_cvt_pk_bf16_f32 v79, v66, v67
    v_pk_fma_f32 v[156:157], v[146:147], v[120:121], v[132:133] op_sel:[1,0,0]
    v_pk_fma_f32 v[158:159], v[146:147], v[122:123], v[134:135] op_sel:[1,0,0]
    v_permlane16_swap_b32 v76, v78
    v_permlane16_swap_b32 v77, v79
    buffer_store_dwordx4 v[76:79], v10, s[24:27], s16 offen sc1
    v_pk_fma_f32 v[156:157], v[68:69], v[146:147], v[156:157] op_sel_hi:[1,0,1]
    v_pk_fma_f32 v[158:159], v[70:71], v[146:147], v[158:159] op_sel_hi:[1,0,1]
    v_pk_mul_f32 v[68:69], v[156:157], v[156:157]
    v_pk_mul_f32 v[70:71], v[158:159], v[158:159]
    v_pk_fma_f32 v[68:69], v[68:69], v[110:111], v[110:111] op_sel:[0,0,1] op_sel_hi:[1,0,1]
    v_pk_fma_f32 v[70:71], v[70:71], v[110:111], v[110:111] op_sel:[0,0,1] op_sel_hi:[1,0,1]
    v_pk_mul_f32 v[68:69], v[68:69], v[156:157]
    v_pk_mul_f32 v[70:71], v[70:71], v[158:159]
    v_exp_f32 v68, v68
    v_exp_f32 v69, v69
    v_exp_f32 v70, v70
    v_exp_f32 v71, v71
    v_pk_add_f32 v[68:69], v[104:105], v[68:69] op_sel_hi:[0,1]
    v_pk_add_f32 v[70:71], v[104:105], v[70:71] op_sel_hi:[0,1]
    v_rcp_f32 v68, v68
    v_rcp_f32 v69, v69
    v_rcp_f32 v70, v70
    v_rcp_f32 v71, v71
    v_pk_mul_f32 v[68:69], v[68:69], v[156:157]
    v_pk_mul_f32 v[70:71], v[70:71], v[158:159]
    v_cvt_pk_bf16_f32 v82, v68, v69
    v_cvt_pk_bf16_f32 v83, v70, v71
    s_nop 0
    v_permlane16_swap_b32 v80, v82
    v_permlane16_swap_b32 v81, v83
    buffer_store_dwordx4 v[80:83], v10, s[24:27], s17 offen sc1
    s_mul_i32 s53, s61, 176128
    s_add_u32 s53, s53, 0x500000
    v_xor_b32 v3, s55, v12
    v_add_u32 v3, s53, v3
    v_xor_b32 v4, s55, v13
    v_add_u32 v4, s53, v4
    v_xor_b32 v5, s55, v14
    v_add_u32 v5, s53, v5
    v_xor_b32 v6, s55, v15
    v_add_u32 v6, s53, v6
    v_lshlrev_b32 v136, 16, v228
    v_and_b32 v137, 0xffff0000, v228
    v_pk_fma_f32 v[88:89], v[236:237], v[136:137], v[88:89]
    v_lshlrev_b32 v136, 16, v229
    v_and_b32 v137, 0xffff0000, v229
    v_pk_fma_f32 v[90:91], v[238:239], v[136:137], v[90:91]
    v_lshlrev_b32 v136, 16, v230
    v_and_b32 v137, 0xffff0000, v230
    v_pk_fma_f32 v[92:93], v[240:241], v[136:137], v[92:93]
    v_lshlrev_b32 v136, 16, v231
    v_and_b32 v137, 0xffff0000, v231
    v_pk_fma_f32 v[94:95], v[242:243], v[136:137], v[94:95]
    v_lshlrev_b32 v136, 16, v232
    v_and_b32 v137, 0xffff0000, v232
    v_pk_fma_f32 v[96:97], v[244:245], v[136:137], v[96:97]
    v_lshlrev_b32 v136, 16, v233
    v_and_b32 v137, 0xffff0000, v233
    v_pk_fma_f32 v[98:99], v[246:247], v[136:137], v[98:99]
    v_lshlrev_b32 v136, 16, v234
    v_and_b32 v137, 0xffff0000, v234
    v_pk_fma_f32 v[100:101], v[248:249], v[136:137], v[100:101]
    v_lshlrev_b32 v136, 16, v235
    v_and_b32 v137, 0xffff0000, v235
    v_pk_fma_f32 v[102:103], v[250:251], v[136:137], v[102:103]
    s_add_u32 s45, s66, 7
    v_mov_b32 v23, s66
    v_mov_b32 v22, s45
    s_mov_b64 exec, 1
    s_waitcnt vmcnt(0)
    s_barrier
    buffer_store_dwordx2 v[22:23], v2, s[24:27], s41 offen sc1
    s_mov_b64 exec, -1
    s_cmp_lg_u32 s50, 7264
    s_cbranch_scc1 L_tag_done
    v_and_b32 v24, 7, v1
    v_lshlrev_b32 v24, 7, v24
    s_mov_b32 s49, 0x80000
    s_add_u32 s45, s66, 6
L_poll_13:
    buffer_load_dwordx2 v[26:27], v24, s[24:27], 0 offen sc1
    s_sub_u32 s49, s49, 1
    s_waitcnt vmcnt(0)
    s_cbranch_scc1 L_polled_14
L_ptest_15:
    v_subrev_u32 v26, s45, v26
    v_lshrrev_b32 v26, 3, v26
    v_bitop3_b32 v26, v27, s66, v26 bitop3:0xbe
    v_cmp_ne_u32 vcc, 0, v26
    s_cbranch_vccnz L_poll_13
L_polled_14:
    v_mov_b32 v24, s66
    s_mov_b32 s53, 0x50000
    s_mov_b64 exec, 1
    buffer_store_dword v24, v2, s[24:27], s53 offen sc1
    s_mov_b64 exec, -1
L_tag_done:
    buffer_load_dwordx4 a[180:183], v16, s[24:27], s74 offen offset:1024 sc1
    buffer_load_dwordx4 a[184:187], v16, s[24:27], s74 offen offset:2048 sc1
    buffer_load_dwordx4 a[188:191], v16, s[24:27], s74 offen offset:3072 sc1
    buffer_load_dwordx4 a[192:195], v16, s[24:27], s75 offen offset:0 sc1
    buffer_load_dwordx4 a[196:199], v16, s[24:27], s75 offen offset:1024 sc1
    buffer_load_dwordx4 a[200:203], v16, s[24:27], s75 offen offset:2048 sc1
    buffer_load_dwordx4 a[204:207], v16, s[24:27], s75 offen offset:3072 sc1
    buffer_load_dwordx4 a[208:211], v16, s[24:27], s76 offen offset:0 sc1
    buffer_load_dwordx4 a[212:215], v16, s[24:27], s76 offen offset:1024 sc1
    buffer_load_dwordx4 a[216:219], v16, s[24:27], s76 offen offset:2048 sc1
    buffer_load_dwordx4 a[220:223], v16, s[24:27], s76 offen offset:3072 sc1
    s_mov_b32 s49, 0x80000
    s_add_u32 s45, s66, 7
    buffer_load_dwordx2 v[22:23], v21, s[24:27], 0 offen sc1
    buffer_load_dwordx4 a[224:227], v16, s[24:27], s77 offen offset:0 sc1
    buffer_load_dwordx4 a[228:231], v16, s[24:27], s77 offen offset:1024 sc1
    buffer_load_dwordx4 a[232:235], v16, s[24:27], s77 offen offset:2048 sc1
    buffer_load_dwordx4 a[236:239], v16, s[24:27], s77 offen offset:3072 sc1
    buffer_load_dwordx4 a[240:243], v16, s[24:27], s78 offen offset:0 sc1
    buffer_load_dwordx4 a[244:247], v16, s[24:27], s78 offen offset:1024 sc1
    buffer_load_dwordx4 a[248:251], v16, s[24:27], s78 offen offset:2048 sc1
    buffer_load_dwordx4 a[252:255], v16, s[24:27], s78 offen offset:3072 sc1
    s_waitcnt vmcnt(8)
    s_branch L_ptest_18
L_poll_16:
    buffer_load_dwordx2 v[22:23], v21, s[24:27], 0 offen sc1
    s_sub_u32 s49, s49, 1
    s_waitcnt vmcnt(0)
    s_cbranch_scc1 L_polled_17
L_ptest_18:
    v_subrev_u32 v22, s45, v22
    v_lshrrev_b32 v22, 3, v22
    v_bitop3_b32 v22, v23, s66, v22 bitop3:0xbe
    v_cmp_ne_u32 vcc, 0, v22
    s_cbranch_vccnz L_poll_16
L_polled_17:
    buffer_load_dwordx4 a[32:35], v3, s[24:27], s68 offen sc1
    buffer_load_dwordx4 a[48:51], v3, s[24:27], s69 offen sc1
    buffer_load_dwordx4 a[36:39], v3, s[24:27], s70 offen sc1
    buffer_load_dwordx4 a[52:55], v3, s[24:27], s71 offen sc1
    buffer_load_dwordx4 a[40:43], v3, s[24:27], s72 offen sc1
    buffer_load_dwordx4 a[56:59], v3, s[24:27], s73 offen sc1
    buffer_load_dwordx4 a[44:47], v3, s[24:27], s74 offen sc1
    buffer_load_dwordx4 a[60:63], v3, s[24:27], s75 offen sc1
    buffer_load_dwordx4 a[64:67], v3, s[24:27], s76 offen sc1
    buffer_load_dwordx4 a[80:83], v3, s[24:27], s77 offen sc1
    s_waitcnt vmcnt(9)
    v_mfma_f32_16x16x32_bf16 v[24:27], a[156:159], a[32:35], 0
    buffer_load_dwordx4 v[152:155], v3, s[24:27], s78 offen sc1
    v_mfma_f32_16x16x32_bf16 v[40:43], a[160:163], a[32:35], 0
    v_mfma_f32_16x16x32_bf16 v[56:59], a[164:167], a[32:35], 0
    v_mfma_f32_16x16x32_bf16 v[72:75], a[168:171], a[32:35], 0
    s_waitcnt vmcnt(9)
    v_mfma_f32_16x16x32_bf16 v[24:27], a[172:175], a[48:51], v[24:27]
    s_waitcnt vmcnt(8)
    buffer_load_dwordx4 v[156:159], v4, s[24:27], s68 offen sc1
    v_mfma_f32_16x16x32_bf16 v[24:27], v[168:171], a[36:39], v[24:27]
    v_mfma_f32_16x16x32_bf16 v[40:43], a[176:179], a[48:51], v[40:43]
    v_mfma_f32_16x16x32_bf16 v[40:43], v[172:175], a[36:39], v[40:43]
    v_mfma_f32_16x16x32_bf16 v[56:59], v[160:163], a[48:51], v[56:59]
    buffer_load_dwordx4 a[68:71], v4, s[24:27], s69 offen sc1
    v_mfma_f32_16x16x32_bf16 v[56:59], v[176:179], a[36:39], v[56:59]
    v_mfma_f32_16x16x32_bf16 v[72:75], v[164:167], a[48:51], v[72:75]
    v_mfma_f32_16x16x32_bf16 v[72:75], v[180:183], a[36:39], v[72:75]
    s_waitcnt vmcnt(9)
    v_mfma_f32_16x16x32_bf16 v[24:27], v[184:187], a[52:55], v[24:27]
    s_waitcnt vmcnt(8)
    buffer_load_dwordx4 a[84:87], v4, s[24:27], s70 offen sc1
    v_mfma_f32_16x16x32_bf16 v[24:27], v[200:203], a[40:43], v[24:27]
    v_mfma_f32_16x16x32_bf16 v[40:43], v[188:191], a[52:55], v[40:43]
    v_mfma_f32_16x16x32_bf16 v[40:43], v[204:207], a[40:43], v[40:43]
    v_mfma_f32_16x16x32_bf16 v[56:59], v[192:195], a[52:55], v[56:59]
    buffer_load_dwordx4 a[72:75], v4, s[24:27], s71 offen sc1
    v_mfma_f32_16x16x32_bf16 v[56:59], v[208:211], a[40:43], v[56:59]
    v_mfma_f32_16x16x32_bf16 v[72:75], v[196:199], a[52:55], v[72:75]
    v_mfma_f32_16x16x32_bf16 v[72:75], v[212:215], a[40:43], v[72:75]
    s_waitcnt vmcnt(9)
    v_mfma_f32_16x16x32_bf16 v[24:27], v[216:219], a[56:59], v[24:27]
    s_waitcnt vmcnt(8)
    buffer_load_dwordx4 a[88:91], v4, s[24:27], s72 offen sc1
    v_mfma_f32_16x16x32_bf16 v[24:27], v[148:151], a[44:47], v[24:27]
    v_mfma_f32_16x16x32_bf16 v[40:43], v[220:223], a[56:59], v[40:43]
    v_mfma_f32_16x16x32_bf16 v[40:43], a[180:183], a[44:47], v[40:43]
    v_mfma_f32_16x16x32_bf16 v[56:59], v[224:227], a[56:59], v[56:59]
    buffer_load_dwordx4 a[76:79], v4, s[24:27], s73 offen sc1
    v_mfma_f32_16x16x32_bf16 v[56:59], a[184:187], a[44:47], v[56:59]
    v_mfma_f32_16x16x32_bf16 v[72:75], v[252:255], a[56:59], v[72:75]
    v_mfma_f32_16x16x32_bf16 v[72:75], a[188:191], a[44:47], v[72:75]
    s_waitcnt vmcnt(9)
    v_mfma_f32_16x16x32_bf16 v[24:27], a[192:195], a[60:63], v[24:27]
    s_waitcnt vmcnt(8)
    buffer_load_dwordx4 a[92:95], v4, s[24:27], s74 offen sc1
    v_mfma_f32_16x16x32_bf16 v[24:27], a[208:211], a[64:67], v[24:27]
    v_mfma_f32_16x16x32_bf16 v[40:43], a[196:199], a[60:63], v[40:43]
    v_mfma_f32_16x16x32_bf16 v[40:43], a[212:215], a[64:67], v[40:43]
    v_mfma_f32_16x16x32_bf16 v[56:59], a[200:203], a[60:63], v[56:59]
    buffer_load_dwordx4 a[96:99], v4, s[24:27], s75 offen sc1
    v_mfma_f32_16x16x32_bf16 v[56:59], a[216:219], a[64:67], v[56:59]
    v_mfma_f32_16x16x32_bf16 v[72:75], a[204:207], a[60:63], v[72:75]
    v_mfma_f32_16x16x32_bf16 v[72:75], a[220:223], a[64:67], v[72:75]
    s_waitcnt vmcnt(9)
    v_mfma_f32_16x16x32_bf16 v[24:27], a[224:227], a[80:83], v[24:27]
    s_waitcnt vmcnt(8)
    buffer_load_dwordx4 a[112:115], v4, s[24:27], s76 offen sc1
    v_mfma_f32_16x16x32_bf16 v[24:27], a[240:243], v[152:155], v[24:27]
    v_mfma_f32_16x16x32_bf16 v[40:43], a[228:231], a[80:83], v[40:43]
    v_mfma_f32_16x16x32_bf16 v[40:43], a[244:247], v[152:155], v[40:43]
    v_mfma_f32_16x16x32_bf16 v[56:59], a[232:235], a[80:83], v[56:59]
    buffer_load_dwordx4 a[100:103], v4, s[24:27], s77 offen sc1
    v_mfma_f32_16x16x32_bf16 v[56:59], a[248:251], v[152:155], v[56:59]
    v_mfma_f32_16x16x32_bf16 v[72:75], a[236:239], a[80:83], v[72:75]
    v_mfma_f32_16x16x32_bf16 v[72:75], a[252:255], v[152:155], v[72:75]
    s_waitcnt vmcnt(9)
    v_mfma_f32_16x16x32_bf16 v[28:31], a[156:159], v[156:159], 0
    buffer_load_dwordx4 v[152:155], v4, s[24:27], s78 offen sc1
    v_mfma_f32_16x16x32_bf16 v[44:47], a[160:163], v[156:159], 0
    ds_write_b128 v12, v[24:27] offset:0
    v_mfma_f32_16x16x32_bf16 v[60:63], a[164:167], v[156:159], 0
    v_mfma_f32_16x16x32_bf16 v[76:79], a[168:171], v[156:159], 0
    s_waitcnt vmcnt(9)
    ds_write_b128 v12, v[40:43] offset:4096
    v_mfma_f32_16x16x32_bf16 v[28:31], a[172:175], a[68:71], v[28:31]
    s_waitcnt vmcnt(8)
    buffer_load_dwordx4 v[156:159], v5, s[24:27], s68 offen sc1
    v_mfma_f32_16x16x32_bf16 v[28:31], v[168:171], a[84:87], v[28:31]
    ds_write_b128 v12, v[56:59] offset:8192
    v_mfma_f32_16x16x32_bf16 v[44:47], a[176:179], a[68:71], v[44:47]
    v_mfma_f32_16x16x32_bf16 v[44:47], v[172:175], a[84:87], v[44:47]
    ds_write_b128 v12, v[72:75] offset:12288
    v_mfma_f32_16x16x32_bf16 v[60:63], v[160:163], a[68:71], v[60:63]
    buffer_load_dwordx4 a[116:119], v5, s[24:27], s69 offen sc1
    v_mfma_f32_16x16x32_bf16 v[60:63], v[176:179], a[84:87], v[60:63]
    v_mfma_f32_16x16x32_bf16 v[76:79], v[164:167], a[68:71], v[76:79]
    v_mfma_f32_16x16x32_bf16 v[76:79], v[180:183], a[84:87], v[76:79]
    s_waitcnt vmcnt(9)
    v_mfma_f32_16x16x32_bf16 v[28:31], v[184:187], a[72:75], v[28:31]
    s_waitcnt vmcnt(8)
    buffer_load_dwordx4 a[104:107], v5, s[24:27], s70 offen sc1
    v_mfma_f32_16x16x32_bf16 v[28:31], v[200:203], a[88:91], v[28:31]
    v_mfma_f32_16x16x32_bf16 v[44:47], v[188:191], a[72:75], v[44:47]
    v_mfma_f32_16x16x32_bf16 v[44:47], v[204:207], a[88:91], v[44:47]
    v_mfma_f32_16x16x32_bf16 v[60:63], v[192:195], a[72:75], v[60:63]
    buffer_load_dwordx4 a[120:123], v5, s[24:27], s71 offen sc1
    v_mfma_f32_16x16x32_bf16 v[60:63], v[208:211], a[88:91], v[60:63]
    v_mfma_f32_16x16x32_bf16 v[76:79], v[196:199], a[72:75], v[76:79]
    v_mfma_f32_16x16x32_bf16 v[76:79], v[212:215], a[88:91], v[76:79]
    s_waitcnt vmcnt(9)
    v_mfma_f32_16x16x32_bf16 v[28:31], v[216:219], a[76:79], v[28:31]
    s_waitcnt vmcnt(8)
    buffer_load_dwordx4 a[108:111], v5, s[24:27], s72 offen sc1
    v_mfma_f32_16x16x32_bf16 v[28:31], v[148:151], a[92:95], v[28:31]
    v_mfma_f32_16x16x32_bf16 v[44:47], v[220:223], a[76:79], v[44:47]
    v_mfma_f32_16x16x32_bf16 v[44:47], a[180:183], a[92:95], v[44:47]
    v_mfma_f32_16x16x32_bf16 v[60:63], v[224:227], a[76:79], v[60:63]
    buffer_load_dwordx4 a[124:127], v5, s[24:27], s73 offen sc1
    v_mfma_f32_16x16x32_bf16 v[60:63], a[184:187], a[92:95], v[60:63]
    v_mfma_f32_16x16x32_bf16 v[76:79], v[252:255], a[76:79], v[76:79]
    v_mfma_f32_16x16x32_bf16 v[76:79], a[188:191], a[92:95], v[76:79]
    s_waitcnt vmcnt(9)
    v_mfma_f32_16x16x32_bf16 v[28:31], a[192:195], a[96:99], v[28:31]
    s_waitcnt vmcnt(8)
    buffer_load_dwordx4 a[128:131], v5, s[24:27], s74 offen sc1
    v_mfma_f32_16x16x32_bf16 v[28:31], a[208:211], a[112:115], v[28:31]
    v_mfma_f32_16x16x32_bf16 v[44:47], a[196:199], a[96:99], v[44:47]
    v_mfma_f32_16x16x32_bf16 v[44:47], a[212:215], a[112:115], v[44:47]
    v_mfma_f32_16x16x32_bf16 v[60:63], a[200:203], a[96:99], v[60:63]
    buffer_load_dwordx4 a[144:147], v5, s[24:27], s75 offen sc1
    v_mfma_f32_16x16x32_bf16 v[60:63], a[216:219], a[112:115], v[60:63]
    v_mfma_f32_16x16x32_bf16 v[76:79], a[204:207], a[96:99], v[76:79]
    v_mfma_f32_16x16x32_bf16 v[76:79], a[220:223], a[112:115], v[76:79]
    s_waitcnt vmcnt(9)
    v_mfma_f32_16x16x32_bf16 v[28:31], a[224:227], a[100:103], v[28:31]
    s_waitcnt vmcnt(8)
    buffer_load_dwordx4 a[132:135], v5, s[24:27], s76 offen sc1
    v_mfma_f32_16x16x32_bf16 v[28:31], a[240:243], v[152:155], v[28:31]
    v_mfma_f32_16x16x32_bf16 v[44:47], a[228:231], a[100:103], v[44:47]
    v_mfma_f32_16x16x32_bf16 v[44:47], a[244:247], v[152:155], v[44:47]
    v_mfma_f32_16x16x32_bf16 v[60:63], a[232:235], a[100:103], v[60:63]
    buffer_load_dwordx4 a[148:151], v5, s[24:27], s77 offen sc1
    v_mfma_f32_16x16x32_bf16 v[60:63], a[248:251], v[152:155], v[60:63]
    v_mfma_f32_16x16x32_bf16 v[76:79], a[236:239], a[100:103], v[76:79]
    v_mfma_f32_16x16x32_bf16 v[76:79], a[252:255], v[152:155], v[76:79]
    s_waitcnt vmcnt(9)
    v_mfma_f32_16x16x32_bf16 v[32:35], a[156:159], v[156:159], 0
    buffer_load_dwordx4 v[152:155], v5, s[24:27], s78 offen sc1
    v_mfma_f32_16x16x32_bf16 v[48:51], a[160:163], v[156:159], 0
    ds_write_b128 v13, v[28:31] offset:16384
    v_mfma_f32_16x16x32_bf16 v[64:67], a[164:167], v[156:159], 0
    v_mfma_f32_16x16x32_bf16 v[80:83], a[168:171], v[156:159], 0
    s_waitcnt vmcnt(9)
    ds_write_b128 v13, v[44:47] offset:20480
    v_mfma_f32_16x16x32_bf16 v[32:35], a[172:175], a[116:119], v[32:35]
    s_waitcnt vmcnt(8)
    buffer_load_dwordx4 v[156:159], v6, s[24:27], s68 offen sc1
    v_mfma_f32_16x16x32_bf16 v[32:35], v[168:171], a[104:107], v[32:35]
    ds_write_b128 v13, v[60:63] offset:24576
    v_mfma_f32_16x16x32_bf16 v[48:51], a[176:179], a[116:119], v[48:51]
    v_mfma_f32_16x16x32_bf16 v[48:51], v[172:175], a[104:107], v[48:51]
    ds_write_b128 v13, v[76:79] offset:28672
    v_mfma_f32_16x16x32_bf16 v[64:67], v[160:163], a[116:119], v[64:67]
    buffer_load_dwordx4 a[136:139], v6, s[24:27], s69 offen sc1
    v_mfma_f32_16x16x32_bf16 v[64:67], v[176:179], a[104:107], v[64:67]
    v_mfma_f32_16x16x32_bf16 v[80:83], v[164:167], a[116:119], v[80:83]
    v_mfma_f32_16x16x32_bf16 v[80:83], v[180:183], a[104:107], v[80:83]
    s_waitcnt vmcnt(9)
    v_mfma_f32_16x16x32_bf16 v[32:35], v[184:187], a[120:123], v[32:35]
    s_waitcnt vmcnt(8)
    buffer_load_dwordx4 a[0:3], v6, s[24:27], s70 offen sc1
    v_mfma_f32_16x16x32_bf16 v[32:35], v[200:203], a[108:111], v[32:35]
    v_mfma_f32_16x16x32_bf16 v[48:51], v[188:191], a[120:123], v[48:51]
    v_mfma_f32_16x16x32_bf16 v[48:51], v[204:207], a[108:111], v[48:51]
    v_mfma_f32_16x16x32_bf16 v[64:67], v[192:195], a[120:123], v[64:67]
    buffer_load_dwordx4 a[4:7], v6, s[24:27], s71 offen sc1
    v_mfma_f32_16x16x32_bf16 v[64:67], v[208:211], a[108:111], v[64:67]
    v_mfma_f32_16x16x32_bf16 v[80:83], v[196:199], a[120:123], v[80:83]
    v_mfma_f32_16x16x32_bf16 v[80:83], v[212:215], a[108:111], v[80:83]
    s_waitcnt vmcnt(9)
    v_mfma_f32_16x16x32_bf16 v[32:35], v[216:219], a[124:127], v[32:35]
    s_waitcnt vmcnt(8)
    buffer_load_dwordx4 a[8:11], v6, s[24:27], s72 offen sc1
    v_mfma_f32_16x16x32_bf16 v[32:35], v[148:151], a[128:131], v[32:35]
    v_mfma_f32_16x16x32_bf16 v[48:51], v[220:223], a[124:127], v[48:51]
    v_mfma_f32_16x16x32_bf16 v[48:51], a[180:183], a[128:131], v[48:51]
    v_mfma_f32_16x16x32_bf16 v[64:67], v[224:227], a[124:127], v[64:67]
    buffer_load_dwordx4 a[12:15], v6, s[24:27], s73 offen sc1
    v_mfma_f32_16x16x32_bf16 v[64:67], a[184:187], a[128:131], v[64:67]
    v_mfma_f32_16x16x32_bf16 v[80:83], v[252:255], a[124:127], v[80:83]
    v_mfma_f32_16x16x32_bf16 v[80:83], a[188:191], a[128:131], v[80:83]
    s_waitcnt vmcnt(9)
    v_mfma_f32_16x16x32_bf16 v[32:35], a[192:195], a[144:147], v[32:35]
    s_waitcnt vmcnt(8)
    buffer_load_dwordx4 a[16:19], v6, s[24:27], s74 offen sc1
    v_mfma_f32_16x16x32_bf16 v[32:35], a[208:211], a[132:135], v[32:35]
    v_mfma_f32_16x16x32_bf16 v[48:51], a[196:199], a[144:147], v[48:51]
    v_mfma_f32_16x16x32_bf16 v[48:51], a[212:215], a[132:135], v[48:51]
    v_mfma_f32_16x16x32_bf16 v[64:67], a[200:203], a[144:147], v[64:67]
    buffer_load_dwordx4 a[20:23], v6, s[24:27], s75 offen sc1
    v_mfma_f32_16x16x32_bf16 v[64:67], a[216:219], a[132:135], v[64:67]
    v_mfma_f32_16x16x32_bf16 v[80:83], a[204:207], a[144:147], v[80:83]
    v_mfma_f32_16x16x32_bf16 v[80:83], a[220:223], a[132:135], v[80:83]
    s_waitcnt vmcnt(9)
    v_mfma_f32_16x16x32_bf16 v[32:35], a[224:227], a[148:151], v[32:35]
    s_waitcnt vmcnt(8)
    buffer_load_dwordx4 a[24:27], v6, s[24:27], s76 offen sc1
    v_mfma_f32_16x16x32_bf16 v[32:35], a[240:243], v[152:155], v[32:35]
    v_mfma_f32_16x16x32_bf16 v[48:51], a[228:231], a[148:151], v[48:51]
    v_mfma_f32_16x16x32_bf16 v[48:51], a[244:247], v[152:155], v[48:51]
    v_mfma_f32_16x16x32_bf16 v[64:67], a[232:235], a[148:151], v[64:67]
    buffer_load_dwordx4 a[28:31], v6, s[24:27], s77 offen sc1
    v_mfma_f32_16x16x32_bf16 v[64:67], a[248:251], v[152:155], v[64:67]
    v_mfma_f32_16x16x32_bf16 v[80:83], a[236:239], a[148:151], v[80:83]
    v_mfma_f32_16x16x32_bf16 v[80:83], a[252:255], v[152:155], v[80:83]
    s_waitcnt vmcnt(9)
    v_mfma_f32_16x16x32_bf16 v[36:39], a[156:159], v[156:159], 0
    buffer_load_dwordx4 v[152:155], v6, s[24:27], s78 offen sc1
    v_mfma_f32_16x16x32_bf16 v[52:55], a[160:163], v[156:159], 0
    ds_write_b128 v14, v[32:35] offset:32768
    v_mfma_f32_16x16x32_bf16 v[68:71], a[164:167], v[156:159], 0
    v_mfma_f32_16x16x32_bf16 v[84:87], a[168:171], v[156:159], 0
    s_waitcnt vmcnt(9)
    ds_write_b128 v14, v[48:51] offset:36864
    v_mfma_f32_16x16x32_bf16 v[36:39], a[172:175], a[136:139], v[36:39]
    s_waitcnt vmcnt(8)
    v_mfma_f32_16x16x32_bf16 v[36:39], v[168:171], a[0:3], v[36:39]
    ds_write_b128 v14, v[64:67] offset:40960
    v_mfma_f32_16x16x32_bf16 v[52:55], a[176:179], a[136:139], v[52:55]
    v_mfma_f32_16x16x32_bf16 v[52:55], v[172:175], a[0:3], v[52:55]
    ds_write_b128 v14, v[80:83] offset:45056
    v_mfma_f32_16x16x32_bf16 v[68:71], v[160:163], a[136:139], v[68:71]
    v_mfma_f32_16x16x32_bf16 v[68:71], v[176:179], a[0:3], v[68:71]
    v_mfma_f32_16x16x32_bf16 v[84:87], v[164:167], a[136:139], v[84:87]
    v_mfma_f32_16x16x32_bf16 v[84:87], v[180:183], a[0:3], v[84:87]
    s_waitcnt vmcnt(7) lgkmcnt(0)
    s_barrier
    v_mfma_f32_16x16x32_bf16 v[36:39], v[184:187], a[4:7], v[36:39]
    s_waitcnt vmcnt(6)
    ds_read_b128 v[24:27], v15 offset:0
    ds_read_b128 v[28:31], v15 offset:16384
    v_mfma_f32_16x16x32_bf16 v[36:39], v[200:203], a[8:11], v[36:39]
    ds_read_b128 v[32:35], v15 offset:32768
    ds_read_b128 v[40:43], v15 offset:4096
    v_mfma_f32_16x16x32_bf16 v[52:55], v[188:191], a[4:7], v[52:55]
    ds_read_b128 v[44:47], v15 offset:20480
    ds_read_b128 v[48:51], v15 offset:36864
    v_mfma_f32_16x16x32_bf16 v[52:55], v[204:207], a[8:11], v[52:55]
    ds_read_b128 v[56:59], v15 offset:8192
    ds_read_b128 v[60:63], v15 offset:24576
    v_mfma_f32_16x16x32_bf16 v[68:71], v[192:195], a[4:7], v[68:71]
    ds_read_b128 v[64:67], v15 offset:40960
    ds_read_b128 v[72:75], v15 offset:12288
    v_mfma_f32_16x16x32_bf16 v[68:71], v[208:211], a[8:11], v[68:71]
    ds_read_b128 v[76:79], v15 offset:28672
    ds_read_b128 v[80:83], v15 offset:45056
    v_mfma_f32_16x16x32_bf16 v[84:87], v[196:199], a[4:7], v[84:87]
    v_mfma_f32_16x16x32_bf16 v[84:87], v[212:215], a[8:11], v[84:87]
    s_waitcnt vmcnt(5) lgkmcnt(9)
    v_add_f32 v24, v24, v28
    v_add_f32 v25, v25, v29
    v_mfma_f32_16x16x32_bf16 v[36:39], v[216:219], a[12:15], v[36:39]
    s_waitcnt vmcnt(4)
    v_add_f32 v26, v26, v30
    v_add_f32 v27, v27, v31
    v_mfma_f32_16x16x32_bf16 v[36:39], v[148:151], a[16:19], v[36:39]
    v_add_f32 v24, v24, v32
    v_add_f32 v25, v25, v33
    v_mfma_f32_16x16x32_bf16 v[52:55], v[220:223], a[12:15], v[52:55]
    v_add_f32 v26, v26, v34
    v_add_f32 v27, v27, v35
    v_mfma_f32_16x16x32_bf16 v[52:55], a[180:183], a[16:19], v[52:55]
    v_fmac_f32 v88, v236, v24
    v_fmac_f32 v89, v237, v25
    v_mfma_f32_16x16x32_bf16 v[68:71], v[224:227], a[12:15], v[68:71]
    v_fmac_f32 v90, v238, v26
    v_fmac_f32 v91, v239, v27
    v_mfma_f32_16x16x32_bf16 v[68:71], a[184:187], a[16:19], v[68:71]
    s_waitcnt lgkmcnt(6)
    v_add_f32 v40, v40, v44
    v_add_f32 v41, v41, v45
    v_mfma_f32_16x16x32_bf16 v[84:87], v[252:255], a[12:15], v[84:87]
    v_add_f32 v42, v42, v46
    v_add_f32 v43, v43, v47
    v_mfma_f32_16x16x32_bf16 v[84:87], a[188:191], a[16:19], v[84:87]
    s_waitcnt vmcnt(3)
    v_add_f32 v40, v40, v48
    v_add_f32 v41, v41, v49
    v_mfma_f32_16x16x32_bf16 v[36:39], a[192:195], a[20:23], v[36:39]
    s_waitcnt vmcnt(2)
    v_add_f32 v42, v42, v50
    v_add_f32 v43, v43, v51
    v_mfma_f32_16x16x32_bf16 v[36:39], a[208:211], a[24:27], v[36:39]
    v_fmac_f32 v92, v240, v40
    v_fmac_f32 v93, v241, v41
    v_mfma_f32_16x16x32_bf16 v[52:55], a[196:199], a[20:23], v[52:55]
    v_fmac_f32 v94, v242, v42
    v_fmac_f32 v95, v243, v43
    v_mfma_f32_16x16x32_bf16 v[52:55], a[212:215], a[24:27], v[52:55]
    s_waitcnt lgkmcnt(3)
    v_add_f32 v56, v56, v60
    v_add_f32 v57, v57, v61
    v_mfma_f32_16x16x32_bf16 v[68:71], a[200:203], a[20:23], v[68:71]
    v_add_f32 v58, v58, v62
    v_add_f32 v59, v59, v63
    v_mfma_f32_16x16x32_bf16 v[68:71], a[216:219], a[24:27], v[68:71]
    v_add_f32 v56, v56, v64
    v_add_f32 v57, v57, v65
    v_mfma_f32_16x16x32_bf16 v[84:87], a[204:207], a[20:23], v[84:87]
    v_add_f32 v58, v58, v66
    v_add_f32 v59, v59, v67
    v_mfma_f32_16x16x32_bf16 v[84:87], a[220:223], a[24:27], v[84:87]
    s_waitcnt vmcnt(1)
    v_fmac_f32 v96, v244, v56
    v_fmac_f32 v97, v245, v57
    v_mfma_f32_16x16x32_bf16 v[36:39], a[224:227], a[28:31], v[36:39]
    s_waitcnt vmcnt(0)
    v_fmac_f32 v98, v246, v58
    v_fmac_f32 v99, v247, v59
    v_mfma_f32_16x16x32_bf16 v[36:39], a[240:243], v[152:155], v[36:39]
    s_waitcnt lgkmcnt(0)
    v_add_f32 v72, v72, v76
    v_add_f32 v73, v73, v77
    v_mfma_f32_16x16x32_bf16 v[52:55], a[228:231], a[28:31], v[52:55]
    v_add_f32 v74, v74, v78
    v_add_f32 v75, v75, v79
    v_mfma_f32_16x16x32_bf16 v[52:55], a[244:247], v[152:155], v[52:55]
    v_add_f32 v72, v72, v80
    v_add_f32 v73, v73, v81
    v_mfma_f32_16x16x32_bf16 v[68:71], a[232:235], a[28:31], v[68:71]
    v_add_f32 v74, v74, v82
    v_add_f32 v75, v75, v83
    v_mfma_f32_16x16x32_bf16 v[68:71], a[248:251], v[152:155], v[68:71]
    v_fmac_f32 v100, v248, v72
    v_fmac_f32 v101, v249, v73
    v_mfma_f32_16x16x32_bf16 v[84:87], a[236:239], a[28:31], v[84:87]
    v_fmac_f32 v102, v250, v74
    v_fmac_f32 v103, v251, v75
    v_mfma_f32_16x16x32_bf16 v[84:87], a[252:255], v[152:155], v[84:87]
    s_nop 2
    v_pk_fma_f32 v[88:89], v[236:237], v[36:37], v[88:89]
    v_pk_fma_f32 v[90:91], v[238:239], v[38:39], v[90:91]
    v_pk_fma_f32 v[92:93], v[240:241], v[52:53], v[92:93]
    v_pk_fma_f32 v[94:95], v[242:243], v[54:55], v[94:95]
    v_cvt_pk_bf16_f32 v128, v88, v89
    v_cvt_pk_bf16_f32 v129, v90, v91
    v_cvt_pk_bf16_f32 v130, v92, v93
    v_cvt_pk_bf16_f32 v131, v94, v95
    s_nop 0
    v_permlane16_swap_b32 v128, v130
    v_permlane16_swap_b32 v129, v131
    buffer_store_dwordx4 v[128:131], v8, s[28:31], 0 offen offset:0 nt
    v_pk_fma_f32 v[96:97], v[244:245], v[68:69], v[96:97]
    v_pk_fma_f32 v[98:99], v[246:247], v[70:71], v[98:99]
    v_pk_fma_f32 v[100:101], v[248:249], v[84:85], v[100:101]
    v_pk_fma_f32 v[102:103], v[250:251], v[86:87], v[102:103]
    v_cvt_pk_bf16_f32 v132, v96, v97
    v_cvt_pk_bf16_f32 v133, v98, v99
    v_cvt_pk_bf16_f32 v134, v100, v101
    v_cvt_pk_bf16_f32 v135, v102, v103
    s_nop 0
    v_permlane16_swap_b32 v132, v134
    v_permlane16_swap_b32 v133, v135
    buffer_store_dwordx4 v[132:135], v8, s[28:31], 0 offen offset:64 nt
L_main_end:
    s_endpgm
L_att_retry:
    s_mov_b32 s48, 1
    s_mov_b32 s6, 0x10000000
    s_waitcnt vmcnt(0) lgkmcnt(0)
    s_mov_b32 s63, 0
    s_lshr_b32 s59, s42, 2
    s_mul_i32 s59, s59, 16384
    s_mov_b32 s60, s59
    s_add_u32 s46, s44, s59
    s_mov_b32 s47, s46
    v_mov_b32 v16, 0xff800000
    v_mov_b32 v17, 0xff800000
    v_mov_b32 v18, 0xff800000
    v_mov_b32 v19, 0xff800000
L_att_maxloop:
    s_barrier
    s_add_u32 m0, s51, 0
    s_nop 0
    buffer_load_dwordx4 v5, s[12:15], s46 offen lds
    s_add_u32 m0, s51, 832
    s_nop 0
    buffer_load_dwordx4 v5, s[12:15], s46 offen offset:256 lds
    s_add_u32 s59, s59, 8192
    s_and_b32 s59, s59, 0x1ffff
    s_add_u32 s46, s44, s59
    s_waitcnt vmcnt(0)
    s_barrier
    ds_read_b128 a[192:195], v3 offset:0
    ds_read_b128 a[196:199], v3 offset:64
    ds_read_b128 a[200:203], v3 offset:128
    ds_read_b128 a[204:207], v3 offset:192
    ds_read_b128 a[208:211], v3 offset:4352
    ds_read_b128 a[212:215], v3 offset:4416
    ds_read_b128 a[216:219], v3 offset:4480
    ds_read_b128 a[220:223], v3 offset:4544
    s_waitcnt lgkmcnt(0)
    v_mfma_f32_16x16x32_bf16 v[216:219], a[192:195], v[152:155], 0
    v_mfma_f32_16x16x32_bf16 v[216:219], a[196:199], v[156:159], v[216:219]
    v_mfma_f32_16x16x32_bf16 v[216:219], a[200:203], v[160:163], v[216:219]
    v_mfma_f32_16x16x32_bf16 v[216:219], a[204:207], v[164:167], v[216:219]
    v_mfma_f32_16x16x32_bf16 v[220:223], a[192:195], v[168:171], 0
    v_mfma_f32_16x16x32_bf16 v[220:223], a[196:199], v[172:175], v[220:223]
    v_mfma_f32_16x16x32_bf16 v[220:223], a[200:203], v[176:179], v[220:223]
    v_mfma_f32_16x16x32_bf16 v[220:223], a[204:207], v[180:183], v[220:223]
    v_mfma_f32_16x16x32_bf16 v[224:227], a[192:195], v[184:187], 0
    v_mfma_f32_16x16x32_bf16 v[224:227], a[196:199], v[188:191], v[224:227]
    v_mfma_f32_16x16x32_bf16 v[224:227], a[200:203], v[192:195], v[224:227]
    v_mfma_f32_16x16x32_bf16 v[224:227], a[204:207], v[196:199], v[224:227]
    v_mfma_f32_16x16x32_bf16 v[228:231], a[192:195], v[200:203], 0
    v_mfma_f32_16x16x32_bf16 v[228:231], a[196:199], v[204:207], v[228:231]
    v_mfma_f32_16x16x32_bf16 v[228:231], a[200:203], v[208:211], v[228:231]
    v_mfma_f32_16x16x32_bf16 v[228:231], a[204:207], v[212:215], v[228:231]
    s_nop 7
    v_max3_f32 v16, v16, v216, v217
    v_max3_f32 v16, v16, v218, v219
    v_max3_f32 v17, v17, v220, v221
    v_max3_f32 v17, v17, v222, v223
    v_max3_f32 v18, v18, v224, v225
    v_max3_f32 v18, v18, v226, v227
    v_max3_f32 v19, v19, v228, v229
    v_max3_f32 v19, v19, v230, v231
    v_mfma_f32_16x16x32_bf16 v[216:219], a[208:211], v[152:155], 0
    v_mfma_f32_16x16x32_bf16 v[216:219], a[212:215], v[156:159], v[216:219]
    v_mfma_f32_16x16x32_bf16 v[216:219], a[216:219], v[160:163], v[216:219]
    v_mfma_f32_16x16x32_bf16 v[216:219], a[220:223], v[164:167], v[216:219]
    v_mfma_f32_16x16x32_bf16 v[220:223], a[208:211], v[168:171], 0
    v_mfma_f32_16x16x32_bf16 v[220:223], a[212:215], v[172:175], v[220:223]
    v_mfma_f32_16x16x32_bf16 v[220:223], a[216:219], v[176:179], v[220:223]
    v_mfma_f32_16x16x32_bf16 v[220:223], a[220:223], v[180:183], v[220:223]
    v_mfma_f32_16x16x32_bf16 v[224:227], a[208:211], v[184:187], 0
    v_mfma_f32_16x16x32_bf16 v[224:227], a[212:215], v[188:191], v[224:227]
    v_mfma_f32_16x16x32_bf16 v[224:227], a[216:219], v[192:195], v[224:227]
    v_mfma_f32_16x16x32_bf16 v[224:227], a[220:223], v[196:199], v[224:227]
    v_mfma_f32_16x16x32_bf16 v[228:231], a[208:211], v[200:203], 0
    v_mfma_f32_16x16x32_bf16 v[228:231], a[212:215], v[204:207], v[228:231]
    v_mfma_f32_16x16x32_bf16 v[228:231], a[216:219], v[208:211], v[228:231]
    v_mfma_f32_16x16x32_bf16 v[228:231], a[220:223], v[212:215], v[228:231]
    s_nop 7
    v_max3_f32 v16, v16, v216, v217
    v_max3_f32 v16, v16, v218, v219
    v_max3_f32 v17, v17, v220, v221
    v_max3_f32 v17, v17, v222, v223
    v_max3_f32 v18, v18, v224, v225
    v_max3_f32 v18, v18, v226, v227
    v_max3_f32 v19, v19, v228, v229
    v_max3_f32 v19, v19, v230, v231
    s_add_u32 s63, s63, 1
    s_cmp_lt_u32 s63, 16
    s_cbranch_scc1 L_att_maxloop
    v_mov_b32 v20, v16
    v_mov_b32 v21, v17
    v_mov_b32 v22, v18
    v_mov_b32 v23, v19
    v_permlane32_swap_b32 v16, v20
    v_permlane32_swap_b32 v17, v21
    v_permlane32_swap_b32 v18, v22
    v_permlane32_swap_b32 v19, v23
    v_max_f32 v16, v16, v20
    v_max_f32 v17, v17, v21
    v_max_f32 v18, v18, v22
    v_max_f32 v19, v19, v23
    v_mov_b32 v20, v16
    v_mov_b32 v21, v17
    v_mov_b32 v22, v18
    v_mov_b32 v23, v19
    v_permlane16_swap_b32 v16, v20
    v_permlane16_swap_b32 v17, v21
    v_permlane16_swap_b32 v18, v22
    v_permlane16_swap_b32 v19, v23
    v_max_f32 v16, v16, v20
    v_max_f32 v17, v17, v21
    v_max_f32 v18, v18, v22
    v_max_f32 v19, v19, v23
    s_barrier
    s_lshr_b32 s59, s42, 2
    s_mul_i32 s59, s59, 16384
    s_mov_b32 s60, s59
    s_add_u32 s46, s44, s59
    s_mov_b32 s47, s46
    s_add_u32 m0, s51, 0
    s_nop 0
    buffer_load_dwordx4 v5, s[12:15], s46 offen lds
    s_add_u32 m0, s51, 832
    s_nop 0
    buffer_load_dwordx4 v5, s[12:15], s46 offen offset:256 lds
    s_add_u32 s59, s59, 8192
    s_and_b32 s59, s59, 0x1ffff
    s_add_u32 s46, s44, s59
    s_add_u32 m0, s51, 8704
    s_nop 0
    buffer_load_dwordx4 v5, s[12:15], s46 offen lds
    s_add_u32 m0, s51, 9536
    s_nop 0
    buffer_load_dwordx4 v5, s[12:15], s46 offen offset:256 lds
    s_add_u32 s59, s59, 8192
    s_and_b32 s59, s59, 0x1ffff
    s_add_u32 s46, s44, s59
    s_add_u32 m0, s52, 17408
    s_nop 0
    buffer_load_dwordx4 v6, s[16:19], s47 offen lds
    s_add_u32 m0, s52, 18208
    s_nop 0
    buffer_load_dwordx4 v6, s[16:19], s47 offen offset:256 lds
    s_add_u32 s60, s60, 8192
    s_and_b32 s60, s60, 0x1ffff
    s_add_u32 s47, s44, s60
    s_add_u32 m0, s51, 25856
    s_nop 0
    buffer_load_dwordx4 v5, s[12:15], s46 offen lds
    s_add_u32 m0, s51, 26688
    s_nop 0
    buffer_load_dwordx4 v5, s[12:15], s46 offen offset:256 lds
    s_add_u32 s59, s59, 8192
    s_and_b32 s59, s59, 0x1ffff
    s_add_u32 s46, s44, s59
    s_add_u32 m0, s52, 34496
    s_nop 0
    buffer_load_dwordx4 v6, s[16:19], s47 offen lds
    s_add_u32 m0, s52, 35296
    s_nop 0
    buffer_load_dwordx4 v6, s[16:19], s47 offen offset:256 lds
    s_add_u32 s60, s60, 8192
    s_and_b32 s60, s60, 0x1ffff
    s_add_u32 s47, s44, s60
    s_waitcnt vmcnt(0)
    s_barrier
    ds_read_b128 a[192:195], v3 offset:0
    ds_read_b128 a[196:199], v3 offset:64
    ds_read_b128 a[200:203], v3 offset:128
    ds_read_b128 a[204:207], v3 offset:192
    ds_read_b128 a[208:211], v3 offset:4352
    ds_read_b128 a[212:215], v3 offset:4416
    ds_read_b128 a[216:219], v3 offset:4480
    ds_read_b128 a[220:223], v3 offset:4544
    v_readlane_b32 s67, v0, 42
    v_readlane_b32 s5, v0, 43
    v_readlane_b32 s57, v0, 44
    v_readlane_b32 s58, v0, 45
    v_readlane_b32 s63, v0, 46
    v_readlane_b32 s49, v0, 47
    s_mul_i32 s4, s3, 25312
    s_add_u32 s45, s66, 3
    v_mov_b32 v15, s66
    v_mov_b32 v14, s45
    s_waitcnt lgkmcnt(0)
    s_branch L_att_setc
L_att_check:
    s_mov_b32 s49, 0x80000
    s_add_u32 s45, s66, 3
L_poll_19:
    buffer_load_dwordx2 v[16:17], v12, s[24:27], 0 offen sc1
    s_sub_u32 s49, s49, 1
    s_waitcnt vmcnt(0)
    s_cbranch_scc1 L_polled_20
L_ptest_21:
    v_subrev_u32 v16, s45, v16
    v_lshrrev_b32 v16, 3, v16
    v_bitop3_b32 v16, v17, s66, v16 bitop3:0xbe
    v_cmp_ne_u32 vcc, 0, v16
    s_cbranch_vccnz L_poll_19
L_polled_20:
    s_branch L_att_checked
L_px_wait:
    s_mov_b32 s49, 0x80000
    s_add_u32 s45, s66, 5
L_poll_22:
    buffer_load_dwordx2 v[22:23], v10, s[24:27], 0 offen sc1
    s_sub_u32 s49, s49, 1
    s_waitcnt vmcnt(0)
    s_cbranch_scc1 L_polled_23
L_ptest_24:
    v_subrev_u32 v22, s45, v22
    v_lshrrev_b32 v22, 3, v22
    v_bitop3_b32 v22, v23, s66, v22 bitop3:0xbe
    v_cmp_ne_u32 vcc, 0, v22
    s_cbranch_vccnz L_poll_22
L_polled_23:
    s_branch L_px_ok
L_code_end:

.section .rodata,"a"
.p2align 6
.amdhsa_kernel adaLN_cond__sliding_block_cached__dense_activation_gelu__prompt_kernel
  .amdhsa_next_free_vgpr 512
  .amdhsa_next_free_sgpr 102
  .amdhsa_accum_offset 256
  .amdhsa_group_segment_fixed_size 0
  .amdhsa_kernarg_size 120
  .amdhsa_user_sgpr_count 2
  .amdhsa_user_sgpr_kernarg_segment_ptr 1
  .amdhsa_system_sgpr_workgroup_id_x 1
  .amdhsa_float_denorm_mode_32 3
  .amdhsa_float_denorm_mode_16_64 3
  .amdhsa_ieee_mode 0
  .amdhsa_dx10_clamp 1
.end_amdhsa_kernel
```
